```python
import torch

def _softmax(x, axis=-1):
    return torch.softmax(x, dim=axis)
def _gelu(x):
    return torch.nn.functional.gelu(x, approximate="tanh")
def _silu(x):
    return torch.nn.functional.silu(x)
def _sigmoid(x):
    return torch.sigmoid(x)
def _layernorm(x, axis=-1, eps=1e-5):
    m = x.mean(dim=axis, keepdim=True)
    v = x.var(dim=axis, keepdim=True, unbiased=False)
    return (x - m) / torch.sqrt(v + eps)
def _scatter_add(tgt, idx, src, axis=0):
    return tgt.clone().index_add_(axis, idx, src)
def _segment_sum(src, seg, n):
    out = torch.zeros((n,) + src.shape[1:], dtype=src.dtype)
    return out.index_add_(0, seg, src)
def _pad(x, pw):
    flat = tuple(v for pair in reversed(pw) for v in pair)
    return torch.nn.functional.pad(x, flat)

kernel_name = 'standalone__mha_block_cached__near_ridge'

def setup_inputs():

    _w = (lambda a: (lambda t: t.to(torch.bfloat16) if t.is_floating_point() else t)(torch.as_tensor(a)))
    B, Sq, D = 16, 160, 448
    H, Sk, Dh = 16, 512, 256
    return {
        "x": _w((lambda *s: torch.randn(*s, dtype=torch.bfloat16) * 0.8)(B, Sq, D)),
        "k_cache": _w((lambda *s: torch.randn(*s, dtype=torch.bfloat16) * 0.8)(B, H, Sk, Dh)),
        "v_cache": _w((lambda *s: torch.randn(*s, dtype=torch.bfloat16) * 0.05)(B, H, Sk, Dh)),
        "wq": _w((lambda *s: torch.randn(*s, dtype=torch.bfloat16) * 0.8)(D, H * Dh) * (D ** -0.5)),
        "wo": _w((lambda *s: torch.randn(*s, dtype=torch.bfloat16) * 0.05)(H * Dh, D) * ((H * Dh) ** -0.5)),
    }

def reference(x, k_cache, v_cache, wq, wo):
    B, Sq, D = x.shape
    H, Dh = 16, 256
    q = (lambda x, *d: x.permute(*d))((x @ wq).reshape(B, Sq, H, Dh), 0, 2, 1, 3)
    scores = torch.einsum("bhqd,bhkd->bhqk", q, k_cache) * (Dh ** -0.5)
    p = _softmax(scores, axis=-1)
    o = torch.einsum("bhqk,bhkd->bhqd", p, v_cache)
    return (lambda x, *d: x.permute(*d))(o, 0, 2, 1, 3).reshape(B, Sq, H * Dh) @ wo
```

```asm
; @launch grid=(256,1,1) block=(256,1,1) lds=163840
.amdgcn_target "amdgcn-amd-amdhsa--gfx950"
.text
.globl standalone__mha_block_cached__near_ridge_kernel
.p2align 8
.type standalone__mha_block_cached__near_ridge_kernel,@function
standalone__mha_block_cached__near_ridge_kernel:
  s_cmp_ge_u32 s2, 256
  s_cbranch_scc1 L_exit
  v_lshrrev_b32 v1, 6, v0
  v_and_b32 v0, 63, v0
  s_mov_b32 s57, 0
  v_readfirstlane_b32 s32, v1
  s_mov_b64 vcc, 0
  s_mov_b32 s58, 0x35800000
  s_mov_b32 s59, 0x19000000
L_start:
  s_load_dwordx2 s[8:9], s[0:1], 0
  s_load_dwordx2 s[20:21], s[0:1], 24
  s_load_dwordx2 s[12:13], s[0:1], 8
  s_load_dwordx2 s[16:17], s[0:1], 16
  s_load_dwordx2 s[24:25], s[0:1], 32
  s_load_dwordx2 s[4:5], s[0:1], 56
  s_load_dwordx2 s[6:7], s[0:1], 40
  s_load_dwordx2 s[64:65], s[0:1], 48
  s_and_b32 s36, s2, 7
  s_lshr_b32 s37, s2, 3
  s_lshl_b32 s33, s36, 1
  s_lshr_b32 s38, s37, 4
  s_add_u32 s33, s33, s38
  s_and_b32 s34, s37, 15
  s_mov_b32 s10, 143360
  s_mov_b32 s11, 0x00020000
  s_mov_b32 s23, 0x00020000
  s_lshl_b32 s42, s32, 13
  s_lshl_b32 s43, s32, 10
  s_lshl_b32 s40, s32, 17
  s_mul_i32 s41, s32, 7168
  v_lshrrev_b32 v44, 5, v0
  v_and_b32 v45, 31, v0
  v_lshlrev_b32 v1, 2, v44
  v_xor_b32 v1, v1, v45
  v_lshlrev_b32 v1, 4, v1
  v_lshl_add_u32 v2, v44, 13, v1
  v_xor_b32 v3, 0x80, v2
  v_add_u32 v3, 15360, v3
  v_add_u32 v4, 30720, v2
  v_add_u32 v5, 30720, v3
  s_and_b32 s38, s32, 1
  s_lshl_b32 s36, s38, 2
  v_lshrrev_b32 v6, 4, v0
  v_xor_b32 v6, s36, v6
  v_and_b32 v1, 7, v0
  v_xor_b32 v6, v6, v1
  v_lshlrev_b32 v6, 4, v6
  v_lshrrev_b32 v1, 3, v0
  v_mul_u32_u24 v1, 896, v1
  v_add_u32 v6, v6, v1
  s_mul_i32 s36, s33, 143360
  s_lshl_b32 s37, s34, 9
  s_waitcnt lgkmcnt(0)
  s_add_u32 s8, s8, s36
  s_addc_u32 s9, s9, 0
  s_add_u32 s20, s20, s37
  s_addc_u32 s21, s21, 0
  s_sub_u32 s22, 3670016, s37
  s_lshl_b32 s36, s2, 2
  s_add_u32 s36, s36, s32
  s_lshl_b32 s36, s36, 12
  s_lshl_b32 s37, s34, 9
  s_sub_u32 s36, s36, s37
  v_lshlrev_b32 v248, 6, v0
  s_lshl_b32 s37, s34, 2
  s_add_u32 s37, s37, s32
  s_lshl_b32 s37, s37, 12
  v_add_u32 v249, s37, v248
  v_add_u32 v248, s36, v248
  buffer_load_dword v248, v248, s[20:23], 0 offen
  buffer_load_dword v249, v249, s[8:11], 0 offen
  s_add_u32 m0, s42, 0
  s_add_u32 s55, s40, 0
  buffer_load_dwordx4 v2, s[20:23], s55 offen offset:0  lds
  buffer_load_dwordx4 v3, s[20:23], s55 offen offset:1024  lds
  buffer_load_dwordx4 v4, s[20:23], s55 offen offset:2048  lds
  buffer_load_dwordx4 v5, s[20:23], s55 offen offset:3072  lds
  s_add_u32 m0, s42, 4096
  s_add_u32 s55, s40, 65536
  buffer_load_dwordx4 v2, s[20:23], s55 offen offset:0  lds
  buffer_load_dwordx4 v3, s[20:23], s55 offen offset:1024  lds
  buffer_load_dwordx4 v4, s[20:23], s55 offen offset:2048  lds
  buffer_load_dwordx4 v5, s[20:23], s55 offen offset:3072  lds
  s_add_u32 m0, s43, 98304
  s_add_u32 s55, s41, 0
  buffer_load_dwordx4 v6, s[8:11], s55 offen  lds
  s_add_u32 m0, s43, 102400
  s_add_u32 s55, s41, 28672
  buffer_load_dwordx4 v6, s[8:11], s55 offen  lds
  s_add_u32 m0, s43, 106496
  s_add_u32 s55, s41, 57344
  buffer_load_dwordx4 v6, s[8:11], s55 offen  lds
  s_add_u32 m0, s43, 110592
  s_add_u32 s55, s41, 86016
  buffer_load_dwordx4 v6, s[8:11], s55 offen  lds
  s_add_u32 m0, s43, 114688
  s_add_u32 s55, s41, 114688
  buffer_load_dwordx4 v6, s[8:11], s55 offen  lds
  s_lshl_b32 s36, s33, 4
  s_add_u32 s36, s36, s34
  s_lshl_b32 s36, s36, 18
  s_add_u32 s16, s16, s36
  s_addc_u32 s17, s17, 0
  s_add_u32 s12, s12, s36
  s_addc_u32 s13, s13, 0
  s_mov_b32 s14, 262144
  s_mov_b32 s15, 0x00020000
  s_mov_b32 s18, 262144
  s_mov_b32 s19, 0x00020000
  s_lshl_b32 s44, s32, 11
  s_add_u32 m0, s42, 32768
  s_add_u32 s55, s40, 524288
  buffer_load_dwordx4 v2, s[20:23], s55 offen offset:0  lds
  buffer_load_dwordx4 v3, s[20:23], s55 offen offset:1024  lds
  buffer_load_dwordx4 v4, s[20:23], s55 offen offset:2048  lds
  buffer_load_dwordx4 v5, s[20:23], s55 offen offset:3072  lds
  s_add_u32 m0, s42, 36864
  s_add_u32 s55, s40, 589824
  buffer_load_dwordx4 v2, s[20:23], s55 offen offset:0  lds
  buffer_load_dwordx4 v3, s[20:23], s55 offen offset:1024  lds
  buffer_load_dwordx4 v4, s[20:23], s55 offen offset:2048  lds
  buffer_load_dwordx4 v5, s[20:23], s55 offen offset:3072  lds
  s_add_u32 m0, s43, 118784
  s_add_u32 s55, s41, 128
  buffer_load_dwordx4 v6, s[8:11], s55 offen  lds
  s_add_u32 m0, s43, 122880
  s_add_u32 s55, s41, 28800
  buffer_load_dwordx4 v6, s[8:11], s55 offen  lds
  s_add_u32 m0, s43, 126976
  s_add_u32 s55, s41, 57472
  buffer_load_dwordx4 v6, s[8:11], s55 offen  lds
  s_add_u32 m0, s43, 131072
  s_add_u32 s55, s41, 86144
  buffer_load_dwordx4 v6, s[8:11], s55 offen  lds
  s_add_u32 m0, s43, 135168
  s_add_u32 s55, s41, 114816
  buffer_load_dwordx4 v6, s[8:11], s55 offen  lds
  v_bfe_u32 v1, v0, 4, 1
  v_and_b32 v8, 7, v0
  v_xor_b32 v8, v8, v1
  v_lshlrev_b32 v8, 4, v8
  v_lshl_add_u32 v8, v44, 7, v8
  v_bfe_u32 v1, v0, 3, 2
  v_lshl_add_u32 v8, v1, 9, v8
  v_xor_b32 v9, 32, v8
  v_add_u32 v9, 7168, v9
  v_xor_b32 v10, 64, v8
  v_add_u32 v10, 14336, v10
  v_xor_b32 v11, 0x60, v8
  v_add_u32 v11, 21504, v11
  s_getpc_b64 s[96:97]
L_pc:
  s_mov_b32 s95, L_codeend-L_pc-4
  s_lshl_b32 s98, s32, 12
  s_add_u32 s98, s98, L_pc-L_pc+0
  v_lshlrev_b32 v242, 6, v0
  v_add_u32 v242, s98, v242
  v_min_u32 v242, s95, v242
  v_mov_b32 v243, s97
  v_add_co_u32 v242, s[98:99], s96, v242
  s_nop 1
  v_addc_co_u32 v243, s[98:99], 0, v243, s[98:99]
  global_load_dword v242, v[242:243], off
  s_lshl_b32 s36, s33, 11
  s_add_u32 s36, s36, 44040192
  s_add_u32 s60, s4, s36
  s_addc_u32 s61, s5, 0
  s_lshl_b32 s36, s33, 4
  s_add_u32 s64, s64, s36
  s_addc_u32 s65, s65, 0
  s_mov_b32 s62, 2048
  s_mov_b32 s63, 0x00020000
  s_mov_b32 s66, 16
  s_mov_b32 s67, 0x00020000
  s_lshl_b32 s3, s34, 7
  s_lshl_b32 s36, s32, 2
  s_add_u32 s3, s3, s36
  v_lshlrev_b32 v247, 23, v0
  v_mov_b32 v245, 0
  buffer_store_dword v245, v247, s[60:63], s3 offen
  s_mul_i32 s36, s34, 229376
  s_add_u32 s24, s24, s36
  s_addc_u32 s25, s25, 0
  s_mul_i32 s36, s33, 688128
  s_lshr_b32 s37, s34, 2
  s_lshl_b32 s37, s37, 11
  s_add_u32 s36, s36, s37
  s_add_u32 s28, s4, s36
  s_addc_u32 s29, s5, 0
  s_mov_b32 s26, 229376
  s_mov_b32 s27, 0x00020000
  s_mov_b32 s30, 688128
  s_mov_b32 s31, 0x00020000
  s_mov_b32 s39, 0x3db8aa3b
  v_bfe_u32 v47, v0, 2, 2
  v_lshl_add_u32 v43, v44, 3, v47
  v_bfe_u32 v1, v0, 4, 1
  v_lshlrev_b32 v46, 5, v1
  v_and_b32 v1, 1, v0
  v_lshl_add_u32 v46, v1, 4, v46
  v_bfe_u32 v1, v0, 1, 1
  v_lshl_add_u32 v46, v1, 3, v46
  v_lshl_add_u32 v1, v47, 6, v46
  s_lshl_b32 s36, s32, 6
  v_lshl_add_u32 v12, v43, 9, v1
  v_xor_b32 v12, s36, v12
  v_xor_b32 v13, 64, v12
  v_xor_b32 v14, 0x80, v12
  v_xor_b32 v15, 0xc0, v12
  v_bfe_u32 v1, v0, 1, 3
  v_xor_b32 v1, v1, v44
  v_lshlrev_b32 v1, 4, v1
  v_lshl_add_u32 v1, v45, 7, v1
  v_add_u32 v20, 114688, v1
  s_lshl_b32 s36, s32, 12
  s_add_u32 s36, s36, 98304
  v_add_u32 v16, s36, v1
  v_xor_b32 v17, 32, v16
  v_xor_b32 v18, 64, v16
  v_xor_b32 v19, 0x60, v16
  v_xor_b32 v21, 32, v20
  v_xor_b32 v22, 64, v20
  v_xor_b32 v23, 0x60, v20
  v_and_b32 v42, 0x13, v0
  v_bfe_u32 v1, v0, 2, 1
  v_lshl_or_b32 v42, v1, 3, v42
  v_bfe_u32 v1, v0, 3, 1
  v_lshl_or_b32 v42, v1, 2, v42
  v_bfe_u32 v1, v42, 1, 3
  v_xor_b32 v1, v1, v44
  v_lshlrev_b32 v1, 4, v1
  v_and_b32 v24, 3, v42
  v_lshl_add_u32 v1, v24, 7, v1
  v_lshrrev_b32 v24, 2, v42
  v_lshl_add_u32 v1, v24, 10, v1
  s_add_u32 s36, s42, 32768
  v_add_u32 v32, s36, v1
  v_xor_b32 v33, 32, v32
  v_xor_b32 v34, 64, v32
  v_xor_b32 v35, 0x60, v32
  s_lshr_b32 s37, s32, 1
  s_lshl_b32 s37, s37, 9
  s_and_b32 s38, s32, 1
  s_lshl_b32 s38, s38, 6
  s_add_u32 s37, s37, s38
  s_add_u32 s37, s37, 32768
  v_xor_b32 v24, s37, v1
  v_xor_b32 v25, 32, v24
  v_xor_b32 v26, 64, v24
  v_xor_b32 v27, 96, v24
  v_xor_b32 v28, 512, v24
  v_xor_b32 v29, 544, v24
  v_xor_b32 v30, 576, v24
  v_xor_b32 v31, 608, v24
  v_lshlrev_b32 v1, 4, v0
  v_add_u32 v7, s36, v1
  v_add_u32 v36, 131072, v1
  s_lshl_b32 s36, s32, 11
  v_add_u32 v37, s36, v36
  s_waitcnt vmcnt(15)
  s_barrier
L_RA0:
  ds_read_b128 v[208:211], v16 offset:0
  ds_read_b64_tr_b16 a[224:225], v12 offset:0
  ds_read_b64_tr_b16 a[226:227], v12 offset:2048
  s_add_u32 m0, s42, 65536
  s_add_u32 s55, s40, 1048576
  buffer_load_dwordx4 v2, s[20:23], s55 offen offset:0  lds
  ds_read_b128 v[212:215], v20 offset:0
  ds_read_b64_tr_b16 a[228:229], v12 offset:256
  ds_read_b64_tr_b16 a[230:231], v12 offset:2304
  ds_read_b64_tr_b16 a[232:233], v13 offset:0
  ds_read_b64_tr_b16 a[234:235], v13 offset:2048
  ds_read_b64_tr_b16 a[236:237], v14 offset:0
  ds_read_b64_tr_b16 a[238:239], v14 offset:2048
  ds_read_b64_tr_b16 a[240:241], v15 offset:0
  ds_read_b64_tr_b16 a[242:243], v15 offset:2048
  ds_read_b64_tr_b16 a[244:245], v13 offset:256
  ds_read_b64_tr_b16 a[246:247], v13 offset:2304
  s_waitcnt lgkmcnt(11)
  v_mfma_f32_32x32x16_bf16 v[48:63], a[224:227], v[208:211], 0
  s_xor_b32 s56, s44, 0
  buffer_load_dwordx4 a[0:3], v8, s[12:15], s56 offen offset:0 nt
  ds_read_b64_tr_b16 a[248:249], v14 offset:256
  ds_read_b64_tr_b16 a[250:251], v14 offset:2304
  ds_read_b64_tr_b16 a[252:253], v15 offset:256
  s_waitcnt lgkmcnt(13)
  v_mfma_f32_32x32x16_bf16 v[176:191], a[224:227], v[212:215], 0
  buffer_load_dwordx4 v3, s[20:23], s55 offen offset:1024  lds
  ds_read_b64_tr_b16 a[254:255], v15 offset:2304
  s_waitcnt lgkmcnt(12)
  v_mfma_f32_32x32x16_bf16 v[112:127], a[228:231], v[208:211], 0
  ds_read_b128 v[216:219], v17 offset:0
  ds_read_b64_tr_b16 a[224:225], v12 offset:8192
  s_getreg_b32 s36, hwreg(HW_REG_XCC_ID, 0, 3)
  s_mul_i32 s37, s36, s36
  s_lshl_b32 s37, s37, 8
  s_add_u32 s36, s36, s37
  v_mfma_f32_32x32x16_bf16 v[192:207], a[228:231], v[212:215], 0
  buffer_load_dwordx4 v4, s[20:23], s55 offen offset:2048  lds
  s_lshl_b32 s36, s36, 8
  s_waitcnt lgkmcnt(10)
  v_mfma_f32_32x32x16_bf16 v[64:79], a[232:235], v[208:211], 0
  ds_read_b64_tr_b16 a[226:227], v12 offset:10240
  ds_read_b128 v[220:223], v21 offset:0
  ds_read_b64_tr_b16 a[228:229], v12 offset:8448
  s_add_u32 s36, s36, 1
  s_lshl_b32 s94, s36, 4
  s_lshl_b32 s37, s32, 29
  v_mfma_f32_32x32x16_bf16 v[80:95], a[236:239], v[208:211], 0
  buffer_load_dwordx4 v5, s[20:23], s55 offen offset:3072  lds
  ds_read_b64_tr_b16 a[230:231], v12 offset:10496
  s_waitcnt lgkmcnt(10)
  v_mfma_f32_32x32x16_bf16 v[96:111], a[240:243], v[208:211], 0
  ds_read_b64_tr_b16 a[232:233], v13 offset:8192
  ds_read_b64_tr_b16 a[234:235], v13 offset:10240
  ds_read_b64_tr_b16 a[236:237], v14 offset:8192
  s_cmp_eq_u32 s57, 0
  s_cselect_b32 s36, s36, 0
  v_add_u32 v244, s37, v247
  v_mfma_f32_32x32x16_bf16 v[128:143], a[244:247], v[208:211], 0
  s_add_u32 m0, s42, 69632
  s_add_u32 s55, s40, 1114112
  buffer_load_dwordx4 v2, s[20:23], s55 offen offset:0  lds
  ds_read_b64_tr_b16 a[238:239], v14 offset:10240
  s_waitcnt lgkmcnt(10)
  v_mfma_f32_32x32x16_bf16 v[144:159], a[248:251], v[208:211], 0
  buffer_load_dwordx4 a[32:35], v8, s[12:15], s56 offen offset:256 nt
  ds_read_b64_tr_b16 a[240:241], v15 offset:8192
  ds_read_b64_tr_b16 a[242:243], v15 offset:10240
  ds_read_b64_tr_b16 a[244:245], v13 offset:8448
  v_mfma_f32_32x32x16_bf16 v[160:175], a[252:255], v[208:211], 0
  buffer_load_dwordx4 v3, s[20:23], s55 offen offset:1024  lds
  ds_read_b64_tr_b16 a[246:247], v13 offset:10496
  s_waitcnt lgkmcnt(10)
  v_mfma_f32_32x32x16_bf16 v[48:63], a[224:227], v[216:219], v[48:63]
  ds_read_b64_tr_b16 a[248:249], v14 offset:8448
  ds_read_b64_tr_b16 a[250:251], v14 offset:10496
  ds_read_b64_tr_b16 a[252:253], v15 offset:8448
  v_mov_b32 v246, s36
  v_lshl_add_u32 v45, v47, 6, v46
  s_lshl_b32 s36, s32, 6
  v_mfma_f32_32x32x16_bf16 v[176:191], a[224:227], v[220:223], v[176:191]
  buffer_load_dwordx4 v4, s[20:23], s55 offen offset:2048  lds
  ds_read_b64_tr_b16 a[254:255], v15 offset:10496
  s_waitcnt lgkmcnt(12)
  v_mfma_f32_32x32x16_bf16 v[112:127], a[228:231], v[216:219], v[112:127]
  ds_read_b128 v[224:227], v18 offset:0
  ds_read_b64_tr_b16 a[224:225], v12 offset:16384
  v_lshl_add_u32 v45, v43, 8, v45
  s_add_u32 s36, s36, 65536
  v_lshrrev_b32 v42, 4, v0
  s_and_b32 s37, s32, 1
  v_mfma_f32_32x32x16_bf16 v[192:207], a[228:231], v[220:223], v[192:207]
  buffer_load_dwordx4 v5, s[20:23], s55 offen offset:3072  lds
  s_lshl_b32 s37, s37, 6
  s_waitcnt lgkmcnt(10)
  v_mfma_f32_32x32x16_bf16 v[64:79], a[232:235], v[216:219], v[64:79]
  ds_read_b64_tr_b16 a[226:227], v12 offset:18432
  ds_read_b128 v[228:231], v22 offset:0
  ds_read_b64_tr_b16 a[228:229], v12 offset:16640
  s_and_b32 s38, s34, 3
  v_and_b32 v44, 1, v0
  v_lshlrev_b32 v44, 4, v44
  v_mfma_f32_32x32x16_bf16 v[80:95], a[236:239], v[216:219], v[80:95]
  s_add_u32 m0, s43, 139264
  s_add_u32 s55, s41, 256
  buffer_load_dwordx4 v6, s[8:11], s55 offen  lds
  ds_read_b64_tr_b16 a[230:231], v12 offset:18688
  s_waitcnt lgkmcnt(10)
  v_mfma_f32_32x32x16_bf16 v[96:111], a[240:243], v[216:219], v[96:111]
  buffer_load_dwordx4 a[4:7], v9, s[12:15], s56 offen offset:1024 nt
  ds_read_b64_tr_b16 a[232:233], v13 offset:16384
  ds_read_b64_tr_b16 a[234:235], v13 offset:18432
  ds_read_b64_tr_b16 a[236:237], v14 offset:16384
  v_mfma_f32_32x32x16_bf16 v[128:143], a[244:247], v[216:219], v[128:143]
  s_add_u32 m0, s43, 143360
  s_add_u32 s55, s41, 28928
  buffer_load_dwordx4 v6, s[8:11], s55 offen  lds
  ds_read_b64_tr_b16 a[238:239], v14 offset:18432
  s_waitcnt lgkmcnt(10)
  v_mfma_f32_32x32x16_bf16 v[144:159], a[248:251], v[216:219], v[144:159]
  ds_read_b64_tr_b16 a[240:241], v15 offset:16384
  ds_read_b64_tr_b16 a[242:243], v15 offset:18432
  ds_read_b64_tr_b16 a[244:245], v13 offset:16640
  s_mul_i32 s47, s38, 256
  s_cmp_eq_u32 s38, 3
  s_cselect_b32 s46, 1, 2
  v_mfma_f32_32x32x16_bf16 v[160:175], a[252:255], v[216:219], v[160:175]
  s_add_u32 m0, s43, 147456
  s_add_u32 s55, s41, 57600
  buffer_load_dwordx4 v6, s[8:11], s55 offen  lds
  ds_read_b64_tr_b16 a[246:247], v13 offset:18688
  s_waitcnt lgkmcnt(10)
  v_mfma_f32_32x32x16_bf16 v[48:63], a[224:227], v[224:227], v[48:63]
  ds_read_b64_tr_b16 a[248:249], v14 offset:16640
  ds_read_b64_tr_b16 a[250:251], v14 offset:18688
  ds_read_b64_tr_b16 a[252:253], v15 offset:16640
  s_add_u32 s48, s47, 128
  s_cmp_eq_u32 s48, 896
  s_cselect_b32 s48, 0, s48
  v_mfma_f32_32x32x16_bf16 v[176:191], a[224:227], v[228:231], v[176:191]
  s_add_u32 m0, s43, 151552
  s_add_u32 s55, s41, 86272
  buffer_load_dwordx4 v6, s[8:11], s55 offen  lds
  ds_read_b64_tr_b16 a[254:255], v15 offset:18688
  s_waitcnt lgkmcnt(12)
  v_mfma_f32_32x32x16_bf16 v[112:127], a[228:231], v[224:227], v[112:127]
  buffer_load_dwordx4 a[36:39], v9, s[12:15], s56 offen offset:1280 nt
  ds_read_b128 v[232:235], v19 offset:0
  ds_read_b64_tr_b16 a[224:225], v12 offset:24576
  s_mov_b32 s101, 0
  v_mfma_f32_32x32x16_bf16 v[192:207], a[228:231], v[228:231], v[192:207]
  s_add_u32 m0, s43, 155648
  s_add_u32 s55, s41, 114944
  buffer_load_dwordx4 v6, s[8:11], s55 offen  lds
  s_waitcnt lgkmcnt(10)
  v_mfma_f32_32x32x16_bf16 v[64:79], a[232:235], v[224:227], v[64:79]
  ds_read_b64_tr_b16 a[226:227], v12 offset:26624
  ds_read_b128 v[236:239], v23 offset:0
  ds_read_b64_tr_b16 a[228:229], v12 offset:24832
  s_add_u32 s49, s48, 128
  s_cmp_eq_u32 s49, 896
  s_cselect_b32 s49, 0, s49
  v_mfma_f32_32x32x16_bf16 v[80:95], a[236:239], v[224:227], v[80:95]
  ds_read_b64_tr_b16 a[230:231], v12 offset:26880
  s_add_u32 s50, s49, 128
  s_cmp_eq_u32 s50, 896
  s_cselect_b32 s50, 0, s50
  s_waitcnt lgkmcnt(10)
  v_mfma_f32_32x32x16_bf16 v[96:111], a[240:243], v[224:227], v[96:111]
  ds_read_b64_tr_b16 a[232:233], v13 offset:24576
  ds_read_b64_tr_b16 a[234:235], v13 offset:26624
  ds_read_b64_tr_b16 a[236:237], v14 offset:24576
  s_add_u32 s51, s50, 128
  s_cmp_eq_u32 s51, 896
  s_cselect_b32 s51, 0, s51
  v_mfma_f32_32x32x16_bf16 v[128:143], a[244:247], v[224:227], v[128:143]
  ds_read_b64_tr_b16 a[238:239], v14 offset:26624
  s_add_u32 s52, s51, 128
  s_cmp_eq_u32 s52, 896
  s_cselect_b32 s52, 0, s52
  s_waitcnt lgkmcnt(10)
  v_mfma_f32_32x32x16_bf16 v[144:159], a[248:251], v[224:227], v[144:159]
  ds_read_b64_tr_b16 a[240:241], v15 offset:24576
  ds_read_b64_tr_b16 a[242:243], v15 offset:26624
  ds_read_b64_tr_b16 a[244:245], v13 offset:24832
  s_add_u32 s53, s52, 128
  s_cmp_eq_u32 s53, 896
  s_cselect_b32 s53, 0, s53
  v_mfma_f32_32x32x16_bf16 v[160:175], a[252:255], v[224:227], v[160:175]
  ds_read_b64_tr_b16 a[246:247], v13 offset:26880
  s_lshl_b32 s45, s53, 7
  s_waitcnt lgkmcnt(10)
  v_mfma_f32_32x32x16_bf16 v[48:63], a[224:227], v[232:235], v[48:63]
  ds_read_b64_tr_b16 a[248:249], v14 offset:24832
  ds_read_b64_tr_b16 a[250:251], v14 offset:26880
  ds_read_b64_tr_b16 a[252:253], v15 offset:24832
  buffer_load_dwordx4 a[8:11], v10, s[12:15], s56 offen offset:2048 nt
  v_mfma_f32_32x32x16_bf16 v[176:191], a[224:227], v[236:239], v[176:191]
  ds_read_b64_tr_b16 a[254:255], v15 offset:26880
  s_waitcnt vmcnt(20)
  s_barrier
L_RA1:
  s_waitcnt lgkmcnt(12)
  v_mfma_f32_32x32x16_bf16 v[112:127], a[228:231], v[232:235], v[112:127]
  ds_read_b128 v[208:211], v16 offset:20480
  ds_read_b64_tr_b16 a[224:225], v12 offset:32768
  v_mfma_f32_32x32x16_bf16 v[192:207], a[228:231], v[236:239], v[192:207]
  s_waitcnt lgkmcnt(10)
  v_mfma_f32_32x32x16_bf16 v[64:79], a[232:235], v[232:235], v[64:79]
  ds_read_b64_tr_b16 a[226:227], v12 offset:34816
  ds_read_b128 v[212:215], v20 offset:20480
  ds_read_b64_tr_b16 a[228:229], v12 offset:33024
  v_mfma_f32_32x32x16_bf16 v[80:95], a[236:239], v[232:235], v[80:95]
  ds_read_b64_tr_b16 a[230:231], v12 offset:35072
  s_waitcnt lgkmcnt(10)
  v_mfma_f32_32x32x16_bf16 v[96:111], a[240:243], v[232:235], v[96:111]
  ds_read_b64_tr_b16 a[232:233], v13 offset:32768
  ds_read_b64_tr_b16 a[234:235], v13 offset:34816
  ds_read_b64_tr_b16 a[236:237], v14 offset:32768
  v_mfma_f32_32x32x16_bf16 v[128:143], a[244:247], v[232:235], v[128:143]
  ds_read_b64_tr_b16 a[238:239], v14 offset:34816
  s_waitcnt lgkmcnt(10)
  v_mfma_f32_32x32x16_bf16 v[144:159], a[248:251], v[232:235], v[144:159]
  buffer_load_dwordx4 a[40:43], v10, s[12:15], s56 offen offset:2304 nt
  ds_read_b64_tr_b16 a[240:241], v15 offset:32768
  ds_read_b64_tr_b16 a[242:243], v15 offset:34816
  ds_read_b64_tr_b16 a[244:245], v13 offset:33024
  v_mfma_f32_32x32x16_bf16 v[160:175], a[252:255], v[232:235], v[160:175]
  ds_read_b64_tr_b16 a[246:247], v13 offset:35072
  s_waitcnt lgkmcnt(10)
  v_mfma_f32_32x32x16_bf16 v[48:63], a[224:227], v[208:211], v[48:63]
  s_barrier
  ds_read_b64_tr_b16 a[248:249], v14 offset:33024
  ds_read_b64_tr_b16 a[250:251], v14 offset:35072
  ds_read_b64_tr_b16 a[252:253], v15 offset:33024
  v_mfma_f32_32x32x16_bf16 v[176:191], a[224:227], v[212:215], v[176:191]
  s_add_u32 m0, s42, 0
  s_add_u32 s55, s40, 1572864
  buffer_load_dwordx4 v2, s[20:23], s55 offen offset:0  lds
  ds_read_b64_tr_b16 a[254:255], v15 offset:35072
  s_waitcnt lgkmcnt(12)
  v_mfma_f32_32x32x16_bf16 v[112:127], a[228:231], v[208:211], v[112:127]
  ds_read_b128 v[216:219], v17 offset:20480
  ds_read_b64_tr_b16 a[224:225], v12 offset:40960
  v_mfma_f32_32x32x16_bf16 v[192:207], a[228:231], v[212:215], v[192:207]
  buffer_load_dwordx4 v3, s[20:23], s55 offen offset:1024  lds
  s_waitcnt lgkmcnt(10)
  v_mfma_f32_32x32x16_bf16 v[64:79], a[232:235], v[208:211], v[64:79]
  ds_read_b64_tr_b16 a[226:227], v12 offset:43008
  ds_read_b128 v[220:223], v21 offset:20480
  ds_read_b64_tr_b16 a[228:229], v12 offset:41216
  v_mfma_f32_32x32x16_bf16 v[80:95], a[236:239], v[208:211], v[80:95]
  buffer_load_dwordx4 v4, s[20:23], s55 offen offset:2048  lds
  ds_read_b64_tr_b16 a[230:231], v12 offset:43264
  s_waitcnt lgkmcnt(10)
  v_mfma_f32_32x32x16_bf16 v[96:111], a[240:243], v[208:211], v[96:111]
  buffer_load_dwordx4 a[12:15], v11, s[12:15], s56 offen offset:3072 nt
  ds_read_b64_tr_b16 a[232:233], v13 offset:40960
  ds_read_b64_tr_b16 a[234:235], v13 offset:43008
  ds_read_b64_tr_b16 a[236:237], v14 offset:40960
  v_mfma_f32_32x32x16_bf16 v[128:143], a[244:247], v[208:211], v[128:143]
  buffer_load_dwordx4 v5, s[20:23], s55 offen offset:3072  lds
  ds_read_b64_tr_b16 a[238:239], v14 offset:43008
  s_waitcnt lgkmcnt(10)
  v_mfma_f32_32x32x16_bf16 v[144:159], a[248:251], v[208:211], v[144:159]
  ds_read_b64_tr_b16 a[240:241], v15 offset:40960
  ds_read_b64_tr_b16 a[242:243], v15 offset:43008
  ds_read_b64_tr_b16 a[244:245], v13 offset:41216
  v_mfma_f32_32x32x16_bf16 v[160:175], a[252:255], v[208:211], v[160:175]
  s_add_u32 m0, s42, 4096
  s_add_u32 s55, s40, 1638400
  buffer_load_dwordx4 v2, s[20:23], s55 offen offset:0  lds
  ds_read_b64_tr_b16 a[246:247], v13 offset:43264
  s_waitcnt lgkmcnt(10)
  v_mfma_f32_32x32x16_bf16 v[48:63], a[224:227], v[216:219], v[48:63]
  ds_read_b64_tr_b16 a[248:249], v14 offset:41216
  ds_read_b64_tr_b16 a[250:251], v14 offset:43264
  ds_read_b64_tr_b16 a[252:253], v15 offset:41216
  v_mfma_f32_32x32x16_bf16 v[176:191], a[224:227], v[220:223], v[176:191]
  buffer_load_dwordx4 v3, s[20:23], s55 offen offset:1024  lds
  ds_read_b64_tr_b16 a[254:255], v15 offset:43264
  s_waitcnt lgkmcnt(12)
  v_mfma_f32_32x32x16_bf16 v[112:127], a[228:231], v[216:219], v[112:127]
  ds_read_b128 v[224:227], v18 offset:20480
  ds_read_b64_tr_b16 a[224:225], v12 offset:49152
  v_mfma_f32_32x32x16_bf16 v[192:207], a[228:231], v[220:223], v[192:207]
  buffer_load_dwordx4 v4, s[20:23], s55 offen offset:2048  lds
  s_waitcnt lgkmcnt(10)
  v_mfma_f32_32x32x16_bf16 v[64:79], a[232:235], v[216:219], v[64:79]
  buffer_load_dwordx4 a[44:47], v11, s[12:15], s56 offen offset:3328 nt
  ds_read_b64_tr_b16 a[226:227], v12 offset:51200
  ds_read_b128 v[228:231], v22 offset:20480
  ds_read_b64_tr_b16 a[228:229], v12 offset:49408
  v_mfma_f32_32x32x16_bf16 v[80:95], a[236:239], v[216:219], v[80:95]
  buffer_load_dwordx4 v5, s[20:23], s55 offen offset:3072  lds
  ds_read_b64_tr_b16 a[230:231], v12 offset:51456
  s_waitcnt lgkmcnt(10)
  v_mfma_f32_32x32x16_bf16 v[96:111], a[240:243], v[216:219], v[96:111]
  ds_read_b64_tr_b16 a[232:233], v13 offset:49152
  ds_read_b64_tr_b16 a[234:235], v13 offset:51200
  ds_read_b64_tr_b16 a[236:237], v14 offset:49152
  v_mfma_f32_32x32x16_bf16 v[128:143], a[244:247], v[216:219], v[128:143]
  s_add_u32 m0, s43, 98304
  s_add_u32 s55, s41, 384
  buffer_load_dwordx4 v6, s[8:11], s55 offen  lds
  ds_read_b64_tr_b16 a[238:239], v14 offset:51200
  s_waitcnt lgkmcnt(10)
  v_mfma_f32_32x32x16_bf16 v[144:159], a[248:251], v[216:219], v[144:159]
  ds_read_b64_tr_b16 a[240:241], v15 offset:49152
  ds_read_b64_tr_b16 a[242:243], v15 offset:51200
  ds_read_b64_tr_b16 a[244:245], v13 offset:49408
  v_mfma_f32_32x32x16_bf16 v[160:175], a[252:255], v[216:219], v[160:175]
  s_add_u32 m0, s43, 102400
  s_add_u32 s55, s41, 29056
  buffer_load_dwordx4 v6, s[8:11], s55 offen  lds
  ds_read_b64_tr_b16 a[246:247], v13 offset:51456
  s_waitcnt lgkmcnt(10)
  v_mfma_f32_32x32x16_bf16 v[48:63], a[224:227], v[224:227], v[48:63]
  s_xor_b32 s56, s44, 32768
  buffer_load_dwordx4 a[16:19], v8, s[12:15], s56 offen offset:0 nt
  ds_read_b64_tr_b16 a[248:249], v14 offset:49408
  ds_read_b64_tr_b16 a[250:251], v14 offset:51456
  ds_read_b64_tr_b16 a[252:253], v15 offset:49408
  v_mfma_f32_32x32x16_bf16 v[176:191], a[224:227], v[228:231], v[176:191]
  s_add_u32 m0, s43, 106496
  s_add_u32 s55, s41, 57728
  buffer_load_dwordx4 v6, s[8:11], s55 offen  lds
  ds_read_b64_tr_b16 a[254:255], v15 offset:51456
  s_waitcnt lgkmcnt(12)
  v_mfma_f32_32x32x16_bf16 v[112:127], a[228:231], v[224:227], v[112:127]
  ds_read_b128 v[232:235], v19 offset:20480
  ds_read_b64_tr_b16 a[224:225], v12 offset:57344
  v_mfma_f32_32x32x16_bf16 v[192:207], a[228:231], v[228:231], v[192:207]
  s_add_u32 m0, s43, 110592
  s_add_u32 s55, s41, 86400
  buffer_load_dwordx4 v6, s[8:11], s55 offen  lds
  s_waitcnt lgkmcnt(10)
  v_mfma_f32_32x32x16_bf16 v[64:79], a[232:235], v[224:227], v[64:79]
  ds_read_b64_tr_b16 a[226:227], v12 offset:59392
  ds_read_b128 v[236:239], v23 offset:20480
  ds_read_b64_tr_b16 a[228:229], v12 offset:57600
  v_mfma_f32_32x32x16_bf16 v[80:95], a[236:239], v[224:227], v[80:95]
  s_add_u32 m0, s43, 114688
  s_add_u32 s55, s41, 115072
  buffer_load_dwordx4 v6, s[8:11], s55 offen  lds
  ds_read_b64_tr_b16 a[230:231], v12 offset:59648
  s_waitcnt lgkmcnt(10)
  v_mfma_f32_32x32x16_bf16 v[96:111], a[240:243], v[224:227], v[96:111]
  ds_read_b64_tr_b16 a[232:233], v13 offset:57344
  ds_read_b64_tr_b16 a[234:235], v13 offset:59392
  ds_read_b64_tr_b16 a[236:237], v14 offset:57344
  v_add_u32 v12, 65536, v12
  v_mfma_f32_32x32x16_bf16 v[128:143], a[244:247], v[224:227], v[128:143]
  ds_read_b64_tr_b16 a[238:239], v14 offset:59392
  s_waitcnt lgkmcnt(10)
  v_mfma_f32_32x32x16_bf16 v[144:159], a[248:251], v[224:227], v[144:159]
  ds_read_b64_tr_b16 a[240:241], v15 offset:57344
  ds_read_b64_tr_b16 a[242:243], v15 offset:59392
  ds_read_b64_tr_b16 a[244:245], v13 offset:57600
  buffer_load_dwordx4 a[48:51], v8, s[12:15], s56 offen offset:256 nt
  v_mfma_f32_32x32x16_bf16 v[160:175], a[252:255], v[224:227], v[160:175]
  ds_read_b64_tr_b16 a[246:247], v13 offset:59648
  v_add_u32 v13, 65536, v13
  s_waitcnt lgkmcnt(10)
  v_mfma_f32_32x32x16_bf16 v[48:63], a[224:227], v[232:235], v[48:63]
  ds_read_b64_tr_b16 a[248:249], v14 offset:57600
  ds_read_b64_tr_b16 a[250:251], v14 offset:59648
  ds_read_b64_tr_b16 a[252:253], v15 offset:57600
  v_add_u32 v14, 65536, v14
  v_mfma_f32_32x32x16_bf16 v[176:191], a[224:227], v[236:239], v[176:191]
  ds_read_b64_tr_b16 a[254:255], v15 offset:59648
  s_waitcnt vmcnt(19)
  s_barrier
L_RA2:
  v_add_u32 v15, 65536, v15
  s_waitcnt lgkmcnt(12)
  v_mfma_f32_32x32x16_bf16 v[112:127], a[228:231], v[232:235], v[112:127]
  ds_read_b128 v[208:211], v16 offset:40960
  ds_read_b64_tr_b16 a[224:225], v12 offset:0
  buffer_atomic_add v246, v244, s[64:67], 0 offen sc1
  v_mfma_f32_32x32x16_bf16 v[192:207], a[228:231], v[236:239], v[192:207]
  s_waitcnt lgkmcnt(10)
  v_mfma_f32_32x32x16_bf16 v[64:79], a[232:235], v[232:235], v[64:79]
  ds_read_b64_tr_b16 a[226:227], v12 offset:2048
  ds_read_b128 v[212:215], v20 offset:40960
  ds_read_b64_tr_b16 a[228:229], v12 offset:256
  v_mfma_f32_32x32x16_bf16 v[80:95], a[236:239], v[232:235], v[80:95]
  ds_read_b64_tr_b16 a[230:231], v12 offset:2304
  s_waitcnt lgkmcnt(10)
  v_mfma_f32_32x32x16_bf16 v[96:111], a[240:243], v[232:235], v[96:111]
  buffer_load_dwordx4 a[20:23], v9, s[12:15], s56 offen offset:1024 nt
  ds_read_b64_tr_b16 a[232:233], v13 offset:0
  ds_read_b64_tr_b16 a[234:235], v13 offset:2048
  ds_read_b64_tr_b16 a[236:237], v14 offset:0
  v_mfma_f32_32x32x16_bf16 v[128:143], a[244:247], v[232:235], v[128:143]
  ds_read_b64_tr_b16 a[238:239], v14 offset:2048
  s_waitcnt lgkmcnt(10)
  v_mfma_f32_32x32x16_bf16 v[144:159], a[248:251], v[232:235], v[144:159]
  ds_read_b64_tr_b16 a[240:241], v15 offset:0
  ds_read_b64_tr_b16 a[242:243], v15 offset:2048
  ds_read_b64_tr_b16 a[244:245], v13 offset:256
  v_mfma_f32_32x32x16_bf16 v[160:175], a[252:255], v[232:235], v[160:175]
  ds_read_b64_tr_b16 a[246:247], v13 offset:2304
  s_waitcnt lgkmcnt(10)
  v_mfma_f32_32x32x16_bf16 v[48:63], a[224:227], v[208:211], v[48:63]
  s_barrier
  ds_read_b64_tr_b16 a[248:249], v14 offset:256
  ds_read_b64_tr_b16 a[250:251], v14 offset:2304
  ds_read_b64_tr_b16 a[252:253], v15 offset:256
  v_mfma_f32_32x32x16_bf16 v[176:191], a[224:227], v[212:215], v[176:191]
  s_add_u32 m0, s42, 32768
  s_add_u32 s55, s40, 2097152
  buffer_load_dwordx4 v2, s[20:23], s55 offen offset:0  lds
  ds_read_b64_tr_b16 a[254:255], v15 offset:2304
  s_waitcnt lgkmcnt(12)
  v_mfma_f32_32x32x16_bf16 v[112:127], a[228:231], v[208:211], v[112:127]
  ds_read_b128 v[216:219], v17 offset:40960
  ds_read_b64_tr_b16 a[224:225], v12 offset:8192
  v_mfma_f32_32x32x16_bf16 v[192:207], a[228:231], v[212:215], v[192:207]
  buffer_load_dwordx4 v3, s[20:23], s55 offen offset:1024  lds
  s_waitcnt lgkmcnt(10)
  v_mfma_f32_32x32x16_bf16 v[64:79], a[232:235], v[208:211], v[64:79]
  buffer_load_dwordx4 a[52:55], v9, s[12:15], s56 offen offset:1280 nt
  ds_read_b64_tr_b16 a[226:227], v12 offset:10240
  ds_read_b128 v[220:223], v21 offset:40960
  ds_read_b64_tr_b16 a[228:229], v12 offset:8448
  v_mfma_f32_32x32x16_bf16 v[80:95], a[236:239], v[208:211], v[80:95]
  buffer_load_dwordx4 v4, s[20:23], s55 offen offset:2048  lds
  ds_read_b64_tr_b16 a[230:231], v12 offset:10496
  s_waitcnt lgkmcnt(10)
  v_mfma_f32_32x32x16_bf16 v[96:111], a[240:243], v[208:211], v[96:111]
  ds_read_b64_tr_b16 a[232:233], v13 offset:8192
  ds_read_b64_tr_b16 a[234:235], v13 offset:10240
  ds_read_b64_tr_b16 a[236:237], v14 offset:8192
  v_mfma_f32_32x32x16_bf16 v[128:143], a[244:247], v[208:211], v[128:143]
  buffer_load_dwordx4 v5, s[20:23], s55 offen offset:3072  lds
  ds_read_b64_tr_b16 a[238:239], v14 offset:10240
  s_waitcnt lgkmcnt(10)
  v_mfma_f32_32x32x16_bf16 v[144:159], a[248:251], v[208:211], v[144:159]
  ds_read_b64_tr_b16 a[240:241], v15 offset:8192
  ds_read_b64_tr_b16 a[242:243], v15 offset:10240
  ds_read_b64_tr_b16 a[244:245], v13 offset:8448
  v_mfma_f32_32x32x16_bf16 v[160:175], a[252:255], v[208:211], v[160:175]
  s_add_u32 m0, s42, 36864
  s_add_u32 s55, s40, 2162688
  buffer_load_dwordx4 v2, s[20:23], s55 offen offset:0  lds
  ds_read_b64_tr_b16 a[246:247], v13 offset:10496
  s_waitcnt lgkmcnt(10)
  v_mfma_f32_32x32x16_bf16 v[48:63], a[224:227], v[216:219], v[48:63]
  ds_read_b64_tr_b16 a[248:249], v14 offset:8448
  ds_read_b64_tr_b16 a[250:251], v14 offset:10496
  ds_read_b64_tr_b16 a[252:253], v15 offset:8448
  v_mfma_f32_32x32x16_bf16 v[176:191], a[224:227], v[220:223], v[176:191]
  buffer_load_dwordx4 v3, s[20:23], s55 offen offset:1024  lds
  ds_read_b64_tr_b16 a[254:255], v15 offset:10496
  s_waitcnt lgkmcnt(12)
  v_mfma_f32_32x32x16_bf16 v[112:127], a[228:231], v[216:219], v[112:127]
  buffer_load_dwordx4 a[24:27], v10, s[12:15], s56 offen offset:2048 nt
  ds_read_b128 v[224:227], v18 offset:40960
  ds_read_b64_tr_b16 a[224:225], v12 offset:16384
  v_mfma_f32_32x32x16_bf16 v[192:207], a[228:231], v[220:223], v[192:207]
  buffer_load_dwordx4 v4, s[20:23], s55 offen offset:2048  lds
  s_waitcnt lgkmcnt(10)
  v_mfma_f32_32x32x16_bf16 v[64:79], a[232:235], v[216:219], v[64:79]
  ds_read_b64_tr_b16 a[226:227], v12 offset:18432
  ds_read_b128 v[228:231], v22 offset:40960
  ds_read_b64_tr_b16 a[228:229], v12 offset:16640
  v_mfma_f32_32x32x16_bf16 v[80:95], a[236:239], v[216:219], v[80:95]
  buffer_load_dwordx4 v5, s[20:23], s55 offen offset:3072  lds
  ds_read_b64_tr_b16 a[230:231], v12 offset:18688
  s_waitcnt lgkmcnt(10)
  v_mfma_f32_32x32x16_bf16 v[96:111], a[240:243], v[216:219], v[96:111]
  ds_read_b64_tr_b16 a[232:233], v13 offset:16384
  ds_read_b64_tr_b16 a[234:235], v13 offset:18432
  ds_read_b64_tr_b16 a[236:237], v14 offset:16384
  v_mfma_f32_32x32x16_bf16 v[128:143], a[244:247], v[216:219], v[128:143]
  s_add_u32 m0, s43, 118784
  s_add_u32 s55, s41, 512
  buffer_load_dwordx4 v6, s[8:11], s55 offen  lds
  ds_read_b64_tr_b16 a[238:239], v14 offset:18432
  s_waitcnt lgkmcnt(10)
  v_mfma_f32_32x32x16_bf16 v[144:159], a[248:251], v[216:219], v[144:159]
  buffer_load_dwordx4 a[56:59], v10, s[12:15], s56 offen offset:2304 nt
  ds_read_b64_tr_b16 a[240:241], v15 offset:16384
  ds_read_b64_tr_b16 a[242:243], v15 offset:18432
  ds_read_b64_tr_b16 a[244:245], v13 offset:16640
  v_mfma_f32_32x32x16_bf16 v[160:175], a[252:255], v[216:219], v[160:175]
  s_add_u32 m0, s43, 122880
  s_add_u32 s55, s41, 29184
  buffer_load_dwordx4 v6, s[8:11], s55 offen  lds
  ds_read_b64_tr_b16 a[246:247], v13 offset:18688
  s_waitcnt lgkmcnt(10)
  v_mfma_f32_32x32x16_bf16 v[48:63], a[224:227], v[224:227], v[48:63]
  ds_read_b64_tr_b16 a[248:249], v14 offset:16640
  ds_read_b64_tr_b16 a[250:251], v14 offset:18688
  ds_read_b64_tr_b16 a[252:253], v15 offset:16640
  v_mfma_f32_32x32x16_bf16 v[176:191], a[224:227], v[228:231], v[176:191]
  s_add_u32 m0, s43, 126976
  s_add_u32 s55, s41, 57856
  buffer_load_dwordx4 v6, s[8:11], s55 offen  lds
  ds_read_b64_tr_b16 a[254:255], v15 offset:18688
  s_waitcnt lgkmcnt(12)
  v_mfma_f32_32x32x16_bf16 v[112:127], a[228:231], v[224:227], v[112:127]
  ds_read_b128 v[232:235], v19 offset:40960
  ds_read_b64_tr_b16 a[224:225], v12 offset:24576
  v_mfma_f32_32x32x16_bf16 v[192:207], a[228:231], v[228:231], v[192:207]
  s_add_u32 m0, s43, 131072
  s_add_u32 s55, s41, 86528
  buffer_load_dwordx4 v6, s[8:11], s55 offen  lds
  s_waitcnt lgkmcnt(10)
  v_mfma_f32_32x32x16_bf16 v[64:79], a[232:235], v[224:227], v[64:79]
  ds_read_b64_tr_b16 a[226:227], v12 offset:26624
  ds_read_b128 v[236:239], v23 offset:40960
  ds_read_b64_tr_b16 a[228:229], v12 offset:24832
  v_mfma_f32_32x32x16_bf16 v[80:95], a[236:239], v[224:227], v[80:95]
  s_add_u32 m0, s43, 135168
  s_add_u32 s55, s41, 115200
  buffer_load_dwordx4 v6, s[8:11], s55 offen  lds
  ds_read_b64_tr_b16 a[230:231], v12 offset:26880
  s_waitcnt lgkmcnt(10)
  v_mfma_f32_32x32x16_bf16 v[96:111], a[240:243], v[224:227], v[96:111]
  ds_read_b64_tr_b16 a[232:233], v13 offset:24576
  ds_read_b64_tr_b16 a[234:235], v13 offset:26624
  ds_read_b64_tr_b16 a[236:237], v14 offset:24576
  buffer_load_dwordx4 a[28:31], v11, s[12:15], s56 offen offset:3072 nt
  v_mfma_f32_32x32x16_bf16 v[128:143], a[244:247], v[224:227], v[128:143]
  ds_read_b64_tr_b16 a[238:239], v14 offset:26624
  v_subrev_u32 v12, 65536, v12
  s_waitcnt lgkmcnt(10)
  v_mfma_f32_32x32x16_bf16 v[144:159], a[248:251], v[224:227], v[144:159]
  ds_read_b64_tr_b16 a[240:241], v15 offset:24576
  ds_read_b64_tr_b16 a[242:243], v15 offset:26624
  ds_read_b64_tr_b16 a[244:245], v13 offset:24832
  v_mfma_f32_32x32x16_bf16 v[160:175], a[252:255], v[224:227], v[160:175]
  ds_read_b64_tr_b16 a[246:247], v13 offset:26880
  v_subrev_u32 v13, 65536, v13
  s_waitcnt lgkmcnt(10)
  v_mfma_f32_32x32x16_bf16 v[48:63], a[224:227], v[232:235], v[48:63]
  ds_read_b64_tr_b16 a[248:249], v14 offset:24832
  ds_read_b64_tr_b16 a[250:251], v14 offset:26880
  ds_read_b64_tr_b16 a[252:253], v15 offset:24832
  v_subrev_u32 v14, 65536, v14
  v_mfma_f32_32x32x16_bf16 v[176:191], a[224:227], v[236:239], v[176:191]
  ds_read_b64_tr_b16 a[254:255], v15 offset:26880
  s_waitcnt vmcnt(20)
  s_barrier
L_RA3:
  v_subrev_u32 v15, 65536, v15
  s_waitcnt lgkmcnt(12)
  v_mfma_f32_32x32x16_bf16 v[112:127], a[228:231], v[232:235], v[112:127]
  ds_read_b128 v[208:211], v16 offset:0
  ds_read_b64_tr_b16 a[224:225], v12 offset:0
  v_mfma_f32_32x32x16_bf16 v[192:207], a[228:231], v[236:239], v[192:207]
  buffer_load_dwordx4 a[60:63], v11, s[12:15], s56 offen offset:3328 nt
  s_waitcnt lgkmcnt(10)
  v_mfma_f32_32x32x16_bf16 v[64:79], a[232:235], v[232:235], v[64:79]
  ds_read_b64_tr_b16 a[226:227], v12 offset:2048
  ds_read_b128 v[212:215], v20 offset:0
  ds_read_b64_tr_b16 a[228:229], v12 offset:256
  v_mfma_f32_32x32x16_bf16 v[80:95], a[236:239], v[232:235], v[80:95]
  ds_read_b64_tr_b16 a[230:231], v12 offset:2304
  s_waitcnt lgkmcnt(10)
  v_mfma_f32_32x32x16_bf16 v[96:111], a[240:243], v[232:235], v[96:111]
  ds_read_b64_tr_b16 a[232:233], v13 offset:0
  ds_read_b64_tr_b16 a[234:235], v13 offset:2048
  ds_read_b64_tr_b16 a[236:237], v14 offset:0
  v_mfma_f32_32x32x16_bf16 v[128:143], a[244:247], v[232:235], v[128:143]
  ds_read_b64_tr_b16 a[238:239], v14 offset:2048
  s_waitcnt lgkmcnt(10)
  v_mfma_f32_32x32x16_bf16 v[144:159], a[248:251], v[232:235], v[144:159]
  ds_read_b64_tr_b16 a[240:241], v15 offset:0
  ds_read_b64_tr_b16 a[242:243], v15 offset:2048
  ds_read_b64_tr_b16 a[244:245], v13 offset:256
  v_mfma_f32_32x32x16_bf16 v[160:175], a[252:255], v[232:235], v[160:175]
  ds_read_b64_tr_b16 a[246:247], v13 offset:2304
  s_waitcnt lgkmcnt(10)
  v_mfma_f32_32x32x16_bf16 v[48:63], a[224:227], v[208:211], v[48:63]
  s_barrier
  ds_read_b64_tr_b16 a[248:249], v14 offset:256
  ds_read_b64_tr_b16 a[250:251], v14 offset:2304
  ds_read_b64_tr_b16 a[252:253], v15 offset:256
  v_mfma_f32_32x32x16_bf16 v[176:191], a[224:227], v[212:215], v[176:191]
  s_add_u32 m0, s42, 65536
  s_add_u32 s55, s40, 2621440
  buffer_load_dwordx4 v2, s[20:23], s55 offen offset:0  lds
  ds_read_b64_tr_b16 a[254:255], v15 offset:2304
  s_waitcnt lgkmcnt(12)
  v_mfma_f32_32x32x16_bf16 v[112:127], a[228:231], v[208:211], v[112:127]
  s_xor_b32 s56, s44, 65536
  buffer_load_dwordx4 a[64:67], v8, s[12:15], s56 offen offset:0 nt
  s_lshl_b32 s98, s32, 12
  s_add_u32 s98, s98, L_RS1-L_pc+0
  v_lshlrev_b32 v242, 6, v0
  v_add_u32 v242, s98, v242
  v_min_u32 v242, s95, v242
  v_mfma_f32_32x32x16_bf16 v[192:207], a[228:231], v[212:215], v[192:207]
  buffer_load_dwordx4 v3, s[20:23], s55 offen offset:1024  lds
  v_mov_b32 v243, s97
  v_add_co_u32 v242, s[98:99], s96, v242
  s_nop 1
  v_addc_co_u32 v243, s[98:99], 0, v243, s[98:99]
  ds_read_b128 v[216:219], v17 offset:0
  ds_read_b64_tr_b16 a[224:225], v12 offset:8192
  s_waitcnt lgkmcnt(10)
  v_mfma_f32_32x32x16_bf16 v[64:79], a[232:235], v[208:211], v[64:79]
  ds_read_b64_tr_b16 a[226:227], v12 offset:10240
  global_load_dword v242, v[242:243], off
  ds_read_b128 v[220:223], v21 offset:0
  ds_read_b64_tr_b16 a[228:229], v12 offset:8448
  v_mfma_f32_32x32x16_bf16 v[80:95], a[236:239], v[208:211], v[80:95]
  buffer_load_dwordx4 v4, s[20:23], s55 offen offset:2048  lds
  ds_read_b64_tr_b16 a[230:231], v12 offset:10496
  s_waitcnt lgkmcnt(10)
  v_mfma_f32_32x32x16_bf16 v[96:111], a[240:243], v[208:211], v[96:111]
  ds_read_b64_tr_b16 a[232:233], v13 offset:8192
  ds_read_b64_tr_b16 a[234:235], v13 offset:10240
  ds_read_b64_tr_b16 a[236:237], v14 offset:8192
  v_mfma_f32_32x32x16_bf16 v[128:143], a[244:247], v[208:211], v[128:143]
  buffer_load_dwordx4 v5, s[20:23], s55 offen offset:3072  lds
  ds_read_b64_tr_b16 a[238:239], v14 offset:10240
  s_waitcnt lgkmcnt(10)
  v_mfma_f32_32x32x16_bf16 v[144:159], a[248:251], v[208:211], v[144:159]
  ds_read_b64_tr_b16 a[240:241], v15 offset:8192
  ds_read_b64_tr_b16 a[242:243], v15 offset:10240
  ds_read_b64_tr_b16 a[244:245], v13 offset:8448
  v_mfma_f32_32x32x16_bf16 v[160:175], a[252:255], v[208:211], v[160:175]
  s_add_u32 m0, s42, 69632
  s_add_u32 s55, s40, 2686976
  buffer_load_dwordx4 v2, s[20:23], s55 offen offset:0  lds
  ds_read_b64_tr_b16 a[246:247], v13 offset:10496
  s_waitcnt lgkmcnt(10)
  v_mfma_f32_32x32x16_bf16 v[48:63], a[224:227], v[216:219], v[48:63]
  buffer_load_dwordx4 a[96:99], v8, s[12:15], s56 offen offset:256 nt
  ds_read_b64_tr_b16 a[248:249], v14 offset:8448
  ds_read_b64_tr_b16 a[250:251], v14 offset:10496
  ds_read_b64_tr_b16 a[252:253], v15 offset:8448
  v_mfma_f32_32x32x16_bf16 v[176:191], a[224:227], v[220:223], v[176:191]
  buffer_load_dwordx4 v3, s[20:23], s55 offen offset:1024  lds
  ds_read_b64_tr_b16 a[254:255], v15 offset:10496
  s_waitcnt lgkmcnt(12)
  v_mfma_f32_32x32x16_bf16 v[112:127], a[228:231], v[216:219], v[112:127]
  ds_read_b128 v[224:227], v18 offset:0
  ds_read_b64_tr_b16 a[224:225], v12 offset:16384
  v_mfma_f32_32x32x16_bf16 v[192:207], a[228:231], v[220:223], v[192:207]
  buffer_load_dwordx4 v4, s[20:23], s55 offen offset:2048  lds
  s_waitcnt lgkmcnt(10)
  v_mfma_f32_32x32x16_bf16 v[64:79], a[232:235], v[216:219], v[64:79]
  ds_read_b64_tr_b16 a[226:227], v12 offset:18432
  ds_read_b128 v[228:231], v22 offset:0
  ds_read_b64_tr_b16 a[228:229], v12 offset:16640
  v_mfma_f32_32x32x16_bf16 v[80:95], a[236:239], v[216:219], v[80:95]
  buffer_load_dwordx4 v5, s[20:23], s55 offen offset:3072  lds
  ds_read_b64_tr_b16 a[230:231], v12 offset:18688
  s_waitcnt lgkmcnt(10)
  v_mfma_f32_32x32x16_bf16 v[96:111], a[240:243], v[216:219], v[96:111]
  buffer_load_dwordx4 a[68:71], v9, s[12:15], s56 offen offset:1024 nt
  ds_read_b64_tr_b16 a[232:233], v13 offset:16384
  ds_read_b64_tr_b16 a[234:235], v13 offset:18432
  ds_read_b64_tr_b16 a[236:237], v14 offset:16384
  v_mfma_f32_32x32x16_bf16 v[128:143], a[244:247], v[216:219], v[128:143]
  s_add_u32 m0, s43, 139264
  s_add_u32 s55, s41, 640
  buffer_load_dwordx4 v6, s[8:11], s55 offen  lds
  ds_read_b64_tr_b16 a[238:239], v14 offset:18432
  s_waitcnt lgkmcnt(10)
  v_mfma_f32_32x32x16_bf16 v[144:159], a[248:251], v[216:219], v[144:159]
  ds_read_b64_tr_b16 a[240:241], v15 offset:16384
  ds_read_b64_tr_b16 a[242:243], v15 offset:18432
  ds_read_b64_tr_b16 a[244:245], v13 offset:16640
  v_mfma_f32_32x32x16_bf16 v[160:175], a[252:255], v[216:219], v[160:175]
  s_add_u32 m0, s43, 143360
  s_add_u32 s55, s41, 29312
  buffer_load_dwordx4 v6, s[8:11], s55 offen  lds
  ds_read_b64_tr_b16 a[246:247], v13 offset:18688
  s_waitcnt lgkmcnt(10)
  v_mfma_f32_32x32x16_bf16 v[48:63], a[224:227], v[224:227], v[48:63]
  ds_read_b64_tr_b16 a[248:249], v14 offset:16640
  ds_read_b64_tr_b16 a[250:251], v14 offset:18688
  ds_read_b64_tr_b16 a[252:253], v15 offset:16640
  v_mfma_f32_32x32x16_bf16 v[176:191], a[224:227], v[228:231], v[176:191]
  s_add_u32 m0, s43, 147456
  s_add_u32 s55, s41, 57984
  buffer_load_dwordx4 v6, s[8:11], s55 offen  lds
  ds_read_b64_tr_b16 a[254:255], v15 offset:18688
  s_waitcnt lgkmcnt(12)
  v_mfma_f32_32x32x16_bf16 v[112:127], a[228:231], v[224:227], v[112:127]
  ds_read_b128 v[232:235], v19 offset:0
  ds_read_b64_tr_b16 a[224:225], v12 offset:24576
  v_mfma_f32_32x32x16_bf16 v[192:207], a[228:231], v[228:231], v[192:207]
  s_add_u32 m0, s43, 151552
  s_add_u32 s55, s41, 86656
  buffer_load_dwordx4 v6, s[8:11], s55 offen  lds
  s_waitcnt lgkmcnt(10)
  v_mfma_f32_32x32x16_bf16 v[64:79], a[232:235], v[224:227], v[64:79]
  buffer_load_dwordx4 a[100:103], v9, s[12:15], s56 offen offset:1280 nt
  ds_read_b64_tr_b16 a[226:227], v12 offset:26624
  ds_read_b128 v[236:239], v23 offset:0
  ds_read_b64_tr_b16 a[228:229], v12 offset:24832
  v_mfma_f32_32x32x16_bf16 v[80:95], a[236:239], v[224:227], v[80:95]
  s_add_u32 m0, s43, 155648
  s_add_u32 s55, s41, 115328
  buffer_load_dwordx4 v6, s[8:11], s55 offen  lds
  ds_read_b64_tr_b16 a[230:231], v12 offset:26880
  s_waitcnt lgkmcnt(10)
  v_mfma_f32_32x32x16_bf16 v[96:111], a[240:243], v[224:227], v[96:111]
  ds_read_b64_tr_b16 a[232:233], v13 offset:24576
  ds_read_b64_tr_b16 a[234:235], v13 offset:26624
  ds_read_b64_tr_b16 a[236:237], v14 offset:24576
  v_mfma_f32_32x32x16_bf16 v[128:143], a[244:247], v[224:227], v[128:143]
  ds_read_b64_tr_b16 a[238:239], v14 offset:26624
  s_waitcnt lgkmcnt(10)
  v_mfma_f32_32x32x16_bf16 v[144:159], a[248:251], v[224:227], v[144:159]
  ds_read_b64_tr_b16 a[240:241], v15 offset:24576
  ds_read_b64_tr_b16 a[242:243], v15 offset:26624
  ds_read_b64_tr_b16 a[244:245], v13 offset:24832
  v_mfma_f32_32x32x16_bf16 v[160:175], a[252:255], v[224:227], v[160:175]
  ds_read_b64_tr_b16 a[246:247], v13 offset:26880
  s_waitcnt lgkmcnt(10)
  v_mfma_f32_32x32x16_bf16 v[48:63], a[224:227], v[232:235], v[48:63]
  ds_read_b64_tr_b16 a[248:249], v14 offset:24832
  ds_read_b64_tr_b16 a[250:251], v14 offset:26880
  ds_read_b64_tr_b16 a[252:253], v15 offset:24832
  v_mfma_f32_32x32x16_bf16 v[176:191], a[224:227], v[236:239], v[176:191]
  ds_read_b64_tr_b16 a[254:255], v15 offset:26880
  buffer_load_dwordx4 a[72:75], v10, s[12:15], s56 offen offset:2048 nt
  s_waitcnt vmcnt(21)
  s_barrier
L_RA4:
  s_waitcnt lgkmcnt(12)
  v_mfma_f32_32x32x16_bf16 v[112:127], a[228:231], v[232:235], v[112:127]
  ds_read_b128 v[208:211], v16 offset:20480
  ds_read_b64_tr_b16 a[224:225], v12 offset:32768
  v_mfma_f32_32x32x16_bf16 v[192:207], a[228:231], v[236:239], v[192:207]
  s_waitcnt lgkmcnt(10)
  v_mfma_f32_32x32x16_bf16 v[64:79], a[232:235], v[232:235], v[64:79]
  ds_read_b64_tr_b16 a[226:227], v12 offset:34816
  ds_read_b128 v[212:215], v20 offset:20480
  ds_read_b64_tr_b16 a[228:229], v12 offset:33024
  v_mfma_f32_32x32x16_bf16 v[80:95], a[236:239], v[232:235], v[80:95]
  ds_read_b64_tr_b16 a[230:231], v12 offset:35072
  s_waitcnt lgkmcnt(10)
  v_mfma_f32_32x32x16_bf16 v[96:111], a[240:243], v[232:235], v[96:111]
  ds_read_b64_tr_b16 a[232:233], v13 offset:32768
  ds_read_b64_tr_b16 a[234:235], v13 offset:34816
  ds_read_b64_tr_b16 a[236:237], v14 offset:32768
  v_mfma_f32_32x32x16_bf16 v[128:143], a[244:247], v[232:235], v[128:143]
  ds_read_b64_tr_b16 a[238:239], v14 offset:34816
  s_waitcnt lgkmcnt(10)
  v_mfma_f32_32x32x16_bf16 v[144:159], a[248:251], v[232:235], v[144:159]
  ds_read_b64_tr_b16 a[240:241], v15 offset:32768
  ds_read_b64_tr_b16 a[242:243], v15 offset:34816
  ds_read_b64_tr_b16 a[244:245], v13 offset:33024
  v_mfma_f32_32x32x16_bf16 v[160:175], a[252:255], v[232:235], v[160:175]
  buffer_load_dwordx4 a[104:107], v10, s[12:15], s56 offen offset:2304 nt
  ds_read_b64_tr_b16 a[246:247], v13 offset:35072
  s_waitcnt lgkmcnt(10)
  v_mfma_f32_32x32x16_bf16 v[48:63], a[224:227], v[208:211], v[48:63]
  s_barrier
  ds_read_b64_tr_b16 a[248:249], v14 offset:33024
  ds_read_b64_tr_b16 a[250:251], v14 offset:35072
  ds_read_b64_tr_b16 a[252:253], v15 offset:33024
  v_mfma_f32_32x32x16_bf16 v[176:191], a[224:227], v[212:215], v[176:191]
  s_add_u32 m0, s42, 0
  s_add_u32 s55, s40, 3145728
  buffer_load_dwordx4 v2, s[20:23], s55 offen offset:0  lds
  s_waitcnt lgkmcnt(11)
  v_mfma_f32_32x32x16_bf16 v[112:127], a[228:231], v[208:211], v[112:127]
  ds_read_b64_tr_b16 a[254:255], v15 offset:35072
  ds_read_b128 v[216:219], v17 offset:20480
  ds_read_b64_tr_b16 a[224:225], v12 offset:40960
  v_mfma_f32_32x32x16_bf16 v[192:207], a[228:231], v[212:215], v[192:207]
  buffer_load_dwordx4 v3, s[20:23], s55 offen offset:1024  lds
  s_waitcnt lgkmcnt(10)
  v_mfma_f32_32x32x16_bf16 v[64:79], a[232:235], v[208:211], v[64:79]
  ds_read_b64_tr_b16 a[226:227], v12 offset:43008
  ds_read_b128 v[220:223], v21 offset:20480
  ds_read_b64_tr_b16 a[228:229], v12 offset:41216
  v_mfma_f32_32x32x16_bf16 v[80:95], a[236:239], v[208:211], v[80:95]
  buffer_load_dwordx4 v4, s[20:23], s55 offen offset:2048  lds
  ds_read_b64_tr_b16 a[230:231], v12 offset:43264
  s_waitcnt lgkmcnt(10)
  v_mfma_f32_32x32x16_bf16 v[96:111], a[240:243], v[208:211], v[96:111]
  ds_read_b64_tr_b16 a[232:233], v13 offset:40960
  ds_read_b64_tr_b16 a[234:235], v13 offset:43008
  ds_read_b64_tr_b16 a[236:237], v14 offset:40960
  v_mfma_f32_32x32x16_bf16 v[128:143], a[244:247], v[208:211], v[128:143]
  buffer_load_dwordx4 v5, s[20:23], s55 offen offset:3072  lds
  ds_read_b64_tr_b16 a[238:239], v14 offset:43008
  s_waitcnt lgkmcnt(10)
  v_mfma_f32_32x32x16_bf16 v[144:159], a[248:251], v[208:211], v[144:159]
  buffer_load_dwordx4 a[76:79], v11, s[12:15], s56 offen offset:3072 nt
  ds_read_b64_tr_b16 a[240:241], v15 offset:40960
  ds_read_b64_tr_b16 a[242:243], v15 offset:43008
  ds_read_b64_tr_b16 a[244:245], v13 offset:41216
  v_mfma_f32_32x32x16_bf16 v[160:175], a[252:255], v[208:211], v[160:175]
  s_add_u32 m0, s42, 4096
  s_add_u32 s55, s40, 3211264
  buffer_load_dwordx4 v2, s[20:23], s55 offen offset:0  lds
  s_waitcnt lgkmcnt(9)
  v_mfma_f32_32x32x16_bf16 v[48:63], a[224:227], v[216:219], v[48:63]
  ds_read_b64_tr_b16 a[246:247], v13 offset:43264
  ds_read_b64_tr_b16 a[248:249], v14 offset:41216
  ds_read_b64_tr_b16 a[250:251], v14 offset:43264
  v_and_b32 v2, 15, v0
  s_lshl_b32 s40, s51, 7
  v_mfma_f32_32x32x16_bf16 v[176:191], a[224:227], v[220:223], v[176:191]
  buffer_load_dwordx4 v3, s[20:23], s55 offen offset:1024  lds
  ds_read_b64_tr_b16 a[252:253], v15 offset:41216
  s_waitcnt lgkmcnt(11)
  v_mfma_f32_32x32x16_bf16 v[112:127], a[228:231], v[216:219], v[112:127]
  ds_read_b64_tr_b16 a[254:255], v15 offset:43264
  ds_read_b128 v[224:227], v18 offset:20480
  ds_read_b64_tr_b16 a[224:225], v12 offset:49152
  v_lshlrev_b32 v3, 2, v42
  v_xor_b32 v2, v2, v3
  v_lshlrev_b32 v2, 4, v2
  v_mfma_f32_32x32x16_bf16 v[192:207], a[228:231], v[220:223], v[192:207]
  buffer_load_dwordx4 v4, s[20:23], s55 offen offset:2048  lds
  v_lshl_add_u32 v2, v42, 9, v2
  s_waitcnt lgkmcnt(10)
  v_mfma_f32_32x32x16_bf16 v[64:79], a[232:235], v[216:219], v[64:79]
  buffer_load_dwordx4 a[108:111], v11, s[12:15], s56 offen offset:3328 nt
  ds_read_b64_tr_b16 a[226:227], v12 offset:51200
  ds_read_b128 v[228:231], v22 offset:20480
  ds_read_b64_tr_b16 a[228:229], v12 offset:49408
  v_mfma_f32_32x32x16_bf16 v[80:95], a[236:239], v[216:219], v[80:95]
  buffer_load_dwordx4 v5, s[20:23], s55 offen offset:3072  lds
  ds_read_b64_tr_b16 a[230:231], v12 offset:51456
  s_waitcnt lgkmcnt(10)
  v_mfma_f32_32x32x16_bf16 v[96:111], a[240:243], v[216:219], v[96:111]
  ds_read_b64_tr_b16 a[232:233], v13 offset:49152
  ds_read_b64_tr_b16 a[234:235], v13 offset:51200
  ds_read_b64_tr_b16 a[236:237], v14 offset:49152
  v_add_u32 v3, 7168, v2
  v_add_u32 v4, 14336, v2
  v_add_u32 v5, 21504, v2
  v_mfma_f32_32x32x16_bf16 v[128:143], a[244:247], v[216:219], v[128:143]
  s_add_u32 m0, s43, 98304
  s_add_u32 s55, s41, 768
  buffer_load_dwordx4 v6, s[8:11], s55 offen  lds
  s_waitcnt lgkmcnt(9)
  v_mfma_f32_32x32x16_bf16 v[144:159], a[248:251], v[216:219], v[144:159]
  ds_read_b64_tr_b16 a[238:239], v14 offset:51200
  ds_read_b64_tr_b16 a[240:241], v15 offset:49152
  ds_read_b64_tr_b16 a[242:243], v15 offset:51200
  v_lshrrev_b32 v42, 4, v0
  v_and_b32 v42, 1, v42
  v_lshlrev_b32 v42, 2, v42
  v_mfma_f32_32x32x16_bf16 v[160:175], a[252:255], v[216:219], v[160:175]
  s_add_u32 m0, s43, 102400
  s_add_u32 s55, s41, 29440
  buffer_load_dwordx4 v6, s[8:11], s55 offen  lds
  s_waitcnt lgkmcnt(8)
  v_mfma_f32_32x32x16_bf16 v[48:63], a[224:227], v[224:227], v[48:63]
  ds_read_b64_tr_b16 a[244:245], v13 offset:49408
  ds_read_b64_tr_b16 a[246:247], v13 offset:51456
  ds_read_b64_tr_b16 a[248:249], v14 offset:49408
  s_lshl_b32 s20, s47, 7
  s_lshl_b32 s21, s48, 7
  s_lshl_b32 s22, s49, 7
  v_mfma_f32_32x32x16_bf16 v[176:191], a[224:227], v[228:231], v[176:191]
  s_add_u32 m0, s43, 106496
  s_add_u32 s55, s41, 58112
  buffer_load_dwordx4 v6, s[8:11], s55 offen  lds
  ds_read_b64_tr_b16 a[250:251], v14 offset:51456
  s_waitcnt lgkmcnt(10)
  v_mfma_f32_32x32x16_bf16 v[112:127], a[228:231], v[224:227], v[112:127]
  s_xor_b32 s56, s44, 98304
  buffer_load_dwordx4 a[80:83], v8, s[12:15], s56 offen offset:0 nt
  ds_read_b64_tr_b16 a[252:253], v15 offset:49408
  ds_read_b64_tr_b16 a[254:255], v15 offset:51456
  v_mfma_f32_32x32x16_bf16 v[192:207], a[228:231], v[228:231], v[192:207]
  s_add_u32 m0, s43, 110592
  s_add_u32 s55, s41, 86784
  buffer_load_dwordx4 v6, s[8:11], s55 offen  lds
  ds_read_b128 v[232:235], v19 offset:20480
  ds_read_b64_tr_b16 a[224:225], v12 offset:57344
  s_waitcnt lgkmcnt(10)
  v_mfma_f32_32x32x16_bf16 v[64:79], a[232:235], v[224:227], v[64:79]
  ds_read_b64_tr_b16 a[226:227], v12 offset:59392
  ds_read_b128 v[236:239], v23 offset:20480
  ds_read_b64_tr_b16 a[228:229], v12 offset:57600
  s_lshl_b32 s23, s50, 7
  v_mfma_f32_32x32x16_bf16 v[80:95], a[236:239], v[224:227], v[80:95]
  s_add_u32 m0, s43, 114688
  s_add_u32 s55, s41, 115456
  buffer_load_dwordx4 v6, s[8:11], s55 offen  lds
  ds_read_b64_tr_b16 a[230:231], v12 offset:59648
  s_waitcnt lgkmcnt(10)
  v_mfma_f32_32x32x16_bf16 v[96:111], a[240:243], v[224:227], v[96:111]
  ds_read_b64_tr_b16 a[232:233], v13 offset:57344
  ds_read_b64_tr_b16 a[234:235], v13 offset:59392
  ds_read_b64_tr_b16 a[236:237], v14 offset:57344
  v_add_u32 v12, 65536, v12
  v_lshlrev_b32 v6, 2, v0
  v_add_u32 v6, 131072, v6
  v_mfma_f32_32x32x16_bf16 v[128:143], a[244:247], v[224:227], v[128:143]
  ds_read_b64_tr_b16 a[238:239], v14 offset:59392
  s_lshl_b32 s41, s52, 7
  s_waitcnt lgkmcnt(10)
  v_mfma_f32_32x32x16_bf16 v[144:159], a[248:251], v[224:227], v[144:159]
  ds_read_b64_tr_b16 a[240:241], v15 offset:57344
  ds_read_b64_tr_b16 a[242:243], v15 offset:59392
  ds_read_b64_tr_b16 a[244:245], v13 offset:57600
  v_mfma_f32_32x32x16_bf16 v[160:175], a[252:255], v[224:227], v[160:175]
  ds_read_b64_tr_b16 a[246:247], v13 offset:59648
  buffer_load_dwordx4 a[112:115], v8, s[12:15], s56 offen offset:256 nt
  v_add_u32 v13, 65536, v13
  s_waitcnt lgkmcnt(10)
  v_mfma_f32_32x32x16_bf16 v[48:63], a[224:227], v[232:235], v[48:63]
  ds_read_b64_tr_b16 a[248:249], v14 offset:57600
  ds_read_b64_tr_b16 a[250:251], v14 offset:59648
  ds_read_b64_tr_b16 a[252:253], v15 offset:57600
  v_add_u32 v14, 65536, v14
  v_mfma_f32_32x32x16_bf16 v[176:191], a[224:227], v[236:239], v[176:191]
  ds_read_b64_tr_b16 a[254:255], v15 offset:59648
  s_waitcnt vmcnt(19)
  s_barrier
L_RA5:
  v_add_u32 v15, 65536, v15
  s_waitcnt lgkmcnt(12)
  v_mfma_f32_32x32x16_bf16 v[112:127], a[228:231], v[232:235], v[112:127]
  ds_read_b128 v[208:211], v16 offset:40960
  ds_read_b64_tr_b16 a[224:225], v12 offset:0
  v_mfma_f32_32x32x16_bf16 v[192:207], a[228:231], v[236:239], v[192:207]
  s_waitcnt lgkmcnt(10)
  v_mfma_f32_32x32x16_bf16 v[64:79], a[232:235], v[232:235], v[64:79]
  ds_read_b64_tr_b16 a[226:227], v12 offset:2048
  ds_read_b128 v[212:215], v20 offset:40960
  ds_read_b64_tr_b16 a[228:229], v12 offset:256
  v_mfma_f32_32x32x16_bf16 v[80:95], a[236:239], v[232:235], v[80:95]
  ds_read_b64_tr_b16 a[230:231], v12 offset:2304
  s_waitcnt lgkmcnt(10)
  v_mfma_f32_32x32x16_bf16 v[96:111], a[240:243], v[232:235], v[96:111]
  ds_read_b64_tr_b16 a[232:233], v13 offset:0
  ds_read_b64_tr_b16 a[234:235], v13 offset:2048
  ds_read_b64_tr_b16 a[236:237], v14 offset:0
  v_mfma_f32_32x32x16_bf16 v[128:143], a[244:247], v[232:235], v[128:143]
  ds_read_b64_tr_b16 a[238:239], v14 offset:2048
  buffer_load_dwordx4 a[84:87], v9, s[12:15], s56 offen offset:1024 nt
  s_waitcnt lgkmcnt(10)
  v_mfma_f32_32x32x16_bf16 v[144:159], a[248:251], v[232:235], v[144:159]
  ds_read_b64_tr_b16 a[240:241], v15 offset:0
  ds_read_b64_tr_b16 a[242:243], v15 offset:2048
  ds_read_b64_tr_b16 a[244:245], v13 offset:256
  v_mfma_f32_32x32x16_bf16 v[160:175], a[252:255], v[232:235], v[160:175]
  ds_read_b64_tr_b16 a[246:247], v13 offset:2304
  s_waitcnt lgkmcnt(10)
  v_mfma_f32_32x32x16_bf16 v[48:63], a[224:227], v[208:211], v[48:63]
  ds_read_b64_tr_b16 a[248:249], v14 offset:256
  ds_read_b64_tr_b16 a[250:251], v14 offset:2304
  s_barrier
  ds_read_b64_tr_b16 a[252:253], v15 offset:256
  v_mfma_f32_32x32x16_bf16 v[176:191], a[224:227], v[212:215], v[176:191]
  ds_read_b64_tr_b16 a[254:255], v15 offset:2304
  s_waitcnt lgkmcnt(12)
  v_mfma_f32_32x32x16_bf16 v[112:127], a[228:231], v[208:211], v[112:127]
  ds_read_b128 v[216:219], v17 offset:40960
  ds_read_b64_tr_b16 a[224:225], v12 offset:8192
  v_mfma_f32_32x32x16_bf16 v[192:207], a[228:231], v[212:215], v[192:207]
  s_waitcnt lgkmcnt(10)
  v_mfma_f32_32x32x16_bf16 v[64:79], a[232:235], v[208:211], v[64:79]
  ds_read_b64_tr_b16 a[226:227], v12 offset:10240
  ds_read_b128 v[220:223], v21 offset:40960
  ds_read_b64_tr_b16 a[228:229], v12 offset:8448
  v_mfma_f32_32x32x16_bf16 v[80:95], a[236:239], v[208:211], v[80:95]
  ds_read_b64_tr_b16 a[230:231], v12 offset:10496
  buffer_load_dwordx4 a[116:119], v9, s[12:15], s56 offen offset:1280 nt
  s_waitcnt lgkmcnt(10)
  v_mfma_f32_32x32x16_bf16 v[96:111], a[240:243], v[208:211], v[96:111]
  ds_read_b64_tr_b16 a[232:233], v13 offset:8192
  ds_read_b64_tr_b16 a[234:235], v13 offset:10240
  ds_read_b64_tr_b16 a[236:237], v14 offset:8192
  v_mfma_f32_32x32x16_bf16 v[128:143], a[244:247], v[208:211], v[128:143]
  ds_read_b64_tr_b16 a[238:239], v14 offset:10240
  s_waitcnt lgkmcnt(10)
  v_mfma_f32_32x32x16_bf16 v[144:159], a[248:251], v[208:211], v[144:159]
  ds_read_b64_tr_b16 a[240:241], v15 offset:8192
  ds_read_b64_tr_b16 a[242:243], v15 offset:10240
  ds_read_b64_tr_b16 a[244:245], v13 offset:8448
  v_mfma_f32_32x32x16_bf16 v[160:175], a[252:255], v[208:211], v[160:175]
  ds_read_b64_tr_b16 a[246:247], v13 offset:10496
  s_waitcnt lgkmcnt(10)
  v_mfma_f32_32x32x16_bf16 v[48:63], a[224:227], v[216:219], v[48:63]
  ds_read_b64_tr_b16 a[248:249], v14 offset:8448
  ds_read_b64_tr_b16 a[250:251], v14 offset:10496
  ds_read_b64_tr_b16 a[252:253], v15 offset:8448
  v_mfma_f32_32x32x16_bf16 v[176:191], a[224:227], v[220:223], v[176:191]
  ds_read_b64_tr_b16 a[254:255], v15 offset:10496
  s_waitcnt lgkmcnt(12)
  v_mfma_f32_32x32x16_bf16 v[112:127], a[228:231], v[216:219], v[112:127]
  ds_read_b128 v[224:227], v18 offset:40960
  ds_read_b64_tr_b16 a[224:225], v12 offset:16384
  buffer_load_dwordx4 a[88:91], v10, s[12:15], s56 offen offset:2048 nt
  v_mfma_f32_32x32x16_bf16 v[192:207], a[228:231], v[220:223], v[192:207]
  s_waitcnt lgkmcnt(10)
  v_mfma_f32_32x32x16_bf16 v[64:79], a[232:235], v[216:219], v[64:79]
  ds_read_b64_tr_b16 a[226:227], v12 offset:18432
  ds_read_b128 v[228:231], v22 offset:40960
  ds_write_b128 v7, a[0:3] offset:0
  v_mfma_f32_32x32x16_bf16 v[80:95], a[236:239], v[216:219], v[80:95]
  ds_read_b64_tr_b16 a[228:229], v12 offset:16640
  s_waitcnt lgkmcnt(10)
  v_mfma_f32_32x32x16_bf16 v[96:111], a[240:243], v[216:219], v[96:111]
  ds_read_b64_tr_b16 a[230:231], v12 offset:18688
  ds_write_b128 v7, a[4:7] offset:1024
  ds_read_b64_tr_b16 a[232:233], v13 offset:16384
  v_mfma_f32_32x32x16_bf16 v[128:143], a[244:247], v[216:219], v[128:143]
  ds_read_b64_tr_b16 a[234:235], v13 offset:18432
  s_waitcnt lgkmcnt(10)
  v_mfma_f32_32x32x16_bf16 v[144:159], a[248:251], v[216:219], v[144:159]
  ds_read_b64_tr_b16 a[236:237], v14 offset:16384
  ds_read_b64_tr_b16 a[238:239], v14 offset:18432
  ds_write_b128 v7, a[8:11] offset:2048
  v_mfma_f32_32x32x16_bf16 v[160:175], a[252:255], v[216:219], v[160:175]
  ds_read_b64_tr_b16 a[240:241], v15 offset:16384
  s_waitcnt lgkmcnt(10)
  v_mfma_f32_32x32x16_bf16 v[48:63], a[224:227], v[224:227], v[48:63]
  ds_read_b64_tr_b16 a[242:243], v15 offset:18432
  ds_read_b64_tr_b16 a[244:245], v13 offset:16640
  ds_read_b64_tr_b16 a[246:247], v13 offset:18688
  buffer_load_dwordx4 a[120:123], v10, s[12:15], s56 offen offset:2304 nt
  v_mfma_f32_32x32x16_bf16 v[176:191], a[224:227], v[228:231], v[176:191]
  ds_write_b128 v7, a[12:15] offset:3072
  s_waitcnt lgkmcnt(11)
  v_mfma_f32_32x32x16_bf16 v[112:127], a[228:231], v[224:227], v[112:127]
  ds_read_b64_tr_b16 a[248:249], v14 offset:16640
  ds_read_b64_tr_b16 a[250:251], v14 offset:18688
  ds_read_b64_tr_b16 a[252:253], v15 offset:16640
  v_mfma_f32_32x32x16_bf16 v[192:207], a[228:231], v[228:231], v[192:207]
  s_waitcnt lgkmcnt(9)
  v_mfma_f32_32x32x16_bf16 v[64:79], a[232:235], v[224:227], v[64:79]
  ds_read_b64_tr_b16 a[254:255], v15 offset:18688
  ds_write_b128 v7, a[16:19] offset:4096
  ds_read_b128 v[232:235], v19 offset:40960
  v_mfma_f32_32x32x16_bf16 v[80:95], a[236:239], v[224:227], v[80:95]
  ds_read_b64_tr_b16 a[224:225], v12 offset:24576
  ds_read_b64_tr_b16 a[226:227], v12 offset:26624
  s_waitcnt lgkmcnt(9)
  v_mfma_f32_32x32x16_bf16 v[96:111], a[240:243], v[224:227], v[96:111]
  ds_read_b128 v[236:239], v23 offset:40960
  ds_write_b128 v7, a[20:23] offset:5120
  ds_read_b64_tr_b16 a[228:229], v12 offset:24832
  v_mfma_f32_32x32x16_bf16 v[128:143], a[244:247], v[224:227], v[128:143]
  ds_read_b64_tr_b16 a[230:231], v12 offset:26880
  ds_write_b128 v7, a[24:27] offset:6144
  s_waitcnt lgkmcnt(9)
  v_mfma_f32_32x32x16_bf16 v[144:159], a[248:251], v[224:227], v[144:159]
  ds_read_b64_tr_b16 a[232:233], v13 offset:24576
  ds_read_b64_tr_b16 a[234:235], v13 offset:26624
  ds_read_b64_tr_b16 a[236:237], v14 offset:24576
  buffer_load_dwordx4 a[92:95], v11, s[12:15], s56 offen offset:3072 nt
  v_mfma_f32_32x32x16_bf16 v[160:175], a[252:255], v[224:227], v[160:175]
  ds_read_b64_tr_b16 a[238:239], v14 offset:26624
  ds_write_b128 v7, a[28:31] offset:7168
  s_waitcnt lgkmcnt(9)
  v_mfma_f32_32x32x16_bf16 v[48:63], a[224:227], v[232:235], v[48:63]
  ds_read_b64_tr_b16 a[240:241], v15 offset:24576
  ds_read_b64_tr_b16 a[242:243], v15 offset:26624
  ds_read_b64_tr_b16 a[244:245], v13 offset:24832
  v_subrev_u32 v12, 65536, v12
  v_mfma_f32_32x32x16_bf16 v[176:191], a[224:227], v[236:239], v[176:191]
  ds_read_b64_tr_b16 a[246:247], v13 offset:26880
  ds_read_b64_tr_b16 a[248:249], v14 offset:24832
  s_waitcnt vmcnt(6)
  s_barrier
L_RA6:
  s_waitcnt lgkmcnt(11)
  v_mfma_f32_32x32x16_bf16 v[112:127], a[228:231], v[232:235], v[112:127]
  ds_read_b64_tr_b16 a[250:251], v14 offset:26880
  ds_read_b64_tr_b16 a[252:253], v15 offset:24832
  ds_read_b64_tr_b16 a[254:255], v15 offset:26880
  v_subrev_u32 v13, 65536, v13
  v_subrev_u32 v14, 65536, v14
  v_subrev_u32 v15, 65536, v15
  v_mfma_f32_32x32x16_bf16 v[192:207], a[228:231], v[236:239], v[192:207]
  s_waitcnt lgkmcnt(9)
  v_mfma_f32_32x32x16_bf16 v[64:79], a[232:235], v[232:235], v[64:79]
  ds_read_b128 v[208:211], v16 offset:0
  ds_read_b64_tr_b16 a[224:225], v12 offset:0
  ds_read_b64_tr_b16 a[226:227], v12 offset:2048
  v_mfma_f32_32x32x16_bf16 v[80:95], a[236:239], v[232:235], v[80:95]
  ds_read_b128 v[212:215], v20 offset:0
  ds_read_b128 v[216:219], v17 offset:0
  buffer_load_dwordx4 a[124:127], v11, s[12:15], s56 offen offset:3328 nt
  s_waitcnt lgkmcnt(9)
  v_mfma_f32_32x32x16_bf16 v[96:111], a[240:243], v[232:235], v[96:111]
  ds_read_b64_tr_b16 a[228:229], v12 offset:8192
  ds_read_b64_tr_b16 a[230:231], v12 offset:10240
  ds_read_b128 v[220:223], v21 offset:0
  v_mfma_f32_32x32x16_bf16 v[128:143], a[244:247], v[232:235], v[128:143]
  ds_read_b128 v[224:227], v18 offset:0
  ds_read_b64_tr_b16 a[232:233], v12 offset:16384
  s_waitcnt lgkmcnt(10)
  v_mfma_f32_32x32x16_bf16 v[144:159], a[248:251], v[232:235], v[144:159]
  ds_read_b64_tr_b16 a[234:235], v12 offset:18432
  ds_read_b128 v[228:231], v22 offset:0
  v_mfma_f32_32x32x16_bf16 v[160:175], a[252:255], v[232:235], v[160:175]
  ds_read_b128 v[232:235], v19 offset:0
  ds_read_b64_tr_b16 a[236:237], v12 offset:24576
  s_waitcnt lgkmcnt(10)
  v_mfma_f32_32x32x16_bf16 v[48:63], a[224:227], v[208:211], v[48:63]
  ds_read_b64_tr_b16 a[238:239], v12 offset:26624
  ds_read_b128 v[236:239], v23 offset:0
  ds_read_b64_tr_b16 a[240:241], v13 offset:0
  s_barrier
  v_mfma_f32_32x32x16_bf16 v[176:191], a[224:227], v[212:215], v[176:191]
  ds_read_b64_tr_b16 a[242:243], v13 offset:2048
  s_waitcnt lgkmcnt(10)
  v_mfma_f32_32x32x16_bf16 v[48:63], a[228:231], v[216:219], v[48:63]
  ds_read_b64_tr_b16 a[244:245], v13 offset:8192
  ds_read_b64_tr_b16 a[246:247], v13 offset:10240
  ds_write_b128 v7, a[32:35] offset:32768
  v_mfma_f32_32x32x16_bf16 v[176:191], a[228:231], v[220:223], v[176:191]
  ds_read_b64_tr_b16 a[248:249], v13 offset:16384
  s_xor_b32 s56, s44, 131072
  buffer_load_dwordx4 a[128:131], v8, s[12:15], s56 offen offset:0 nt
  s_waitcnt lgkmcnt(10)
  v_mfma_f32_32x32x16_bf16 v[48:63], a[232:235], v[224:227], v[48:63]
  ds_read_b64_tr_b16 a[250:251], v13 offset:18432
  ds_read_b64_tr_b16 a[252:253], v13 offset:24576
  ds_read_b64_tr_b16 a[254:255], v13 offset:26624
  v_mfma_f32_32x32x16_bf16 v[176:191], a[232:235], v[228:231], v[176:191]
  ds_write_b128 v7, a[36:39] offset:33792
  s_waitcnt lgkmcnt(10)
  v_mfma_f32_32x32x16_bf16 v[48:63], a[236:239], v[232:235], v[48:63]
  ds_read_b64_tr_b16 a[224:225], v14 offset:0
  ds_read_b64_tr_b16 a[226:227], v14 offset:2048
  ds_read_b64_tr_b16 a[228:229], v14 offset:8192
  v_mfma_f32_32x32x16_bf16 v[176:191], a[236:239], v[236:239], v[176:191]
  ds_read_b64_tr_b16 a[230:231], v14 offset:10240
  s_waitcnt lgkmcnt(10)
  v_mfma_f32_32x32x16_bf16 v[64:79], a[240:243], v[208:211], v[64:79]
  ds_write_b128 v7, a[40:43] offset:34816
  ds_read_b64_tr_b16 a[232:233], v14 offset:16384
  ds_read_b64_tr_b16 a[234:235], v14 offset:18432
  v_mfma_f32_32x32x16_bf16 v[64:79], a[244:247], v[216:219], v[64:79]
  ds_read_b64_tr_b16 a[236:237], v14 offset:24576
  buffer_load_dwordx4 a[160:163], v8, s[12:15], s56 offen offset:256 nt
  v_mul_f32 v48, s39, v48
  s_waitcnt lgkmcnt(9)
  v_mfma_f32_32x32x16_bf16 v[64:79], a[248:251], v[224:227], v[64:79]
  ds_read_b64_tr_b16 a[238:239], v14 offset:26624
  ds_write_b128 v7, a[44:47] offset:35840
  ds_read_b64_tr_b16 a[240:241], v15 offset:0
  v_mfma_f32_32x32x16_bf16 v[64:79], a[252:255], v[232:235], v[64:79]
  ds_read_b64_tr_b16 a[242:243], v15 offset:2048
  ds_read_b64_tr_b16 a[244:245], v15 offset:8192
  v_mul_f32 v176, s39, v176
  v_mul_f32 v177, s39, v177
  v_mul_f32 v178, s39, v178
  s_waitcnt lgkmcnt(9)
  v_mfma_f32_32x32x16_bf16 v[80:95], a[224:227], v[208:211], v[80:95]
  ds_read_b64_tr_b16 a[246:247], v15 offset:10240
  ds_write_b128 v7, a[48:51] offset:36864
  ds_read_b64_tr_b16 a[248:249], v15 offset:16384
  v_mfma_f32_32x32x16_bf16 v[80:95], a[228:231], v[216:219], v[80:95]
  ds_read_b64_tr_b16 a[250:251], v15 offset:18432
  ds_read_b64_tr_b16 a[252:253], v15 offset:24576
  v_mul_f32 v179, s39, v179
  v_cvt_pk_bf16_f32 v176, v176, v177
  v_mul_f32 v180, s39, v180
  s_waitcnt lgkmcnt(9)
  v_mfma_f32_32x32x16_bf16 v[80:95], a[232:235], v[224:227], v[80:95]
  ds_read_b64_tr_b16 a[254:255], v15 offset:26624
  ds_write_b128 v7, a[52:55] offset:37888
  ds_read_b64_tr_b16 a[224:225], v12 offset:256
  v_mfma_f32_32x32x16_bf16 v[80:95], a[236:239], v[232:235], v[80:95]
  ds_read_b64_tr_b16 a[226:227], v12 offset:2304
  ds_write_b128 v7, a[56:59] offset:38912
  s_waitcnt lgkmcnt(9)
  v_mfma_f32_32x32x16_bf16 v[96:111], a[240:243], v[208:211], v[96:111]
  ds_read_b64_tr_b16 a[228:229], v12 offset:8448
  ds_read_b64_tr_b16 a[230:231], v12 offset:10496
  buffer_load_dwordx4 a[132:135], v9, s[12:15], s56 offen offset:1024 nt
  ds_write_b128 v7, a[60:63] offset:39936
  v_mfma_f32_32x32x16_bf16 v[96:111], a[244:247], v[216:219], v[96:111]
  ds_read_b64_tr_b16 a[232:233], v12 offset:16640
  ds_read_b64_tr_b16 a[234:235], v12 offset:18688
  v_mul_f32 v181, s39, v181
  v_mul_f32 v182, s39, v182
  v_mul_f32 v183, s39, v183
  s_waitcnt lgkmcnt(9)
  v_mfma_f32_32x32x16_bf16 v[96:111], a[248:251], v[224:227], v[96:111]
  ds_read_b64_tr_b16 a[236:237], v12 offset:24832
  ds_read_b64_tr_b16 a[238:239], v12 offset:26880
  ds_read_b64_tr_b16 a[240:241], v13 offset:256
  v_cvt_pk_bf16_f32 v177, v178, v179
  v_mul_f32 v184, s39, v184
  v_mul_f32 v185, s39, v185
  v_mfma_f32_32x32x16_bf16 v[96:111], a[252:255], v[232:235], v[96:111]
  ds_read_b64_tr_b16 a[242:243], v13 offset:2304
  ds_read_b64_tr_b16 a[244:245], v13 offset:8448
  v_mul_f32 v186, s39, v186
  v_mul_f32 v187, s39, v187
  v_mul_f32 v188, s39, v188
  s_waitcnt lgkmcnt(11)
  v_mfma_f32_32x32x16_bf16 v[112:127], a[224:227], v[208:211], v[112:127]
  ds_read_b64_tr_b16 a[246:247], v13 offset:10496
  ds_read_b64_tr_b16 a[248:249], v13 offset:16640
  ds_read_b64_tr_b16 a[250:251], v13 offset:18688
  v_mul_f32 v189, s39, v189
  v_mul_f32 v190, s39, v190
  v_mul_f32 v191, s39, v191
  v_mfma_f32_32x32x16_bf16 v[192:207], a[224:227], v[212:215], v[192:207]
  buffer_load_dwordx4 a[164:167], v9, s[12:15], s56 offen offset:1280 nt
  v_cvt_pk_bf16_f32 v178, v180, v181
  v_cvt_pk_bf16_f32 v179, v182, v183
  s_waitcnt lgkmcnt(11)
  v_mfma_f32_32x32x16_bf16 v[112:127], a[228:231], v[216:219], v[112:127]
  ds_read_b64_tr_b16 a[252:253], v13 offset:24832
  ds_read_b64_tr_b16 a[254:255], v13 offset:26880
  ds_read_b64_tr_b16 a[224:225], v14 offset:256
  v_cvt_pk_bf16_f32 v180, v184, v185
  v_cvt_pk_bf16_f32 v181, v186, v187
  v_cvt_pk_bf16_f32 v182, v188, v189
  v_mfma_f32_32x32x16_bf16 v[192:207], a[228:231], v[220:223], v[192:207]
  v_cvt_pk_bf16_f32 v183, v190, v191
  v_mul_f32 v49, s39, v49
  v_mul_f32 v50, s39, v50
  v_mul_f32 v51, s39, v51
  v_mul_f32 v52, s39, v52
  s_waitcnt lgkmcnt(11)
  v_mfma_f32_32x32x16_bf16 v[112:127], a[232:235], v[224:227], v[112:127]
  ds_read_b64_tr_b16 a[226:227], v14 offset:2304
  ds_read_b64_tr_b16 a[228:229], v14 offset:8448
  ds_read_b64_tr_b16 a[230:231], v14 offset:10496
  v_mul_f32 v53, s39, v53
  v_mul_f32 v54, s39, v54
  v_mul_f32 v55, s39, v55
  v_mfma_f32_32x32x16_bf16 v[192:207], a[232:235], v[228:231], v[192:207]
  v_cvt_pk_bf16_f32 v48, v48, v49
  v_cvt_pk_bf16_f32 v50, v50, v51
  v_cvt_pk_bf16_f32 v52, v52, v53
  v_cvt_pk_bf16_f32 v54, v54, v55
  v_accvgpr_write_b32 a0, v48
  s_waitcnt lgkmcnt(12)
  v_mfma_f32_32x32x16_bf16 v[112:127], a[236:239], v[232:235], v[112:127]
  ds_read_b64_tr_b16 a[232:233], v14 offset:16640
  ds_read_b64_tr_b16 a[234:235], v14 offset:18688
  v_accvgpr_write_b32 a1, v50
  v_accvgpr_write_b32 a2, v52
  v_accvgpr_write_b32 a3, v54
  v_mul_f32 v56, s39, v56
  v_mfma_f32_32x32x16_bf16 v[192:207], a[236:239], v[236:239], v[192:207]
  v_mul_f32 v57, s39, v57
  v_mul_f32 v58, s39, v58
  v_mul_f32 v59, s39, v59
  v_mul_f32 v60, s39, v60
  v_mul_f32 v61, s39, v61
  s_waitcnt lgkmcnt(10)
  v_mfma_f32_32x32x16_bf16 v[128:143], a[240:243], v[208:211], v[128:143]
  ds_read_b64_tr_b16 a[236:237], v14 offset:24832
  ds_read_b64_tr_b16 a[238:239], v14 offset:26880
  ds_write_b128 v37, v[176:179] offset:16384
  v_mfma_f32_32x32x16_bf16 v[128:143], a[244:247], v[216:219], v[128:143]
  ds_write_b128 v37, v[180:183] offset:17408
  buffer_load_dwordx4 a[136:139], v10, s[12:15], s56 offen offset:2048 nt
  s_waitcnt lgkmcnt(10)
  v_mfma_f32_32x32x16_bf16 v[128:143], a[248:251], v[224:227], v[128:143]
  ds_read_b64_tr_b16 a[240:241], v15 offset:256
  ds_read_b64_tr_b16 a[242:243], v15 offset:2304
  ds_read_b64_tr_b16 a[244:245], v15 offset:8448
  v_mul_f32 v62, s39, v62
  v_mul_f32 v63, s39, v63
  v_cvt_pk_bf16_f32 v56, v56, v57
  v_mfma_f32_32x32x16_bf16 v[128:143], a[252:255], v[232:235], v[128:143]
  ds_read_b64_tr_b16 a[246:247], v15 offset:10496
  v_cvt_pk_bf16_f32 v58, v58, v59
  v_cvt_pk_bf16_f32 v60, v60, v61
  v_cvt_pk_bf16_f32 v62, v62, v63
  v_accvgpr_write_b32 a4, v56
  s_waitcnt lgkmcnt(10)
  v_mfma_f32_32x32x16_bf16 v[144:159], a[224:227], v[208:211], v[144:159]
  ds_read_b64_tr_b16 a[248:249], v15 offset:16640
  ds_read_b64_tr_b16 a[250:251], v15 offset:18688
  ds_read_b64_tr_b16 a[252:253], v15 offset:24832
  s_waitcnt lgkmcnt(7)
  s_barrier
L_RS0:
  v_mfma_f32_32x32x16_bf16 v[144:159], a[228:231], v[216:219], v[144:159]
  ds_read_b64_tr_b16 a[254:255], v15 offset:26880
  ds_read_b128 a[224:227], v24 offset:0
  ds_read_b128 a[228:231], v24 offset:8192
  v_accvgpr_write_b32 a5, v58
  v_accvgpr_write_b32 a6, v60
  v_accvgpr_write_b32 a7, v62
  v_mfma_f32_32x32x16_bf16 v[144:159], a[232:235], v[224:227], v[144:159]
  ds_read_b128 a[232:235], v24 offset:16384
  v_mul_f32 v64, s39, v64
  v_mul_f32 v65, s39, v65
  v_mul_f32 v66, s39, v66
  v_mul_f32 v67, s39, v67
  v_mul_f32 v68, s39, v68
  v_mfma_f32_32x32x16_bf16 v[144:159], a[236:239], v[232:235], v[144:159]
  ds_read_b128 a[236:239], v24 offset:24576
  buffer_load_dwordx4 a[168:171], v10, s[12:15], s56 offen offset:2304 nt
  v_mul_f32 v69, s39, v69
  s_waitcnt lgkmcnt(8)
  v_mfma_f32_32x32x16_bf16 v[160:175], a[240:243], v[208:211], v[160:175]
  ds_read_b128 a[240:243], v32 offset:0
  v_mul_f32 v70, s39, v70
  v_mul_f32 v71, s39, v71
  v_cvt_pk_bf16_f32 v64, v64, v65
  v_cvt_pk_bf16_f32 v66, v66, v67
  v_cvt_pk_bf16_f32 v68, v68, v69
  v_mfma_f32_32x32x16_bf16 v[160:175], a[244:247], v[216:219], v[160:175]
  ds_read_b128 a[244:247], v36 offset:16384
  v_cvt_pk_bf16_f32 v70, v70, v71
  v_accvgpr_write_b32 a8, v64
  v_accvgpr_write_b32 a9, v66
  v_accvgpr_write_b32 a10, v68
  s_waitcnt lgkmcnt(6)
  v_mfma_f32_32x32x16_bf16 v[160:175], a[248:251], v[224:227], v[160:175]
  ds_read_b128 a[248:251], v25 offset:0
  v_accvgpr_write_b32 a11, v70
  v_mul_f32 v72, s39, v72
  v_mul_f32 v73, s39, v73
  v_mul_f32 v74, s39, v74
  v_mul_f32 v75, s39, v75
  v_mfma_f32_32x32x16_bf16 v[160:175], a[252:255], v[232:235], v[160:175]
  ds_read_b128 a[252:255], v25 offset:8192
  v_mul_f32 v76, s39, v76
  v_mul_f32 v77, s39, v77
  v_mul_f32 v78, s39, v78
  v_mul_f32 v79, s39, v79
  s_waitcnt lgkmcnt(6)
  v_mfma_f32_32x32x16_bf16 v[240:255], a[224:227], a[0:3], 0
  ds_read_b128 a[224:227], v25 offset:16384
  s_barrier
  v_cvt_pk_bf16_f32 v72, v72, v73
  v_cvt_pk_bf16_f32 v74, v74, v75
  v_cvt_pk_bf16_f32 v76, v76, v77
  v_mfma_f32_32x32x16_bf16 v[224:239], a[228:231], a[0:3], 0
  ds_read_b128 a[228:231], v25 offset:24576
  buffer_load_dwordx4 a[140:143], v11, s[12:15], s56 offen offset:3072 nt
  v_cvt_pk_bf16_f32 v78, v78, v79
  s_waitcnt lgkmcnt(6)
  v_mfma_f32_32x32x16_bf16 v[176:191], a[232:235], a[0:3], 0
  ds_read_b128 a[232:235], v33 offset:0
  v_accvgpr_write_b32 a12, v72
  v_accvgpr_write_b32 a13, v74
  v_accvgpr_write_b32 a14, v76
  v_accvgpr_write_b32 a15, v78
  v_mul_f32 v80, s39, v80
  v_mfma_f32_32x32x16_bf16 v[208:223], a[236:239], a[0:3], 0
  ds_read_b128 a[236:239], v36 offset:17408
  v_mul_f32 v81, s39, v81
  v_mul_f32 v82, s39, v82
  v_mul_f32 v83, s39, v83
  v_mul_f32 v84, s39, v84
  s_waitcnt lgkmcnt(5)
  v_mfma_f32_32x32x16_bf16 v[48:63], a[240:243], a[244:247], 0
  ds_read_b128 a[240:243], v26 offset:0
  ds_read_b128 a[244:247], v26 offset:8192
  v_mul_f32 v85, s39, v85
  v_mul_f32 v86, s39, v86
  v_mul_f32 v87, s39, v87
  v_cvt_pk_bf16_f32 v80, v80, v81
  v_mfma_f32_32x32x16_bf16 v[240:255], a[248:251], a[4:7], v[240:255]
  ds_read_b128 a[248:251], v26 offset:16384
  v_cvt_pk_bf16_f32 v82, v82, v83
  v_cvt_pk_bf16_f32 v84, v84, v85
  v_cvt_pk_bf16_f32 v86, v86, v87
  v_accvgpr_write_b32 a16, v80
  s_waitcnt lgkmcnt(6)
  v_mfma_f32_32x32x16_bf16 v[224:239], a[252:255], a[4:7], v[224:239]
  ds_read_b128 a[252:255], v26 offset:24576
  v_accvgpr_write_b32 a17, v82
  v_accvgpr_write_b32 a18, v84
  v_accvgpr_write_b32 a19, v86
  v_mul_f32 v88, s39, v88
  v_mul_f32 v89, s39, v89
  v_mfma_f32_32x32x16_bf16 v[176:191], a[224:227], a[4:7], v[176:191]
  ds_read_b128 a[224:227], v34 offset:0
  v_mul_f32 v90, s39, v90
  v_mul_f32 v91, s39, v91
  v_mul_f32 v92, s39, v92
  v_mul_f32 v93, s39, v93
  s_waitcnt lgkmcnt(5)
  v_mfma_f32_32x32x16_bf16 v[208:223], a[228:231], a[4:7], v[208:223]
  ds_read_b128 a[228:231], v36 offset:18432
  buffer_load_dwordx4 a[172:175], v11, s[12:15], s56 offen offset:3328 nt
  v_mul_f32 v94, s39, v94
  v_mul_f32 v95, s39, v95
  v_mfma_f32_32x32x16_bf16 v[48:63], a[232:235], a[236:239], v[48:63]
  ds_read_b128 a[232:235], v27 offset:0
  ds_read_b128 a[236:239], v27 offset:8192
  v_cvt_pk_bf16_f32 v88, v88, v89
  v_cvt_pk_bf16_f32 v90, v90, v91
  v_cvt_pk_bf16_f32 v92, v92, v93
  s_waitcnt lgkmcnt(6)
  v_mfma_f32_32x32x16_bf16 v[240:255], a[240:243], a[8:11], v[240:255]
  ds_read_b128 a[240:243], v27 offset:16384
  v_cvt_pk_bf16_f32 v94, v94, v95
  v_accvgpr_write_b32 a20, v88
  v_accvgpr_write_b32 a21, v90
  v_accvgpr_write_b32 a22, v92
  v_accvgpr_write_b32 a23, v94
  v_mfma_f32_32x32x16_bf16 v[224:239], a[244:247], a[8:11], v[224:239]
  ds_read_b128 a[244:247], v27 offset:24576
  v_mul_f32 v192, s39, v192
  v_mul_f32 v193, s39, v193
  v_mul_f32 v194, s39, v194
  v_mul_f32 v195, s39, v195
  s_waitcnt lgkmcnt(6)
  v_mfma_f32_32x32x16_bf16 v[176:191], a[248:251], a[8:11], v[176:191]
  ds_read_b128 a[248:251], v35 offset:0
  v_cvt_pk_bf16_f32 v192, v192, v193
  v_mul_f32 v196, s39, v196
  v_mul_f32 v197, s39, v197
  v_mul_f32 v198, s39, v198
  v_mul_f32 v199, s39, v199
  v_mfma_f32_32x32x16_bf16 v[208:223], a[252:255], a[8:11], v[208:223]
  ds_read_b128 a[252:255], v36 offset:19456
  v_cvt_pk_bf16_f32 v193, v194, v195
  v_mul_f32 v200, s39, v200
  v_mul_f32 v201, s39, v201
  v_mul_f32 v202, s39, v202
  s_waitcnt lgkmcnt(5)
  v_mfma_f32_32x32x16_bf16 v[48:63], a[224:227], a[228:231], v[48:63]
  ds_read_b128 a[224:227], v28 offset:0
  ds_read_b128 a[228:231], v28 offset:8192
  v_mul_f32 v203, s39, v203
  v_mul_f32 v204, s39, v204
  v_mul_f32 v205, s39, v205
  v_mul_f32 v206, s39, v206
  v_mfma_f32_32x32x16_bf16 v[240:255], a[232:235], a[12:15], v[240:255]
  ds_read_b128 a[232:235], v28 offset:16384
  s_xor_b32 s56, s44, 163840
  buffer_load_dwordx4 a[144:147], v8, s[12:15], s56 offen offset:0 nt
  s_waitcnt lgkmcnt(6)
  v_mfma_f32_32x32x16_bf16 v[224:239], a[236:239], a[12:15], v[224:239]
  ds_read_b128 a[236:239], v28 offset:24576
  v_mul_f32 v207, s39, v207
  v_cvt_pk_bf16_f32 v194, v196, v197
  v_cvt_pk_bf16_f32 v195, v198, v199
  v_cvt_pk_bf16_f32 v196, v200, v201
  v_cvt_pk_bf16_f32 v197, v202, v203
  v_mfma_f32_32x32x16_bf16 v[176:191], a[240:243], a[12:15], v[176:191]
  ds_read_b128 a[240:243], v32 offset:512
  v_cvt_pk_bf16_f32 v198, v204, v205
  v_cvt_pk_bf16_f32 v199, v206, v207
  v_mul_f32 v96, s39, v96
  v_mul_f32 v97, s39, v97
  s_waitcnt lgkmcnt(5)
  v_mfma_f32_32x32x16_bf16 v[208:223], a[244:247], a[12:15], v[208:223]
  ds_read_b128 a[244:247], v36 offset:20480
  ds_write_b128 v37, v[192:195] offset:24576
  v_mul_f32 v98, s39, v98
  v_mfma_f32_32x32x16_bf16 v[48:63], a[248:251], a[252:255], v[48:63]
  ds_read_b128 a[248:251], v29 offset:0
  ds_read_b128 a[252:255], v29 offset:8192
  v_mul_f32 v99, s39, v99
  v_mul_f32 v100, s39, v100
  v_mul_f32 v101, s39, v101
  s_waitcnt lgkmcnt(7)
  v_mfma_f32_32x32x16_bf16 v[240:255], a[224:227], a[16:19], v[240:255]
  ds_read_b128 a[224:227], v29 offset:16384
  ds_write_b128 v37, v[196:199] offset:25600
  v_mul_f32 v102, s39, v102
  v_mfma_f32_32x32x16_bf16 v[224:239], a[228:231], a[16:19], v[224:239]
  ds_read_b128 a[228:231], v29 offset:24576
  buffer_load_dwordx4 a[176:179], v8, s[12:15], s56 offen offset:256 nt
  v_mul_f32 v103, s39, v103
  s_waitcnt lgkmcnt(8)
  v_mfma_f32_32x32x16_bf16 v[176:191], a[232:235], a[16:19], v[176:191]
  ds_read_b128 a[232:235], v33 offset:512
  v_cvt_pk_bf16_f32 v96, v96, v97
  v_cvt_pk_bf16_f32 v98, v98, v99
  v_cvt_pk_bf16_f32 v100, v100, v101
  v_cvt_pk_bf16_f32 v102, v102, v103
  v_accvgpr_write_b32 a24, v96
  v_mfma_f32_32x32x16_bf16 v[208:223], a[236:239], a[16:19], v[208:223]
  ds_read_b128 a[236:239], v36 offset:21504
  v_accvgpr_write_b32 a25, v98
  v_accvgpr_write_b32 a26, v100
  v_accvgpr_write_b32 a27, v102
  v_mul_f32 v104, s39, v104
  s_waitcnt lgkmcnt(6)
  v_mfma_f32_32x32x16_bf16 v[48:63], a[240:243], a[244:247], v[48:63]
  ds_read_b128 a[240:243], v30 offset:0
  ds_read_b128 a[244:247], v30 offset:8192
  v_mul_f32 v105, s39, v105
  v_mul_f32 v106, s39, v106
  v_mul_f32 v107, s39, v107
  v_mul_f32 v108, s39, v108
  v_mfma_f32_32x32x16_bf16 v[240:255], a[248:251], a[20:23], v[240:255]
  ds_read_b128 a[248:251], v30 offset:16384
  v_mul_f32 v109, s39, v109
  v_mul_f32 v110, s39, v110
  v_mul_f32 v111, s39, v111
  v_cvt_pk_bf16_f32 v104, v104, v105
  s_waitcnt lgkmcnt(7)
  v_mfma_f32_32x32x16_bf16 v[224:239], a[252:255], a[20:23], v[224:239]
  ds_read_b128 a[252:255], v30 offset:24576
  v_cvt_pk_bf16_f32 v106, v106, v107
  v_cvt_pk_bf16_f32 v108, v108, v109
  v_cvt_pk_bf16_f32 v110, v110, v111
  v_accvgpr_write_b32 a28, v104
  v_accvgpr_write_b32 a29, v106
  v_mfma_f32_32x32x16_bf16 v[176:191], a[224:227], a[20:23], v[176:191]
  ds_read_b128 a[224:227], v34 offset:512
  v_accvgpr_write_b32 a30, v108
  v_accvgpr_write_b32 a31, v110
  v_mul_f32 v112, s39, v112
  v_mul_f32 v113, s39, v113
  s_waitcnt lgkmcnt(5)
  v_mfma_f32_32x32x16_bf16 v[208:223], a[228:231], a[20:23], v[208:223]
  ds_read_b128 a[228:231], v36 offset:22528
  buffer_load_dwordx4 a[148:151], v9, s[12:15], s56 offen offset:1024 nt
  v_mul_f32 v114, s39, v114
  v_mul_f32 v115, s39, v115
  v_mfma_f32_32x32x16_bf16 v[48:63], a[232:235], a[236:239], v[48:63]
  ds_read_b128 a[232:235], v31 offset:0
  ds_read_b128 a[236:239], v31 offset:8192
  v_mul_f32 v116, s39, v116
  v_mul_f32 v117, s39, v117
  v_mul_f32 v118, s39, v118
  s_waitcnt lgkmcnt(6)
  v_mfma_f32_32x32x16_bf16 v[240:255], a[240:243], a[24:27], v[240:255]
  ds_read_b128 a[240:243], v31 offset:16384
  v_mul_f32 v119, s39, v119
  v_cvt_pk_bf16_f32 v112, v112, v113
  v_cvt_pk_bf16_f32 v114, v114, v115
  v_cvt_pk_bf16_f32 v116, v116, v117
  v_cvt_pk_bf16_f32 v118, v118, v119
  v_mfma_f32_32x32x16_bf16 v[224:239], a[244:247], a[24:27], v[224:239]
  ds_read_b128 a[244:247], v31 offset:24576
  s_barrier
L_RS1:
  v_accvgpr_write_b32 a32, v112
  v_accvgpr_write_b32 a33, v114
  s_waitcnt lgkmcnt(6)
  v_mfma_f32_32x32x16_bf16 v[176:191], a[248:251], a[24:27], v[176:191]
  ds_read_b128 a[248:251], v35 offset:512
  v_accvgpr_write_b32 a34, v116
  v_accvgpr_write_b32 a35, v118
  v_mul_f32 v120, s39, v120
  v_mul_f32 v121, s39, v121
  v_mul_f32 v122, s39, v122
  v_mfma_f32_32x32x16_bf16 v[208:223], a[252:255], a[24:27], v[208:223]
  ds_read_b128 a[252:255], v36 offset:23552
  v_mul_f32 v123, s39, v123
  v_mul_f32 v124, s39, v124
  v_mul_f32 v125, s39, v125
  v_mul_f32 v126, s39, v126
  s_waitcnt lgkmcnt(5)
  v_mfma_f32_32x32x16_bf16 v[48:63], a[224:227], a[228:231], v[48:63]
  ds_read_b128 a[224:227], v24 offset:32768
  ds_read_b128 a[228:231], v24 offset:40960
  buffer_load_dwordx4 a[180:183], v9, s[12:15], s56 offen offset:1280 nt
  v_mul_f32 v127, s39, v127
  v_mfma_f32_32x32x16_bf16 v[240:255], a[232:235], a[28:31], v[240:255]
  ds_read_b128 a[232:235], v24 offset:49152
  v_cvt_pk_bf16_f32 v120, v120, v121
  v_cvt_pk_bf16_f32 v122, v122, v123
  v_cvt_pk_bf16_f32 v124, v124, v125
  v_cvt_pk_bf16_f32 v126, v126, v127
  s_waitcnt lgkmcnt(6)
  v_mfma_f32_32x32x16_bf16 v[224:239], a[236:239], a[28:31], v[224:239]
  ds_read_b128 a[236:239], v24 offset:57344
  v_accvgpr_write_b32 a36, v120
  v_accvgpr_write_b32 a37, v122
  v_accvgpr_write_b32 a38, v124
  v_accvgpr_write_b32 a39, v126
  v_mul_f32 v128, s39, v128
  v_mfma_f32_32x32x16_bf16 v[176:191], a[240:243], a[28:31], v[176:191]
  ds_read_b128 a[240:243], v32 offset:32768
  v_mul_f32 v129, s39, v129
  v_mul_f32 v130, s39, v130
  v_mul_f32 v131, s39, v131
  v_mul_f32 v132, s39, v132
  s_waitcnt lgkmcnt(5)
  v_mfma_f32_32x32x16_bf16 v[208:223], a[244:247], a[28:31], v[208:223]
  ds_read_b128 a[244:247], v36 offset:24576
  v_mul_f32 v133, s39, v133
  v_mul_f32 v134, s39, v134
  v_mul_f32 v135, s39, v135
  v_cvt_pk_bf16_f32 v128, v128, v129
  v_cvt_pk_bf16_f32 v130, v130, v131
  v_mfma_f32_32x32x16_bf16 v[48:63], a[248:251], a[252:255], v[48:63]
  ds_read_b128 a[248:251], v25 offset:32768
  ds_read_b128 a[252:255], v25 offset:40960
  v_cvt_pk_bf16_f32 v132, v132, v133
  v_cvt_pk_bf16_f32 v134, v134, v135
  v_accvgpr_write_b32 a40, v128
  s_waitcnt lgkmcnt(6)
  v_mfma_f32_32x32x16_bf16 v[240:255], a[224:227], a[32:35], v[240:255]
  ds_read_b128 a[224:227], v25 offset:49152
  s_barrier
  v_accvgpr_write_b32 a41, v130
  v_accvgpr_write_b32 a42, v132
  v_accvgpr_write_b32 a43, v134
  v_mfma_f32_32x32x16_bf16 v[224:239], a[228:231], a[32:35], v[224:239]
  ds_read_b128 a[228:231], v25 offset:57344
  buffer_load_dwordx4 a[152:155], v10, s[12:15], s56 offen offset:2048 nt
  v_mul_f32 v136, s39, v136
  s_waitcnt lgkmcnt(6)
  v_mfma_f32_32x32x16_bf16 v[176:191], a[232:235], a[32:35], v[176:191]
  ds_read_b128 a[232:235], v33 offset:32768
  v_mul_f32 v137, s39, v137
  v_mul_f32 v138, s39, v138
  v_mul_f32 v139, s39, v139
  v_mul_f32 v140, s39, v140
  v_mul_f32 v141, s39, v141
  v_mfma_f32_32x32x16_bf16 v[208:223], a[236:239], a[32:35], v[208:223]
  ds_read_b128 a[236:239], v36 offset:25600
  v_mul_f32 v142, s39, v142
  v_mul_f32 v143, s39, v143
  v_cvt_pk_bf16_f32 v136, v136, v137
  v_cvt_pk_bf16_f32 v138, v138, v139
  s_waitcnt lgkmcnt(5)
  v_mfma_f32_32x32x16_bf16 v[48:63], a[240:243], a[244:247], v[48:63]
  ds_read_b128 a[240:243], v26 offset:32768
  ds_read_b128 a[244:247], v26 offset:40960
  v_cvt_pk_bf16_f32 v140, v140, v141
  v_cvt_pk_bf16_f32 v142, v142, v143
  v_accvgpr_write_b32 a44, v136
  v_accvgpr_write_b32 a45, v138
  v_mfma_f32_32x32x16_bf16 v[240:255], a[248:251], a[36:39], v[240:255]
  ds_read_b128 a[248:251], v26 offset:49152
  v_accvgpr_write_b32 a46, v140
  v_accvgpr_write_b32 a47, v142
  v_mul_f32 v144, s39, v144
  v_mul_f32 v145, s39, v145
  s_waitcnt lgkmcnt(6)
  v_mfma_f32_32x32x16_bf16 v[224:239], a[252:255], a[36:39], v[224:239]
  ds_read_b128 a[252:255], v26 offset:57344
  v_mul_f32 v146, s39, v146
  v_mul_f32 v147, s39, v147
  v_mul_f32 v148, s39, v148
  v_mul_f32 v149, s39, v149
  v_mul_f32 v150, s39, v150
  v_mfma_f32_32x32x16_bf16 v[176:191], a[224:227], a[36:39], v[176:191]
  ds_read_b128 a[224:227], v34 offset:32768
  v_mul_f32 v151, s39, v151
  v_cvt_pk_bf16_f32 v144, v144, v145
  v_cvt_pk_bf16_f32 v146, v146, v147
  v_cvt_pk_bf16_f32 v148, v148, v149
  s_waitcnt lgkmcnt(5)
  v_mfma_f32_32x32x16_bf16 v[208:223], a[228:231], a[36:39], v[208:223]
  ds_read_b128 a[228:231], v36 offset:26624
  buffer_load_dwordx4 a[184:187], v10, s[12:15], s56 offen offset:2304 nt
  v_cvt_pk_bf16_f32 v150, v150, v151
  v_accvgpr_write_b32 a48, v144
  v_mfma_f32_32x32x16_bf16 v[48:63], a[232:235], a[236:239], v[48:63]
  ds_read_b128 a[232:235], v27 offset:32768
  ds_read_b128 a[236:239], v27 offset:40960
  v_accvgpr_write_b32 a49, v146
  v_accvgpr_write_b32 a50, v148
  v_accvgpr_write_b32 a51, v150
  s_waitcnt lgkmcnt(6)
  v_mfma_f32_32x32x16_bf16 v[240:255], a[240:243], a[40:43], v[240:255]
  ds_read_b128 a[240:243], v27 offset:49152
  v_mul_f32 v152, s39, v152
  v_mul_f32 v153, s39, v153
  v_mul_f32 v154, s39, v154
  v_mul_f32 v155, s39, v155
  v_mul_f32 v156, s39, v156
  v_mfma_f32_32x32x16_bf16 v[224:239], a[244:247], a[40:43], v[224:239]
  ds_read_b128 a[244:247], v27 offset:57344
  v_mul_f32 v157, s39, v157
  v_mul_f32 v158, s39, v158
  v_mul_f32 v159, s39, v159
  v_cvt_pk_bf16_f32 v152, v152, v153
  s_waitcnt lgkmcnt(6)
  v_mfma_f32_32x32x16_bf16 v[176:191], a[248:251], a[40:43], v[176:191]
  ds_read_b128 a[248:251], v35 offset:32768
  v_cvt_pk_bf16_f32 v154, v154, v155
  v_cvt_pk_bf16_f32 v156, v156, v157
  v_cvt_pk_bf16_f32 v158, v158, v159
  v_accvgpr_write_b32 a52, v152
  v_accvgpr_write_b32 a53, v154
  v_mfma_f32_32x32x16_bf16 v[208:223], a[252:255], a[40:43], v[208:223]
  ds_read_b128 a[252:255], v36 offset:27648
  v_accvgpr_write_b32 a54, v156
  v_accvgpr_write_b32 a55, v158
  v_mul_f32 v160, s39, v160
  v_mul_f32 v161, s39, v161
  s_waitcnt lgkmcnt(5)
  v_mfma_f32_32x32x16_bf16 v[48:63], a[224:227], a[228:231], v[48:63]
  ds_read_b128 a[224:227], v28 offset:32768
  ds_read_b128 a[228:231], v28 offset:40960
  ds_write_b128 v7, a[64:67] offset:0
  v_mfma_f32_32x32x16_bf16 v[240:255], a[232:235], a[44:47], v[240:255]
  ds_read_b128 a[232:235], v28 offset:49152
  buffer_load_dwordx4 a[156:159], v11, s[12:15], s56 offen offset:3072 nt
  v_mul_f32 v162, s39, v162
  s_waitcnt lgkmcnt(7)
  v_mfma_f32_32x32x16_bf16 v[224:239], a[236:239], a[44:47], v[224:239]
  ds_read_b128 a[236:239], v28 offset:57344
  ds_write_b128 v7, a[68:71] offset:1024
  v_mul_f32 v163, s39, v163
  v_mfma_f32_32x32x16_bf16 v[176:191], a[240:243], a[44:47], v[176:191]
  ds_read_b128 a[240:243], v32 offset:33280
  v_mul_f32 v164, s39, v164
  v_mul_f32 v165, s39, v165
  v_mul_f32 v166, s39, v166
  v_mul_f32 v167, s39, v167
  s_waitcnt lgkmcnt(7)
  v_mfma_f32_32x32x16_bf16 v[208:223], a[244:247], a[44:47], v[208:223]
  ds_read_b128 a[244:247], v36 offset:28672
  ds_write_b128 v7, a[72:75] offset:2048
  v_cvt_pk_bf16_f32 v160, v160, v161
  v_mfma_f32_32x32x16_bf16 v[48:63], a[248:251], a[252:255], v[48:63]
  ds_read_b128 a[248:251], v29 offset:32768
  ds_read_b128 a[252:255], v29 offset:40960
  v_cvt_pk_bf16_f32 v162, v162, v163
  v_cvt_pk_bf16_f32 v164, v164, v165
  v_cvt_pk_bf16_f32 v166, v166, v167
  s_waitcnt lgkmcnt(9)
  v_mfma_f32_32x32x16_bf16 v[240:255], a[224:227], a[48:51], v[240:255]
  ds_read_b128 a[224:227], v29 offset:49152
  ds_write_b128 v7, a[76:79] offset:3072
  v_accvgpr_write_b32 a56, v160
  v_mfma_f32_32x32x16_bf16 v[224:239], a[228:231], a[48:51], v[224:239]
  ds_read_b128 a[228:231], v29 offset:57344
  buffer_load_dwordx4 a[188:191], v11, s[12:15], s56 offen offset:3328 nt
  v_accvgpr_write_b32 a57, v162
  s_waitcnt lgkmcnt(9)
  v_mfma_f32_32x32x16_bf16 v[176:191], a[232:235], a[48:51], v[176:191]
  ds_read_b128 a[232:235], v33 offset:33280
  ds_write_b128 v7, a[80:83] offset:4096
  v_accvgpr_write_b32 a58, v164
  v_mfma_f32_32x32x16_bf16 v[208:223], a[236:239], a[48:51], v[208:223]
  ds_read_b128 a[236:239], v36 offset:29696
  v_accvgpr_write_b32 a59, v166
  v_mul_f32 v168, s39, v168
  v_mul_f32 v169, s39, v169
  v_mul_f32 v170, s39, v170
  s_waitcnt lgkmcnt(7)
  v_mfma_f32_32x32x16_bf16 v[48:63], a[240:243], a[244:247], v[48:63]
  ds_read_b128 a[240:243], v30 offset:32768
  ds_read_b128 a[244:247], v30 offset:40960
  s_waitcnt vmcnt(21)
  ds_write_b128 v7, a[84:87] offset:5120
  v_mfma_f32_32x32x16_bf16 v[240:255], a[248:251], a[52:55], v[240:255]
  ds_read_b128 a[248:251], v30 offset:49152
  v_mul_f32 v171, s39, v171
  v_mul_f32 v172, s39, v172
  v_mul_f32 v173, s39, v173
  v_mul_f32 v174, s39, v174
  s_waitcnt lgkmcnt(9)
  v_mfma_f32_32x32x16_bf16 v[224:239], a[252:255], a[52:55], v[224:239]
  ds_read_b128 a[252:255], v30 offset:57344
  s_waitcnt vmcnt(19)
  ds_write_b128 v7, a[88:91] offset:6144
  v_mfma_f32_32x32x16_bf16 v[176:191], a[224:227], a[52:55], v[176:191]
  ds_read_b128 a[224:227], v34 offset:33280
  s_xor_b32 s56, s44, 196608
  buffer_load_dwordx4 a[192:195], v8, s[12:15], s56 offen offset:0 nt
  s_waitcnt lgkmcnt(7)
  v_mfma_f32_32x32x16_bf16 v[208:223], a[228:231], a[52:55], v[208:223]
  ds_read_b128 a[228:231], v36 offset:30720
  s_waitcnt vmcnt(18)
  ds_write_b128 v7, a[92:95] offset:7168
  v_mfma_f32_32x32x16_bf16 v[48:63], a[232:235], a[236:239], v[48:63]
  ds_read_b128 a[232:235], v31 offset:32768
  ds_read_b128 a[236:239], v31 offset:40960
  v_mul_f32 v175, s39, v175
  v_cvt_pk_bf16_f32 v168, v168, v169
  v_cvt_pk_bf16_f32 v170, v170, v171
  s_waitcnt lgkmcnt(9)
  v_mfma_f32_32x32x16_bf16 v[240:255], a[240:243], a[56:59], v[240:255]
  ds_read_b128 a[240:243], v31 offset:49152
  v_cvt_pk_bf16_f32 v172, v172, v173
  v_cvt_pk_bf16_f32 v174, v174, v175
  v_accvgpr_write_b32 a60, v168
  v_accvgpr_write_b32 a61, v170
  v_accvgpr_write_b32 a62, v172
  v_mfma_f32_32x32x16_bf16 v[224:239], a[244:247], a[56:59], v[224:239]
  ds_read_b128 a[244:247], v31 offset:57344
  s_waitcnt lgkmcnt(4)
  s_barrier
L_RS2:
  v_accvgpr_write_b32 a63, v174
  v_mfma_f32_32x32x16_bf16 v[176:191], a[248:251], a[56:59], v[176:191]
  ds_read_b128 a[248:251], v35 offset:33280
  v_xor_b32 v12, s36, v45
  v_xor_b32 v13, 64, v12
  v_xor_b32 v14, 0x80, v12
  v_xor_b32 v15, 0xc0, v12
  v_mov_b32 v45, 0x3f80
  v_mfma_f32_32x32x16_bf16 v[208:223], a[252:255], a[56:59], v[208:223]
  ds_read_b128 a[252:255], v36 offset:31744
  v_lshlrev_b32 v45, v44, v45
  v_mfma_f32_32x32x16_bf16 v[48:63], a[224:227], a[228:231], v[48:63]
  ds_read_b128 a[224:227], v32 offset:0
  ds_read_b128 a[228:231], v36 offset:16384
  buffer_load_dwordx4 a[196:199], v9, s[12:15], s56 offen offset:1024 nt
  s_waitcnt lgkmcnt(6)
  v_mfma_f32_32x32x16_bf16 v[240:255], a[232:235], a[60:63], v[240:255]
  ds_read_b128 a[232:235], v33 offset:0
  v_mfma_f32_32x32x16_bf16 v[224:239], a[236:239], a[60:63], v[224:239]
  ds_read_b128 a[236:239], v36 offset:17408
  s_waitcnt lgkmcnt(6)
  v_mfma_f32_32x32x16_bf16 v[176:191], a[240:243], a[60:63], v[176:191]
  ds_read_b128 a[240:243], v34 offset:0
  v_mfma_f32_32x32x16_bf16 v[208:223], a[244:247], a[60:63], v[208:223]
  ds_read_b128 a[244:247], v36 offset:18432
  s_waitcnt lgkmcnt(4)
  v_mfma_f32_32x32x16_bf16 v[48:63], a[248:251], a[252:255], v[48:63]
  ds_read_b128 a[248:251], v35 offset:0
  ds_read_b128 a[252:255], v36 offset:19456
  s_cbranch_vccnz L_fix1
L_ret1:
  v_exp_f32 v240, v240
  v_mfma_f32_32x32x16_bf16 v[128:143], a[224:227], a[228:231], 0
  ds_read_b128 a[224:227], v32 offset:512
  ds_read_b128 a[228:231], v36 offset:20480
  s_barrier
  s_waitcnt lgkmcnt(6)
  v_mfma_f32_32x32x16_bf16 v[128:143], a[232:235], a[236:239], v[128:143]
  ds_read_b128 a[232:235], v33 offset:512
  ds_read_b128 a[236:239], v36 offset:21504
  buffer_load_dwordx4 a[200:203], v10, s[12:15], s56 offen offset:2048 nt
  s_waitcnt lgkmcnt(6)
  v_mfma_f32_32x32x16_bf16 v[128:143], a[240:243], a[244:247], v[128:143]
  ds_read_b128 a[240:243], v34 offset:512
  ds_read_b128 a[244:247], v36 offset:22528
  s_cbranch_vccnz L_fix0
L_ret0:
  s_waitcnt lgkmcnt(6)
  v_mfma_f32_32x32x16_bf16 v[128:143], a[248:251], a[252:255], v[128:143]
  ds_read_b128 a[248:251], v35 offset:512
  ds_read_b128 a[252:255], v36 offset:23552
  v_exp_f32 v48, v48
  s_waitcnt lgkmcnt(6)
  v_mfma_f32_32x32x16_bf16 v[128:143], a[224:227], a[228:231], v[128:143]
  ds_read_b128 a[224:227], v24 offset:0
  ds_read_b128 a[228:231], v25 offset:0
  v_exp_f32 v49, v49
  s_waitcnt lgkmcnt(6)
  v_mfma_f32_32x32x16_bf16 v[128:143], a[232:235], a[236:239], v[128:143]
  ds_read_b128 a[232:235], v26 offset:0
  ds_read_b128 a[236:239], v27 offset:0
  v_exp_f32 v50, v50
  v_add_f32 v39, v48, v49
  s_waitcnt lgkmcnt(6)
  v_mfma_f32_32x32x16_bf16 v[128:143], a[240:243], a[244:247], v[128:143]
  ds_read_b128 a[240:243], v28 offset:0
  ds_read_b128 a[244:247], v29 offset:0
  v_exp_f32 v51, v51
  v_add_f32 v39, v39, v50
  s_waitcnt lgkmcnt(6)
  v_mfma_f32_32x32x16_bf16 v[128:143], a[248:251], a[252:255], v[128:143]
  ds_read_b128 a[248:251], v30 offset:0
  ds_read_b128 a[252:255], v31 offset:0
  buffer_load_dwordx4 a[204:207], v11, s[12:15], s56 offen offset:3072 nt
  s_waitcnt lgkmcnt(6)
  v_mfma_f32_32x32x16_bf16 v[64:79], a[224:227], a[0:3], 0
  ds_read_b128 a[224:227], v24 offset:8192
  v_exp_f32 v52, v52
  v_exp_f32 v53, v53
  v_add_f32 v39, v39, v51
  v_mfma_f32_32x32x16_bf16 v[64:79], a[228:231], a[4:7], v[64:79]
  ds_read_b128 a[228:231], v25 offset:8192
  v_exp_f32 v54, v54
  v_add_f32 v39, v39, v52
  v_add_f32 v39, v39, v53
  s_waitcnt lgkmcnt(6)
  v_mfma_f32_32x32x16_bf16 v[64:79], a[232:235], a[8:11], v[64:79]
  ds_read_b128 a[232:235], v26 offset:8192
  v_exp_f32 v55, v55
  v_exp_f32 v56, v56
  v_add_f32 v39, v39, v54
  v_mfma_f32_32x32x16_bf16 v[64:79], a[236:239], a[12:15], v[64:79]
  ds_read_b128 a[236:239], v27 offset:8192
  v_exp_f32 v57, v57
  v_add_f32 v39, v39, v55
  v_cvt_pk_bf16_f32 v48, v48, v49
  s_waitcnt lgkmcnt(6)
  v_mfma_f32_32x32x16_bf16 v[64:79], a[240:243], a[16:19], v[64:79]
  ds_read_b128 a[240:243], v28 offset:8192
  v_exp_f32 v58, v58
  v_add_f32 v39, v39, v56
  v_exp_f32 v59, v59
  v_mfma_f32_32x32x16_bf16 v[64:79], a[244:247], a[20:23], v[64:79]
  ds_read_b128 a[244:247], v29 offset:8192
  v_exp_f32 v60, v60
  v_exp_f32 v61, v61
  s_waitcnt lgkmcnt(6)
  v_mfma_f32_32x32x16_bf16 v[64:79], a[248:251], a[24:27], v[64:79]
  ds_read_b128 a[248:251], v30 offset:8192
  ds_write_b128 v7, a[96:99] offset:32768
  v_cvt_pk_bf16_f32 v49, v50, v51
  v_mfma_f32_32x32x16_bf16 v[64:79], a[252:255], a[28:31], v[64:79]
  ds_read_b128 a[252:255], v31 offset:8192
  s_xor_b32 s56, s44, 229376
  buffer_load_dwordx4 a[208:211], v8, s[12:15], s56 offen offset:0 nt
  s_waitcnt lgkmcnt(7)
  v_mfma_f32_32x32x16_bf16 v[80:95], a[224:227], a[0:3], 0
  ds_read_b128 a[224:227], v24 offset:16384
  ds_write_b128 v7, a[100:103] offset:33792
  v_add_f32 v39, v39, v57
  v_mfma_f32_32x32x16_bf16 v[80:95], a[228:231], a[4:7], v[80:95]
  ds_read_b128 a[228:231], v25 offset:16384
  v_exp_f32 v62, v62
  v_exp_f32 v63, v63
  s_waitcnt lgkmcnt(8)
  v_mfma_f32_32x32x16_bf16 v[80:95], a[232:235], a[8:11], v[80:95]
  ds_read_b128 a[232:235], v26 offset:16384
  ds_write_b128 v7, a[104:107] offset:34816
  v_cvt_pk_bf16_f32 v50, v52, v53
  v_mfma_f32_32x32x16_bf16 v[80:95], a[236:239], a[12:15], v[80:95]
  ds_read_b128 a[236:239], v27 offset:16384
  v_cvt_pk_bf16_f32 v51, v54, v55
  v_add_f32 v39, v39, v58
  v_cvt_pk_bf16_f32 v52, v56, v57
  v_cvt_pk_bf16_f32 v53, v58, v59
  s_waitcnt lgkmcnt(9)
  v_mfma_f32_32x32x16_bf16 v[80:95], a[240:243], a[16:19], v[80:95]
  ds_read_b128 a[240:243], v28 offset:16384
  ds_write_b128 v7, a[108:111] offset:35840
  v_cvt_pk_bf16_f32 v54, v60, v61
  v_mfma_f32_32x32x16_bf16 v[80:95], a[244:247], a[20:23], v[80:95]
  ds_read_b128 a[244:247], v29 offset:16384
  buffer_load_dwordx4 a[212:215], v9, s[12:15], s56 offen offset:1024 nt
  v_cvt_pk_bf16_f32 v55, v62, v63
  s_waitcnt lgkmcnt(9)
  v_mfma_f32_32x32x16_bf16 v[80:95], a[248:251], a[24:27], v[80:95]
  ds_read_b128 a[248:251], v30 offset:16384
  ds_write_b128 v7, a[112:115] offset:36864
  v_add_f32 v39, v39, v59
  v_mfma_f32_32x32x16_bf16 v[80:95], a[252:255], a[28:31], v[80:95]
  ds_read_b128 a[252:255], v31 offset:16384
  ds_write_b128 v37, v[48:51] offset:0
  s_waitcnt lgkmcnt(10)
  v_mfma_f32_32x32x16_bf16 v[96:111], a[224:227], a[0:3], 0
  ds_read_b128 a[224:227], v24 offset:24576
  ds_write_b128 v7, a[116:119] offset:37888
  v_add_f32 v39, v39, v60
  v_mfma_f32_32x32x16_bf16 v[96:111], a[228:231], a[4:7], v[96:111]
  ds_read_b128 a[228:231], v25 offset:24576
  ds_write_b128 v37, v[52:55] offset:1024
  s_waitcnt lgkmcnt(11)
  v_mfma_f32_32x32x16_bf16 v[96:111], a[232:235], a[8:11], v[96:111]
  ds_read_b128 a[232:235], v26 offset:24576
  ds_write_b128 v7, a[120:123] offset:38912
  v_add_f32 v39, v39, v61
  v_mfma_f32_32x32x16_bf16 v[96:111], a[236:239], a[12:15], v[96:111]
  ds_read_b128 a[236:239], v27 offset:24576
  buffer_load_dwordx4 a[216:219], v10, s[12:15], s56 offen offset:2048 nt
  v_add_f32 v39, v39, v62
  s_waitcnt lgkmcnt(11)
  v_mfma_f32_32x32x16_bf16 v[96:111], a[240:243], a[16:19], v[96:111]
  s_waitcnt vmcnt(23)
  ds_write_b128 v7, a[124:127] offset:39936
  ds_read_b128 a[240:243], v28 offset:24576
  v_mfma_f32_32x32x16_bf16 v[96:111], a[244:247], a[20:23], v[96:111]
  ds_read_b128 a[244:247], v29 offset:24576
  v_add_f32 v39, v39, v63
  v_exp_f32 v241, v241
  s_waitcnt lgkmcnt(11)
  v_mfma_f32_32x32x16_bf16 v[96:111], a[248:251], a[24:27], v[96:111]
  ds_read_b128 a[248:251], v30 offset:24576
  v_exp_f32 v242, v242
  v_exp_f32 v243, v243
  v_add_f32 v38, v240, v241
  v_mfma_f32_32x32x16_bf16 v[96:111], a[252:255], a[28:31], v[96:111]
  ds_read_b128 a[252:255], v31 offset:24576
  s_waitcnt lgkmcnt(4)
  s_barrier
L_RS3:
  v_add_f32 v38, v38, v242
  v_mfma_f32_32x32x16_bf16 v[112:127], a[224:227], a[0:3], 0
  ds_read_b128 a[224:227], v32 offset:32768
  v_exp_f32 v244, v244
  v_exp_f32 v245, v245
  v_add_f32 v38, v38, v243
  v_mfma_f32_32x32x16_bf16 v[112:127], a[228:231], a[4:7], v[112:127]
  ds_read_b128 a[228:231], v36 offset:24576
  v_exp_f32 v246, v246
  v_add_f32 v38, v38, v244
  v_exp_f32 v247, v247
  v_mfma_f32_32x32x16_bf16 v[112:127], a[232:235], a[8:11], v[112:127]
  ds_read_b128 a[232:235], v33 offset:32768
  buffer_load_dwordx4 a[220:223], v11, s[12:15], s56 offen offset:3072 nt
  v_add_f32 v38, v38, v245
  v_add_f32 v38, v38, v246
  v_mfma_f32_32x32x16_bf16 v[112:127], a[236:239], a[12:15], v[112:127]
  ds_read_b128 a[236:239], v36 offset:25600
  v_exp_f32 v248, v248
  v_exp_f32 v249, v249
  s_waitcnt lgkmcnt(6)
  v_mfma_f32_32x32x16_bf16 v[112:127], a[240:243], a[16:19], v[112:127]
  ds_read_b128 a[240:243], v34 offset:32768
  v_add_f32 v38, v38, v247
  v_exp_f32 v250, v250
  v_add_f32 v38, v38, v248
  v_add_f32 v38, v38, v249
  v_mfma_f32_32x32x16_bf16 v[112:127], a[244:247], a[20:23], v[112:127]
  ds_read_b128 a[244:247], v36 offset:26624
  v_exp_f32 v251, v251
  v_exp_f32 v252, v252
  s_waitcnt lgkmcnt(6)
  v_mfma_f32_32x32x16_bf16 v[112:127], a[248:251], a[24:27], v[112:127]
  ds_read_b128 a[248:251], v35 offset:32768
  v_add_f32 v38, v38, v250
  v_exp_f32 v253, v253
  v_add_f32 v38, v38, v251
  v_add_f32 v38, v38, v252
  v_mfma_f32_32x32x16_bf16 v[112:127], a[252:255], a[28:31], v[112:127]
  ds_read_b128 a[252:255], v36 offset:27648
  v_exp_f32 v254, v254
  s_cbranch_vccnz L_fix2
L_ret2:
  s_waitcnt lgkmcnt(4)
  v_mfma_f32_32x32x16_bf16 v[128:143], a[224:227], a[228:231], v[128:143]
  ds_read_b128 a[224:227], v32 offset:33280
  ds_read_b128 a[228:231], v36 offset:28672
  s_barrier
  v_exp_f32 v255, v255
  v_mfma_f32_32x32x16_bf16 v[128:143], a[232:235], a[236:239], v[128:143]
  ds_read_b128 a[232:235], v33 offset:33280
  ds_read_b128 a[236:239], v36 offset:29696
  s_add_u32 m0, s42, 0
  s_xor_b32 s55, s44, 196864
  buffer_load_dwordx4 v8, s[12:15], s55 offen offset:0 nt lds
  s_waitcnt lgkmcnt(6)
  v_mfma_f32_32x32x16_bf16 v[128:143], a[240:243], a[244:247], v[128:143]
  ds_read_b128 a[240:243], v34 offset:33280
  ds_read_b128 a[244:247], v36 offset:30720
  s_lshl_b32 s98, s32, 12
  s_add_u32 s98, s98, L_RS8-L_pc+0
  v_lshlrev_b32 v16, 6, v0
  v_add_u32 v16, s98, v16
  v_min_u32 v16, s95, v16
  s_waitcnt lgkmcnt(6)
  v_mfma_f32_32x32x16_bf16 v[128:143], a[248:251], a[252:255], v[128:143]
  ds_read_b128 a[248:251], v35 offset:33280
  ds_read_b128 a[252:255], v36 offset:31744
  v_mov_b32 v17, s97
  v_add_co_u32 v16, s[98:99], s96, v16
  s_nop 1
  v_addc_co_u32 v17, s[98:99], 0, v17, s[98:99]
  global_load_dword v16, v[16:17], off
  s_waitcnt lgkmcnt(6)
  v_mfma_f32_32x32x16_bf16 v[128:143], a[224:227], a[228:231], v[128:143]
  ds_read_b128 a[224:227], v24 offset:32768
  ds_read_b128 a[228:231], v25 offset:32768
  v_add_f32 v38, v38, v253
  v_add_f32 v38, v38, v254
  v_add_f32 v38, v38, v255
  s_waitcnt lgkmcnt(6)
  v_mfma_f32_32x32x16_bf16 v[128:143], a[232:235], a[236:239], v[128:143]
  ds_read_b128 a[232:235], v26 offset:32768
  ds_read_b128 a[236:239], v27 offset:32768
  v_exp_f32 v224, v224
  v_cvt_pk_bf16_f32 v240, v240, v241
  s_waitcnt lgkmcnt(6)
  v_mfma_f32_32x32x16_bf16 v[128:143], a[240:243], a[244:247], v[128:143]
  ds_read_b128 a[240:243], v28 offset:32768
  ds_read_b128 a[244:247], v29 offset:32768
  v_exp_f32 v225, v225
  v_add_f32 v38, v38, v224
  s_waitcnt lgkmcnt(6)
  v_mfma_f32_32x32x16_bf16 v[128:143], a[248:251], a[252:255], v[128:143]
  ds_read_b128 a[248:251], v30 offset:32768
  ds_read_b128 a[252:255], v31 offset:32768
  v_exp_f32 v226, v226
  v_add_f32 v38, v38, v225
  s_waitcnt lgkmcnt(6)
  v_mfma_f32_32x32x16_bf16 v[64:79], a[224:227], a[32:35], v[64:79]
  buffer_load_dwordx4 v9, s[12:15], s55 offen offset:1024 nt lds
  ds_read_b128 a[224:227], v24 offset:40960
  v_add_f32 v38, v38, v226
  v_mfma_f32_32x32x16_bf16 v[64:79], a[228:231], a[36:39], v[64:79]
  ds_read_b128 a[228:231], v25 offset:40960
  v_exp_f32 v227, v227
  v_exp_f32 v228, v228
  s_waitcnt lgkmcnt(6)
  v_mfma_f32_32x32x16_bf16 v[64:79], a[232:235], a[40:43], v[64:79]
  ds_read_b128 a[232:235], v26 offset:40960
  v_exp_f32 v229, v229
  v_add_f32 v38, v38, v227
  v_exp_f32 v230, v230
  v_mfma_f32_32x32x16_bf16 v[64:79], a[236:239], a[44:47], v[64:79]
  ds_read_b128 a[236:239], v27 offset:40960
  v_add_f32 v38, v38, v228
  v_exp_f32 v231, v231
  v_add_f32 v38, v38, v229
  s_waitcnt lgkmcnt(6)
  v_mfma_f32_32x32x16_bf16 v[64:79], a[240:243], a[48:51], v[64:79]
  ds_read_b128 a[240:243], v28 offset:40960
  v_exp_f32 v232, v232
  v_add_f32 v38, v38, v230
  v_exp_f32 v233, v233
  v_mfma_f32_32x32x16_bf16 v[64:79], a[244:247], a[52:55], v[64:79]
  ds_read_b128 a[244:247], v29 offset:40960
  buffer_load_dwordx4 v10, s[12:15], s55 offen offset:2048 nt lds
  s_waitcnt lgkmcnt(6)
  v_mfma_f32_32x32x16_bf16 v[64:79], a[248:251], a[56:59], v[64:79]
  ds_read_b128 a[248:251], v30 offset:40960
  s_waitcnt vmcnt(27)
  ds_write_b128 v7, a[128:131] offset:0
  v_mfma_f32_32x32x16_bf16 v[64:79], a[252:255], a[60:63], v[64:79]
  ds_read_b128 a[252:255], v31 offset:40960
  v_add_f32 v38, v38, v231
  v_exp_f32 v234, v234
  v_add_f32 v38, v38, v232
  s_waitcnt lgkmcnt(7)
  v_mfma_f32_32x32x16_bf16 v[80:95], a[224:227], a[32:35], v[80:95]
  ds_read_b128 a[224:227], v24 offset:49152
  s_waitcnt vmcnt(25)
  ds_write_b128 v7, a[132:135] offset:1024
  v_mfma_f32_32x32x16_bf16 v[80:95], a[228:231], a[36:39], v[80:95]
  ds_read_b128 a[228:231], v25 offset:49152
  v_exp_f32 v235, v235
  v_add_f32 v38, v38, v233
  v_add_f32 v38, v38, v234
  s_waitcnt lgkmcnt(8)
  v_mfma_f32_32x32x16_bf16 v[80:95], a[232:235], a[40:43], v[80:95]
  ds_read_b128 a[232:235], v26 offset:49152
  s_waitcnt vmcnt(23)
  ds_write_b128 v7, a[136:139] offset:2048
  v_mfma_f32_32x32x16_bf16 v[80:95], a[236:239], a[44:47], v[80:95]
  ds_read_b128 a[236:239], v27 offset:49152
  v_exp_f32 v236, v236
  v_exp_f32 v237, v237
  s_waitcnt lgkmcnt(9)
  v_mfma_f32_32x32x16_bf16 v[80:95], a[240:243], a[48:51], v[80:95]
  ds_read_b128 a[240:243], v28 offset:49152
  s_waitcnt vmcnt(21)
  ds_write_b128 v7, a[140:143] offset:3072
  v_mfma_f32_32x32x16_bf16 v[80:95], a[244:247], a[52:55], v[80:95]
  ds_read_b128 a[244:247], v29 offset:49152
  buffer_load_dwordx4 v11, s[12:15], s55 offen offset:3072 nt lds
  s_waitcnt lgkmcnt(9)
  v_mfma_f32_32x32x16_bf16 v[80:95], a[248:251], a[56:59], v[80:95]
  ds_read_b128 a[248:251], v30 offset:49152
  s_waitcnt vmcnt(20)
  ds_write_b128 v7, a[144:147] offset:4096
  v_mfma_f32_32x32x16_bf16 v[80:95], a[252:255], a[60:63], v[80:95]
  ds_read_b128 a[252:255], v31 offset:49152
  v_add_f32 v38, v38, v235
  v_cvt_pk_bf16_f32 v241, v242, v243
  v_exp_f32 v238, v238
  s_waitcnt lgkmcnt(9)
  v_mfma_f32_32x32x16_bf16 v[96:111], a[224:227], a[32:35], v[96:111]
  ds_read_b128 a[224:227], v24 offset:57344
  s_waitcnt vmcnt(18)
  ds_write_b128 v7, a[148:151] offset:5120
  v_mfma_f32_32x32x16_bf16 v[96:111], a[228:231], a[36:39], v[96:111]
  ds_read_b128 a[228:231], v25 offset:57344
  v_add_f32 v38, v38, v236
  v_cvt_pk_bf16_f32 v242, v244, v245
  v_cvt_pk_bf16_f32 v243, v246, v247
  v_add_f32 v38, v38, v237
  s_waitcnt lgkmcnt(9)
  v_mfma_f32_32x32x16_bf16 v[96:111], a[232:235], a[40:43], v[96:111]
  ds_read_b128 a[232:235], v26 offset:57344
  s_waitcnt vmcnt(16)
  ds_write_b128 v7, a[152:155] offset:6144
  v_mfma_f32_32x32x16_bf16 v[96:111], a[236:239], a[44:47], v[96:111]
  ds_read_b128 a[236:239], v27 offset:57344
  v_exp_f32 v239, v239
  v_cvt_pk_bf16_f32 v244, v248, v249
  v_cvt_pk_bf16_f32 v245, v250, v251
  s_waitcnt lgkmcnt(9)
  v_mfma_f32_32x32x16_bf16 v[96:111], a[240:243], a[48:51], v[96:111]
  s_waitcnt vmcnt(14)
  ds_write_b128 v7, a[156:159] offset:7168
  ds_read_b128 a[240:243], v28 offset:57344
  s_add_u32 m0, s42, 4096
  s_xor_b32 s55, s44, 229632
  buffer_load_dwordx4 v8, s[12:15], s55 offen offset:0 nt lds
  v_mfma_f32_32x32x16_bf16 v[96:111], a[244:247], a[52:55], v[96:111]
  ds_read_b128 a[244:247], v29 offset:57344
  v_cvt_pk_bf16_f32 v246, v252, v253
  v_cvt_pk_bf16_f32 v247, v254, v255
  v_add_f32 v38, v38, v238
  v_add_f32 v38, v38, v239
  s_waitcnt lgkmcnt(9)
  v_mfma_f32_32x32x16_bf16 v[96:111], a[248:251], a[56:59], v[96:111]
  ds_read_b128 a[248:251], v30 offset:57344
  v_cvt_pk_bf16_f32 v248, v224, v225
  v_cvt_pk_bf16_f32 v249, v226, v227
  v_cvt_pk_bf16_f32 v250, v228, v229
  v_cvt_pk_bf16_f32 v251, v230, v231
  v_cvt_pk_bf16_f32 v252, v232, v233
  v_mfma_f32_32x32x16_bf16 v[96:111], a[252:255], a[60:63], v[96:111]
  ds_read_b128 a[252:255], v31 offset:57344
  s_waitcnt lgkmcnt(4)
  s_barrier
L_RS4:
  v_cvt_pk_bf16_f32 v253, v234, v235
  v_mfma_f32_32x32x16_bf16 v[112:127], a[224:227], a[32:35], v[112:127]
  ds_read_b128 a[224:227], v32 offset:0
  v_cvt_pk_bf16_f32 v254, v236, v237
  v_cvt_pk_bf16_f32 v255, v238, v239
  s_cbranch_vccnz L_fix3
L_ret3:
  s_waitcnt vmcnt(4)
  v_lshrrev_b32 v16, 1, v47
  v_mfma_f32_32x32x16_bf16 v[112:127], a[228:231], a[36:39], v[112:127]
  ds_read_b128 a[228:231], v36 offset:16384
  buffer_load_dwordx4 v9, s[12:15], s55 offen offset:1024 nt lds
  v_lshl_add_u32 v16, v16, 6, v46
  v_mfma_f32_32x32x16_bf16 v[112:127], a[232:235], a[40:43], v[112:127]
  ds_read_b128 a[232:235], v33 offset:0
  v_exp_f32 v176, v176
  v_exp_f32 v177, v177
  v_add_f32 v38, v38, v176
  v_mfma_f32_32x32x16_bf16 v[112:127], a[236:239], a[44:47], v[112:127]
  ds_read_b128 a[236:239], v36 offset:17408
  v_exp_f32 v178, v178
  v_exp_f32 v179, v179
  s_waitcnt lgkmcnt(6)
  v_mfma_f32_32x32x16_bf16 v[112:127], a[240:243], a[48:51], v[112:127]
  ds_read_b128 a[240:243], v34 offset:0
  v_add_f32 v38, v38, v177
  v_exp_f32 v180, v180
  v_add_f32 v38, v38, v178
  v_add_f32 v38, v38, v179
  v_mfma_f32_32x32x16_bf16 v[112:127], a[244:247], a[52:55], v[112:127]
  ds_read_b128 a[244:247], v36 offset:18432
  v_exp_f32 v181, v181
  v_exp_f32 v182, v182
  s_waitcnt lgkmcnt(6)
  v_mfma_f32_32x32x16_bf16 v[112:127], a[248:251], a[56:59], v[112:127]
  ds_read_b128 a[248:251], v35 offset:0
  v_add_f32 v38, v38, v180
  v_exp_f32 v183, v183
  v_add_f32 v38, v38, v181
  v_add_f32 v38, v38, v182
  v_mfma_f32_32x32x16_bf16 v[112:127], a[252:255], a[60:63], v[112:127]
  ds_read_b128 a[252:255], v36 offset:19456
  v_exp_f32 v184, v184
  v_exp_f32 v185, v185
  s_waitcnt lgkmcnt(4)
  v_mfma_f32_32x32x16_bf16 v[48:63], a[224:227], a[228:231], 0
  ds_read_b128 a[224:227], v32 offset:512
  ds_read_b128 a[228:231], v36 offset:20480
  buffer_load_dwordx4 v10, s[12:15], s55 offen offset:2048 nt lds
  v_mfma_f32_32x32x16_bf16 v[48:63], a[232:235], a[236:239], v[48:63]
  ds_read_b128 a[232:235], v33 offset:512
  ds_read_b128 a[236:239], v36 offset:21504
  s_barrier
  s_lshl_b32 s36, s33, 2
  s_waitcnt lgkmcnt(6)
  v_mfma_f32_32x32x16_bf16 v[48:63], a[240:243], a[244:247], v[48:63]
  ds_read_b128 a[240:243], v34 offset:512
  ds_read_b128 a[244:247], v36 offset:22528
  s_add_u32 s36, s36, s32
  s_lshl_b32 s36, s36, 12
  v_lshlrev_b32 v18, 6, v0
  s_waitcnt lgkmcnt(6)
  v_mfma_f32_32x32x16_bf16 v[48:63], a[248:251], a[252:255], v[48:63]
  ds_read_b128 a[248:251], v35 offset:512
  ds_read_b128 a[252:255], v36 offset:23552
  v_add_u32 v18, s36, v18
  v_add_f32 v38, v38, v183
  v_add_f32 v38, v38, v184
  s_waitcnt lgkmcnt(6)
  v_mfma_f32_32x32x16_bf16 v[48:63], a[224:227], a[228:231], v[48:63]
  ds_read_b128 a[224:227], v24 offset:0
  ds_read_b128 a[228:231], v25 offset:0
  v_exp_f32 v186, v186
  v_add_f32 v38, v38, v185
  s_waitcnt lgkmcnt(6)
  v_mfma_f32_32x32x16_bf16 v[48:63], a[232:235], a[236:239], v[48:63]
  ds_read_b128 a[232:235], v26 offset:0
  ds_read_b128 a[236:239], v27 offset:0
  v_exp_f32 v187, v187
  v_add_f32 v38, v38, v186
  s_waitcnt lgkmcnt(6)
  v_mfma_f32_32x32x16_bf16 v[48:63], a[240:243], a[244:247], v[48:63]
  ds_read_b128 a[240:243], v28 offset:0
  ds_read_b128 a[244:247], v29 offset:0
  v_exp_f32 v188, v188
  v_add_f32 v38, v38, v187
  s_waitcnt lgkmcnt(6)
  v_mfma_f32_32x32x16_bf16 v[48:63], a[248:251], a[252:255], v[48:63]
  ds_read_b128 a[248:251], v30 offset:0
  buffer_load_dwordx4 v11, s[12:15], s55 offen offset:3072 nt lds
  s_waitcnt lgkmcnt(5)
  v_mfma_f32_32x32x16_bf16 v[144:159], a[224:227], a[0:3], 0
  ds_read_b128 a[252:255], v31 offset:0
  ds_read_b128 a[224:227], v24 offset:8192
  buffer_load_dword v18, v18, s[24:27], 0 offen
  v_mfma_f32_32x32x16_bf16 v[144:159], a[228:231], a[4:7], v[144:159]
  ds_read_b128 a[228:231], v25 offset:8192
  v_exp_f32 v189, v189
  v_exp_f32 v190, v190
  s_waitcnt lgkmcnt(6)
  v_mfma_f32_32x32x16_bf16 v[144:159], a[232:235], a[8:11], v[144:159]
  ds_read_b128 a[232:235], v26 offset:8192
  v_add_f32 v38, v38, v188
  s_cbranch_vccnz L_fix4
L_ret4:
  v_exp_f32 v191, v191
  v_mfma_f32_32x32x16_bf16 v[144:159], a[236:239], a[12:15], v[144:159]
  ds_read_b128 a[236:239], v27 offset:8192
  v_add_f32 v38, v38, v189
  v_add_f32 v38, v38, v190
  v_exp_f32 v208, v208
  s_waitcnt lgkmcnt(6)
  v_mfma_f32_32x32x16_bf16 v[144:159], a[240:243], a[16:19], v[144:159]
  ds_read_b128 a[240:243], v28 offset:8192
  v_add_f32 v38, v38, v191
  v_exp_f32 v209, v209
  v_exp_f32 v210, v210
  v_mfma_f32_32x32x16_bf16 v[144:159], a[244:247], a[20:23], v[144:159]
  ds_read_b128 a[244:247], v29 offset:8192
  v_add_f32 v38, v38, v208
  v_exp_f32 v211, v211
  v_add_f32 v38, v38, v209
  s_waitcnt lgkmcnt(6)
  v_mfma_f32_32x32x16_bf16 v[144:159], a[248:251], a[24:27], v[144:159]
  ds_read_b128 a[248:251], v30 offset:8192
  s_add_u32 m0, s42, 98304
  s_xor_b32 s55, s44, 0
  buffer_load_dwordx4 v2, s[16:19], s55 offen offset:0 nt lds
  ds_write_b128 v7, a[160:163] offset:32768
  v_mfma_f32_32x32x16_bf16 v[144:159], a[252:255], a[28:31], v[144:159]
  ds_read_b128 a[252:255], v31 offset:8192
  v_exp_f32 v212, v212
  v_add_f32 v38, v38, v210
  v_add_f32 v38, v38, v211
  s_waitcnt lgkmcnt(7)
  v_mfma_f32_32x32x16_bf16 v[160:175], a[224:227], a[0:3], 0
  ds_read_b128 a[224:227], v24 offset:16384
  ds_write_b128 v7, a[164:167] offset:33792
  v_add_f32 v38, v38, v212
  v_mfma_f32_32x32x16_bf16 v[160:175], a[228:231], a[4:7], v[160:175]
  ds_read_b128 a[228:231], v25 offset:16384
  v_exp_f32 v213, v213
  v_exp_f32 v214, v214
  s_waitcnt lgkmcnt(8)
  v_mfma_f32_32x32x16_bf16 v[160:175], a[232:235], a[8:11], v[160:175]
  ds_read_b128 a[232:235], v26 offset:16384
  ds_write_b128 v7, a[168:171] offset:34816
  v_add_f32 v38, v38, v213
  v_mfma_f32_32x32x16_bf16 v[160:175], a[236:239], a[12:15], v[160:175]
  ds_read_b128 a[236:239], v27 offset:16384
  v_exp_f32 v215, v215
  v_exp_f32 v216, v216
  s_waitcnt lgkmcnt(9)
  v_mfma_f32_32x32x16_bf16 v[160:175], a[240:243], a[16:19], v[160:175]
  ds_read_b128 a[240:243], v28 offset:16384
  ds_write_b128 v7, a[172:175] offset:35840
  v_add_f32 v38, v38, v214
  v_mfma_f32_32x32x16_bf16 v[160:175], a[244:247], a[20:23], v[160:175]
  ds_read_b128 a[244:247], v29 offset:16384
  buffer_load_dwordx4 v3, s[16:19], s55 offen offset:1024 nt lds
  s_waitcnt lgkmcnt(9)
  v_mfma_f32_32x32x16_bf16 v[160:175], a[248:251], a[24:27], v[160:175]
  ds_read_b128 a[248:251], v30 offset:16384
  ds_write_b128 v7, a[176:179] offset:36864
  v_add_f32 v38, v38, v215
  v_mfma_f32_32x32x16_bf16 v[160:175], a[252:255], a[28:31], v[160:175]
  ds_read_b128 a[252:255], v31 offset:16384
  v_exp_f32 v217, v217
  v_exp_f32 v218, v218
  s_waitcnt lgkmcnt(9)
  v_mfma_f32_32x32x16_bf16 v[192:207], a[224:227], a[0:3], 0
  ds_read_b128 a[224:227], v24 offset:24576
  ds_write_b128 v7, a[180:183] offset:37888
  v_add_f32 v38, v38, v216
  v_mfma_f32_32x32x16_bf16 v[192:207], a[228:231], a[4:7], v[192:207]
  ds_read_b128 a[228:231], v25 offset:24576
  v_exp_f32 v219, v219
  v_add_f32 v38, v38, v217
  v_add_f32 v38, v38, v218
  s_waitcnt lgkmcnt(9)
  v_mfma_f32_32x32x16_bf16 v[192:207], a[232:235], a[8:11], v[192:207]
  ds_read_b128 a[232:235], v26 offset:24576
  ds_write_b128 v7, a[184:187] offset:38912
  v_cvt_pk_bf16_f32 v176, v176, v177
  v_mfma_f32_32x32x16_bf16 v[192:207], a[236:239], a[12:15], v[192:207]
  ds_read_b128 a[236:239], v27 offset:24576
  buffer_load_dwordx4 v4, s[16:19], s55 offen offset:2048 nt lds
  s_waitcnt lgkmcnt(9)
  v_mfma_f32_32x32x16_bf16 v[192:207], a[240:243], a[16:19], v[192:207]
  ds_write_b128 v7, a[188:191] offset:39936
  ds_read_b128 a[240:243], v28 offset:24576
  v_add_f32 v38, v38, v219
  v_mfma_f32_32x32x16_bf16 v[192:207], a[244:247], a[20:23], v[192:207]
  ds_read_b128 a[244:247], v29 offset:24576
  v_exp_f32 v220, v220
  v_exp_f32 v221, v221
  s_waitcnt lgkmcnt(9)
  v_mfma_f32_32x32x16_bf16 v[192:207], a[248:251], a[24:27], v[192:207]
  ds_read_b128 a[248:251], v30 offset:24576
  v_cvt_pk_bf16_f32 v177, v178, v179
  v_exp_f32 v222, v222
  v_add_f32 v38, v38, v220
  v_cvt_pk_bf16_f32 v178, v180, v181
  v_mfma_f32_32x32x16_bf16 v[192:207], a[252:255], a[28:31], v[192:207]
  ds_read_b128 a[252:255], v31 offset:24576
  s_waitcnt lgkmcnt(4)
  s_barrier
L_RS5:
  v_cvt_pk_bf16_f32 v179, v182, v183
  v_mfma_f32_32x32x16_bf16 v[224:239], a[224:227], a[0:3], 0
  ds_read_b128 a[224:227], v32 offset:32768
  v_exp_f32 v223, v223
  v_add_f32 v38, v38, v221
  v_cvt_pk_bf16_f32 v180, v184, v185
  v_cvt_pk_bf16_f32 v181, v186, v187
  v_mfma_f32_32x32x16_bf16 v[224:239], a[228:231], a[4:7], v[224:239]
  ds_read_b128 a[228:231], v36 offset:24576
  buffer_load_dwordx4 v5, s[16:19], s55 offen offset:3072 nt lds
  v_cvt_pk_bf16_f32 v182, v188, v189
  v_mfma_f32_32x32x16_bf16 v[224:239], a[232:235], a[8:11], v[224:239]
  ds_read_b128 a[232:235], v33 offset:32768
  v_cvt_pk_bf16_f32 v183, v190, v191
  v_add_f32 v38, v38, v222
  v_add_f32 v38, v38, v223
  v_cvt_pk_bf16_f32 v184, v208, v209
  v_cvt_pk_bf16_f32 v185, v210, v211
  v_mfma_f32_32x32x16_bf16 v[224:239], a[236:239], a[12:15], v[224:239]
  ds_read_b128 a[236:239], v36 offset:25600
  v_cvt_pk_bf16_f32 v186, v212, v213
  v_cvt_pk_bf16_f32 v187, v214, v215
  v_cvt_pk_bf16_f32 v188, v216, v217
  v_cvt_pk_bf16_f32 v189, v218, v219
  s_waitcnt lgkmcnt(6)
  v_mfma_f32_32x32x16_bf16 v[224:239], a[240:243], a[16:19], v[224:239]
  ds_read_b128 a[240:243], v34 offset:32768
  v_cvt_pk_bf16_f32 v190, v220, v221
  v_cvt_pk_bf16_f32 v191, v222, v223
  s_cbranch_vccnz L_fix5
L_ret5:
  s_lshl_b32 s36, s32, 12
  v_mfma_f32_32x32x16_bf16 v[224:239], a[244:247], a[20:23], v[224:239]
  ds_read_b128 a[244:247], v36 offset:26624
  v_exp_f32 v128, v128
  v_exp_f32 v129, v129
  s_waitcnt lgkmcnt(6)
  v_mfma_f32_32x32x16_bf16 v[224:239], a[248:251], a[24:27], v[224:239]
  ds_read_b128 a[248:251], v35 offset:32768
  v_exp_f32 v130, v130
  v_add_f32 v39, v39, v128
  v_exp_f32 v131, v131
  v_mfma_f32_32x32x16_bf16 v[224:239], a[252:255], a[28:31], v[224:239]
  ds_read_b128 a[252:255], v36 offset:27648
  v_add_f32 v39, v39, v129
  v_exp_f32 v132, v132
  v_add_f32 v39, v39, v130
  s_waitcnt lgkmcnt(4)
  v_mfma_f32_32x32x16_bf16 v[48:63], a[224:227], a[228:231], v[48:63]
  ds_read_b128 a[224:227], v32 offset:33280
  ds_read_b128 a[228:231], v36 offset:28672
  s_add_u32 m0, s42, 102400
  s_xor_b32 s55, s44, 32768
  buffer_load_dwordx4 v2, s[16:19], s55 offen offset:0 nt lds
  v_mfma_f32_32x32x16_bf16 v[48:63], a[232:235], a[236:239], v[48:63]
  ds_read_b128 a[232:235], v33 offset:33280
  ds_read_b128 a[236:239], v36 offset:29696
  s_barrier
  v_add_f32 v39, v39, v131
  s_waitcnt lgkmcnt(6)
  v_mfma_f32_32x32x16_bf16 v[48:63], a[240:243], a[244:247], v[48:63]
  ds_read_b128 a[240:243], v34 offset:33280
  ds_read_b128 a[244:247], v36 offset:30720
  v_exp_f32 v133, v133
  v_add_f32 v39, v39, v132
  s_waitcnt lgkmcnt(6)
  v_mfma_f32_32x32x16_bf16 v[48:63], a[248:251], a[252:255], v[48:63]
  ds_read_b128 a[248:251], v35 offset:33280
  ds_read_b128 a[252:255], v36 offset:31744
  v_exp_f32 v134, v134
  v_add_f32 v39, v39, v133
  s_waitcnt lgkmcnt(6)
  v_mfma_f32_32x32x16_bf16 v[48:63], a[224:227], a[228:231], v[48:63]
  ds_read_b128 a[224:227], v24 offset:32768
  ds_read_b128 a[228:231], v25 offset:32768
  v_exp_f32 v135, v135
  v_add_f32 v39, v39, v134
  s_waitcnt lgkmcnt(6)
  v_mfma_f32_32x32x16_bf16 v[48:63], a[232:235], a[236:239], v[48:63]
  ds_read_b128 a[232:235], v26 offset:32768
  ds_read_b128 a[236:239], v27 offset:32768
  v_exp_f32 v136, v136
  v_add_f32 v39, v39, v135
  s_waitcnt lgkmcnt(6)
  v_mfma_f32_32x32x16_bf16 v[48:63], a[240:243], a[244:247], v[48:63]
  ds_read_b128 a[240:243], v28 offset:32768
  ds_read_b128 a[244:247], v29 offset:32768
  v_exp_f32 v137, v137
  v_cvt_pk_bf16_f32 v128, v128, v129
  s_waitcnt lgkmcnt(6)
  v_mfma_f32_32x32x16_bf16 v[48:63], a[248:251], a[252:255], v[48:63]
  ds_read_b128 a[248:251], v30 offset:32768
  buffer_load_dwordx4 v3, s[16:19], s55 offen offset:1024 nt lds
  s_waitcnt lgkmcnt(5)
  v_mfma_f32_32x32x16_bf16 v[144:159], a[224:227], a[32:35], v[144:159]
  ds_read_b128 a[252:255], v31 offset:32768
  ds_read_b128 a[224:227], v24 offset:40960
  v_exp_f32 v138, v138
  v_add_f32 v39, v39, v136
  v_cvt_pk_bf16_f32 v129, v130, v131
  v_mfma_f32_32x32x16_bf16 v[144:159], a[228:231], a[36:39], v[144:159]
  ds_read_b128 a[228:231], v25 offset:40960
  v_exp_f32 v139, v139
  v_exp_f32 v140, v140
  s_waitcnt lgkmcnt(6)
  v_mfma_f32_32x32x16_bf16 v[144:159], a[232:235], a[40:43], v[144:159]
  ds_read_b128 a[232:235], v26 offset:40960
  v_exp_f32 v141, v141
  v_exp_f32 v142, v142
  v_add_f32 v39, v39, v137
  v_mfma_f32_32x32x16_bf16 v[144:159], a[236:239], a[44:47], v[144:159]
  ds_read_b128 a[236:239], v27 offset:40960
  v_exp_f32 v143, v143
  v_cvt_pk_bf16_f32 v130, v132, v133
  v_cvt_pk_bf16_f32 v131, v134, v135
  s_waitcnt lgkmcnt(6)
  v_mfma_f32_32x32x16_bf16 v[144:159], a[240:243], a[48:51], v[144:159]
  ds_read_b128 a[240:243], v28 offset:40960
  v_add_f32 v39, v39, v138
  v_cvt_pk_bf16_f32 v132, v136, v137
  v_cvt_pk_bf16_f32 v133, v138, v139
  v_cvt_pk_bf16_f32 v134, v140, v141
  v_cvt_pk_bf16_f32 v135, v142, v143
  v_mfma_f32_32x32x16_bf16 v[144:159], a[244:247], a[52:55], v[144:159]
  ds_read_b128 a[244:247], v29 offset:40960
  buffer_load_dwordx4 v4, s[16:19], s55 offen offset:2048 nt lds
  s_waitcnt lgkmcnt(6)
  v_mfma_f32_32x32x16_bf16 v[144:159], a[248:251], a[56:59], v[144:159]
  ds_read_b128 a[248:251], v30 offset:40960
  ds_write_b128 v7, a[192:195] offset:0
  v_add_f32 v39, v39, v139
  v_mfma_f32_32x32x16_bf16 v[144:159], a[252:255], a[60:63], v[144:159]
  ds_read_b128 a[252:255], v31 offset:40960
  ds_write_b128 v37, v[128:131] offset:8192
  s_waitcnt lgkmcnt(8)
  v_mfma_f32_32x32x16_bf16 v[160:175], a[224:227], a[32:35], v[160:175]
  ds_read_b128 a[224:227], v24 offset:49152
  ds_write_b128 v7, a[196:199] offset:1024
  v_add_f32 v39, v39, v140
  v_mfma_f32_32x32x16_bf16 v[160:175], a[228:231], a[36:39], v[160:175]
  ds_read_b128 a[228:231], v25 offset:49152
  ds_write_b128 v37, v[132:135] offset:9216
  s_waitcnt lgkmcnt(10)
  v_mfma_f32_32x32x16_bf16 v[160:175], a[232:235], a[40:43], v[160:175]
  ds_read_b128 a[232:235], v26 offset:49152
  ds_write_b128 v7, a[200:203] offset:2048
  v_add_f32 v39, v39, v141
  v_mfma_f32_32x32x16_bf16 v[160:175], a[236:239], a[44:47], v[160:175]
  ds_read_b128 a[236:239], v27 offset:49152
  buffer_load_dwordx4 v5, s[16:19], s55 offen offset:3072 nt lds
  s_waitcnt lgkmcnt(11)
  v_mfma_f32_32x32x16_bf16 v[160:175], a[240:243], a[48:51], v[160:175]
  ds_read_b128 a[240:243], v28 offset:49152
  ds_write_b128 v7, a[204:207] offset:3072
  v_add_f32 v39, v39, v142
  v_mfma_f32_32x32x16_bf16 v[160:175], a[244:247], a[52:55], v[160:175]
  ds_read_b128 a[244:247], v29 offset:49152
  v_add_f32 v39, v39, v143
  s_cbranch_vccnz L_fix6
L_ret6:
  v_lshl_add_u32 v16, v43, 7, v16
  s_waitcnt lgkmcnt(11)
  v_mfma_f32_32x32x16_bf16 v[160:175], a[248:251], a[56:59], v[160:175]
  ds_read_b128 a[248:251], v30 offset:49152
  ds_write_b128 v7, a[208:211] offset:4096
  s_add_u32 s36, s36, s37
  v_mfma_f32_32x32x16_bf16 v[160:175], a[252:255], a[60:63], v[160:175]
  ds_read_b128 a[252:255], v31 offset:49152
  v_exp_f32 v64, v64
  v_exp_f32 v65, v65
  s_waitcnt lgkmcnt(10)
  v_mfma_f32_32x32x16_bf16 v[192:207], a[224:227], a[32:35], v[192:207]
  ds_read_b128 a[224:227], v24 offset:57344
  ds_write_b128 v7, a[212:215] offset:5120
  v_add_f32 v38, v38, v64
  v_mfma_f32_32x32x16_bf16 v[192:207], a[228:231], a[36:39], v[192:207]
  ds_read_b128 a[228:231], v25 offset:57344
  v_exp_f32 v66, v66
  v_exp_f32 v67, v67
  s_waitcnt lgkmcnt(9)
  v_mfma_f32_32x32x16_bf16 v[192:207], a[232:235], a[40:43], v[192:207]
  ds_read_b128 a[232:235], v26 offset:57344
  ds_write_b128 v7, a[216:219] offset:6144
  v_add_f32 v38, v38, v65
  v_mfma_f32_32x32x16_bf16 v[192:207], a[236:239], a[44:47], v[192:207]
  ds_read_b128 a[236:239], v27 offset:57344
  s_xor_b32 s56, s44, 65536
  buffer_load_dwordx4 a[64:67], v2, s[16:19], s56 offen offset:0 nt
  s_waitcnt lgkmcnt(9)
  v_mfma_f32_32x32x16_bf16 v[192:207], a[240:243], a[48:51], v[192:207]
  ds_write_b128 v7, a[220:223] offset:7168
  ds_read_b128 a[240:243], v28 offset:57344
  v_add_f32 v38, v38, v66
  v_mfma_f32_32x32x16_bf16 v[192:207], a[244:247], a[52:55], v[192:207]
  ds_read_b128 a[244:247], v29 offset:57344
  v_exp_f32 v68, v68
  v_exp_f32 v69, v69
  s_waitcnt lgkmcnt(9)
  v_mfma_f32_32x32x16_bf16 v[192:207], a[248:251], a[56:59], v[192:207]
  ds_read_b128 a[248:251], v30 offset:57344
  v_add_f32 v38, v38, v67
  v_exp_f32 v70, v70
  v_add_f32 v38, v38, v68
  v_add_f32 v38, v38, v69
  v_mfma_f32_32x32x16_bf16 v[192:207], a[252:255], a[60:63], v[192:207]
  ds_read_b128 a[252:255], v31 offset:57344
  s_waitcnt lgkmcnt(4)
  s_barrier
L_RS6:
  v_add_f32 v38, v38, v70
  v_mfma_f32_32x32x16_bf16 v[224:239], a[224:227], a[32:35], v[224:239]
  ds_read_b128 a[224:227], v32 offset:0
  buffer_load_dwordx4 a[68:71], v3, s[16:19], s56 offen offset:1024 nt
  v_exp_f32 v71, v71
  v_mfma_f32_32x32x16_bf16 v[224:239], a[228:231], a[36:39], v[224:239]
  ds_read_b128 a[228:231], v36 offset:16384
  v_exp_f32 v72, v72
  v_exp_f32 v73, v73
  v_add_f32 v38, v38, v71
  v_mfma_f32_32x32x16_bf16 v[224:239], a[232:235], a[40:43], v[224:239]
  ds_read_b128 a[232:235], v33 offset:0
  v_exp_f32 v74, v74
  v_add_f32 v38, v38, v72
  v_exp_f32 v75, v75
  v_mfma_f32_32x32x16_bf16 v[224:239], a[236:239], a[44:47], v[224:239]
  ds_read_b128 a[236:239], v36 offset:17408
  v_add_f32 v38, v38, v73
  v_exp_f32 v76, v76
  v_add_f32 v38, v38, v74
  s_waitcnt lgkmcnt(6)
  v_mfma_f32_32x32x16_bf16 v[224:239], a[240:243], a[48:51], v[224:239]
  ds_read_b128 a[240:243], v34 offset:0
  v_exp_f32 v77, v77
  v_add_f32 v38, v38, v75
  v_exp_f32 v78, v78
  v_mfma_f32_32x32x16_bf16 v[224:239], a[244:247], a[52:55], v[224:239]
  ds_read_b128 a[244:247], v36 offset:18432
  v_add_f32 v38, v38, v76
  s_cbranch_vccnz L_fix7
L_ret7:
  v_add_f32 v38, v38, v77
  s_waitcnt lgkmcnt(6)
  v_mfma_f32_32x32x16_bf16 v[224:239], a[248:251], a[56:59], v[224:239]
  ds_read_b128 a[248:251], v35 offset:0
  v_exp_f32 v79, v79
  v_add_f32 v38, v38, v78
  v_exp_f32 v80, v80
  v_mfma_f32_32x32x16_bf16 v[224:239], a[252:255], a[60:63], v[224:239]
  ds_read_b128 a[252:255], v36 offset:19456
  buffer_load_dwordx4 a[72:75], v4, s[16:19], s56 offen offset:2048 nt
  v_add_f32 v38, v38, v79
  s_waitcnt lgkmcnt(4)
  v_mfma_f32_32x32x16_bf16 v[208:223], a[224:227], a[228:231], 0
  ds_read_b128 a[224:227], v32 offset:512
  ds_read_b128 a[228:231], v36 offset:20480
  v_exp_f32 v81, v81
  v_exp_f32 v82, v82
  v_mfma_f32_32x32x16_bf16 v[208:223], a[232:235], a[236:239], v[208:223]
  ds_read_b128 a[232:235], v33 offset:512
  ds_read_b128 a[236:239], v36 offset:21504
  v_add_f32 v38, v38, v80
  v_exp_f32 v83, v83
  s_waitcnt lgkmcnt(6)
  v_mfma_f32_32x32x16_bf16 v[208:223], a[240:243], a[244:247], v[208:223]
  ds_read_b128 a[240:243], v34 offset:512
  ds_read_b128 a[244:247], v36 offset:22528
  v_add_f32 v38, v38, v81
  v_exp_f32 v84, v84
  s_waitcnt lgkmcnt(6)
  v_mfma_f32_32x32x16_bf16 v[208:223], a[248:251], a[252:255], v[208:223]
  ds_read_b128 a[248:251], v35 offset:512
  ds_read_b128 a[252:255], v36 offset:23552
  v_add_f32 v38, v38, v82
  v_exp_f32 v85, v85
  s_waitcnt lgkmcnt(6)
  v_mfma_f32_32x32x16_bf16 v[208:223], a[224:227], a[228:231], v[208:223]
  ds_read_b128 a[224:227], v24 offset:0
  ds_read_b128 a[228:231], v25 offset:0
  v_add_f32 v38, v38, v83
  v_exp_f32 v86, v86
  s_waitcnt lgkmcnt(6)
  v_mfma_f32_32x32x16_bf16 v[208:223], a[232:235], a[236:239], v[208:223]
  ds_read_b128 a[232:235], v26 offset:0
  ds_read_b128 a[236:239], v27 offset:0
  v_add_f32 v38, v38, v84
  v_exp_f32 v87, v87
  s_waitcnt lgkmcnt(6)
  v_mfma_f32_32x32x16_bf16 v[208:223], a[240:243], a[244:247], v[208:223]
  ds_read_b128 a[240:243], v28 offset:0
  ds_read_b128 a[244:247], v29 offset:0
  buffer_load_dwordx4 a[76:79], v5, s[16:19], s56 offen offset:3072 nt
  s_waitcnt lgkmcnt(6)
  v_mfma_f32_32x32x16_bf16 v[208:223], a[248:251], a[252:255], v[208:223]
  ds_read_b128 a[248:251], v30 offset:0
  ds_read_b128 a[252:255], v31 offset:0
  v_add_f32 v38, v38, v85
  v_exp_f32 v88, v88
  s_waitcnt lgkmcnt(6)
  v_mfma_f32_32x32x16_bf16 v[128:143], a[224:227], a[0:3], 0
  ds_read_b128 a[224:227], v24 offset:8192
  v_add_f32 v38, v38, v86
  v_exp_f32 v89, v89
  v_add_f32 v38, v38, v87
  v_add_f32 v38, v38, v88
  v_mfma_f32_32x32x16_bf16 v[128:143], a[228:231], a[4:7], v[128:143]
  ds_read_b128 a[228:231], v25 offset:8192
  v_exp_f32 v90, v90
  v_exp_f32 v91, v91
  s_waitcnt lgkmcnt(6)
  v_mfma_f32_32x32x16_bf16 v[128:143], a[232:235], a[8:11], v[128:143]
  ds_read_b128 a[232:235], v26 offset:8192
  v_add_f32 v38, v38, v89
  v_exp_f32 v92, v92
  v_add_f32 v38, v38, v90
  v_cvt_pk_bf16_f32 v64, v64, v65
  v_mfma_f32_32x32x16_bf16 v[128:143], a[236:239], a[12:15], v[128:143]
  ds_read_b128 a[236:239], v27 offset:8192
  v_exp_f32 v93, v93
  v_add_f32 v38, v38, v91
  v_cvt_pk_bf16_f32 v65, v66, v67
  s_waitcnt lgkmcnt(6)
  v_mfma_f32_32x32x16_bf16 v[128:143], a[240:243], a[16:19], v[128:143]
  ds_read_b128 a[240:243], v28 offset:8192
  s_xor_b32 s56, s44, 98304
  buffer_load_dwordx4 a[80:83], v2, s[16:19], s56 offen offset:0 nt
  v_add_f32 v38, v38, v92
  v_mfma_f32_32x32x16_bf16 v[128:143], a[244:247], a[20:23], v[128:143]
  ds_read_b128 a[244:247], v29 offset:8192
  v_exp_f32 v94, v94
  v_cvt_pk_bf16_f32 v66, v68, v69
  v_cvt_pk_bf16_f32 v67, v70, v71
  s_waitcnt lgkmcnt(6)
  v_mfma_f32_32x32x16_bf16 v[128:143], a[248:251], a[24:27], v[128:143]
  ds_read_b128 a[248:251], v30 offset:8192
  v_exp_f32 v95, v95
  v_add_f32 v38, v38, v93
  v_cvt_pk_bf16_f32 v68, v72, v73
  v_cvt_pk_bf16_f32 v69, v74, v75
  v_mfma_f32_32x32x16_bf16 v[128:143], a[252:255], a[28:31], v[128:143]
  ds_read_b128 a[252:255], v31 offset:8192
  v_cvt_pk_bf16_f32 v70, v76, v77
  v_cvt_pk_bf16_f32 v71, v78, v79
  v_add_f32 v38, v38, v94
  v_add_f32 v38, v38, v95
  v_cvt_pk_bf16_f32 v72, v80, v81
  v_cvt_pk_bf16_f32 v73, v82, v83
  v_cvt_pk_bf16_f32 v74, v84, v85
  v_cvt_pk_bf16_f32 v75, v86, v87
  v_cvt_pk_bf16_f32 v76, v88, v89
  v_cvt_pk_bf16_f32 v77, v90, v91
  v_cvt_pk_bf16_f32 v78, v92, v93
  v_cvt_pk_bf16_f32 v79, v94, v95
  s_waitcnt lgkmcnt(6)
  v_mfma_f32_32x32x16_bf16 v[80:95], a[224:227], a[0:3], 0
  ds_read_b128 a[224:227], v24 offset:16384
  s_cbranch_vccnz L_fix8
L_ret8:
  v_exp_f32 v96, v96
  v_subrev_u32 v32, 32768, v32
  v_mfma_f32_32x32x16_bf16 v[80:95], a[228:231], a[4:7], v[80:95]
  ds_read_b128 a[228:231], v25 offset:16384
  v_exp_f32 v97, v97
  v_exp_f32 v98, v98
  s_waitcnt lgkmcnt(6)
  v_mfma_f32_32x32x16_bf16 v[80:95], a[232:235], a[8:11], v[80:95]
  ds_read_b128 a[232:235], v26 offset:16384
  v_add_f32 v38, v38, v96
  v_exp_f32 v99, v99
  v_add_f32 v38, v38, v97
  v_add_f32 v38, v38, v98
  v_mfma_f32_32x32x16_bf16 v[80:95], a[236:239], a[12:15], v[80:95]
  ds_read_b128 a[236:239], v27 offset:16384
  v_exp_f32 v100, v100
  v_exp_f32 v101, v101
  v_add_f32 v38, v38, v99
  v_exp_f32 v102, v102
  v_add_f32 v38, v38, v100
  v_exp_f32 v103, v103
  v_add_f32 v38, v38, v101
  v_exp_f32 v104, v104
  v_add_f32 v38, v38, v102
  s_waitcnt lgkmcnt(6)
  v_mfma_f32_32x32x16_bf16 v[80:95], a[240:243], a[16:19], v[80:95]
  ds_read_b128 a[240:243], v28 offset:16384
  v_exp_f32 v105, v105
  v_add_f32 v38, v38, v103
  v_exp_f32 v106, v106
  v_add_f32 v38, v38, v104
  v_exp_f32 v107, v107
  v_add_f32 v38, v38, v105
  v_exp_f32 v108, v108
  v_add_f32 v38, v38, v106
  v_exp_f32 v109, v109
  v_add_f32 v38, v38, v107
  v_exp_f32 v110, v110
  v_add_f32 v38, v38, v108
  s_cbranch_vccnz L_fix9
L_ret9:
  buffer_load_dwordx4 a[84:87], v3, s[16:19], s56 offen offset:1024 nt
  v_mfma_f32_32x32x16_bf16 v[80:95], a[244:247], a[20:23], v[80:95]
  ds_read_b128 a[244:247], v29 offset:16384
  v_exp_f32 v111, v111
  v_add_f32 v38, v38, v109
  v_add_f32 v38, v38, v110
  v_exp_f32 v112, v112
  v_add_f32 v38, v38, v111
  v_exp_f32 v113, v113
  v_exp_f32 v114, v114
  v_add_f32 v38, v38, v112
  v_exp_f32 v115, v115
  v_add_f32 v38, v38, v113
  v_exp_f32 v116, v116
  v_add_f32 v38, v38, v114
  v_exp_f32 v117, v117
  v_add_f32 v38, v38, v115
  s_waitcnt lgkmcnt(6)
  v_mfma_f32_32x32x16_bf16 v[80:95], a[248:251], a[24:27], v[80:95]
  ds_read_b128 a[248:251], v30 offset:16384
  v_exp_f32 v118, v118
  v_add_f32 v38, v38, v116
  v_exp_f32 v119, v119
  v_add_f32 v38, v38, v117
  v_exp_f32 v120, v120
  v_add_f32 v38, v38, v118
  v_exp_f32 v121, v121
  v_add_f32 v38, v38, v119
  v_exp_f32 v122, v122
  v_add_f32 v38, v38, v120
  v_exp_f32 v123, v123
  v_add_f32 v38, v38, v121
  v_mfma_f32_32x32x16_bf16 v[80:95], a[252:255], a[28:31], v[80:95]
  ds_read_b128 a[252:255], v31 offset:16384
  v_exp_f32 v124, v124
  v_add_f32 v38, v38, v122
  v_cvt_pk_bf16_f32 v96, v96, v97
  v_exp_f32 v125, v125
  v_add_f32 v38, v38, v123
  v_cvt_pk_bf16_f32 v97, v98, v99
  v_exp_f32 v126, v126
  v_add_f32 v38, v38, v124
  v_cvt_pk_bf16_f32 v98, v100, v101
  v_cvt_pk_bf16_f32 v99, v102, v103
  v_exp_f32 v127, v127
  v_add_f32 v38, v38, v125
  v_cvt_pk_bf16_f32 v100, v104, v105
  v_cvt_pk_bf16_f32 v101, v106, v107
  v_cvt_pk_bf16_f32 v102, v108, v109
  v_cvt_pk_bf16_f32 v103, v110, v111
  v_add_f32 v38, v38, v126
  v_add_f32 v38, v38, v127
  v_cvt_pk_bf16_f32 v104, v112, v113
  v_cvt_pk_bf16_f32 v105, v114, v115
  v_cvt_pk_bf16_f32 v106, v116, v117
  v_cvt_pk_bf16_f32 v107, v118, v119
  v_cvt_pk_bf16_f32 v108, v120, v121
  v_cvt_pk_bf16_f32 v109, v122, v123
  v_cvt_pk_bf16_f32 v110, v124, v125
  v_cvt_pk_bf16_f32 v111, v126, v127
  s_waitcnt lgkmcnt(6)
  v_mfma_f32_32x32x16_bf16 v[112:127], a[224:227], a[0:3], 0
  ds_read_b128 a[224:227], v24 offset:24576
  s_cbranch_vccnz L_fix11
L_ret11:
  v_exp_f32 v144, v144
  v_subrev_u32 v33, 32768, v33
  v_mfma_f32_32x32x16_bf16 v[112:127], a[228:231], a[4:7], v[112:127]
  ds_read_b128 a[228:231], v25 offset:24576
  v_exp_f32 v145, v145
  v_exp_f32 v146, v146
  s_waitcnt lgkmcnt(6)
  v_mfma_f32_32x32x16_bf16 v[112:127], a[232:235], a[8:11], v[112:127]
  ds_read_b128 a[232:235], v26 offset:24576
  buffer_load_dwordx4 a[88:91], v4, s[16:19], s56 offen offset:2048 nt
  v_add_f32 v38, v38, v144
  v_add_f32 v38, v38, v145
  v_mfma_f32_32x32x16_bf16 v[112:127], a[236:239], a[12:15], v[112:127]
  ds_read_b128 a[236:239], v27 offset:24576
  v_exp_f32 v147, v147
  v_exp_f32 v148, v148
  v_add_f32 v38, v38, v146
  v_exp_f32 v149, v149
  v_add_f32 v38, v38, v147
  v_exp_f32 v150, v150
  v_add_f32 v38, v38, v148
  v_exp_f32 v151, v151
  v_add_f32 v38, v38, v149
  v_exp_f32 v152, v152
  v_add_f32 v38, v38, v150
  s_waitcnt lgkmcnt(6)
  v_mfma_f32_32x32x16_bf16 v[112:127], a[240:243], a[16:19], v[112:127]
  ds_read_b128 a[240:243], v28 offset:24576
  v_exp_f32 v153, v153
  v_add_f32 v38, v38, v151
  v_exp_f32 v154, v154
  v_add_f32 v38, v38, v152
  v_exp_f32 v155, v155
  v_add_f32 v38, v38, v153
  v_exp_f32 v156, v156
  v_add_f32 v38, v38, v154
  v_exp_f32 v157, v157
  v_add_f32 v38, v38, v155
  v_exp_f32 v158, v158
  v_add_f32 v38, v38, v156
  s_cbranch_vccnz L_fix12
L_ret12:
  v_mfma_f32_32x32x16_bf16 v[112:127], a[244:247], a[20:23], v[112:127]
  ds_read_b128 a[244:247], v29 offset:24576
  v_exp_f32 v159, v159
  v_add_f32 v38, v38, v157
  v_add_f32 v38, v38, v158
  v_exp_f32 v160, v160
  v_add_f32 v38, v38, v159
  v_exp_f32 v161, v161
  v_exp_f32 v162, v162
  v_add_f32 v38, v38, v160
  v_exp_f32 v163, v163
  v_add_f32 v38, v38, v161
  v_exp_f32 v164, v164
  v_add_f32 v38, v38, v162
  v_exp_f32 v165, v165
  v_add_f32 v38, v38, v163
  s_waitcnt lgkmcnt(6)
  v_mfma_f32_32x32x16_bf16 v[112:127], a[248:251], a[24:27], v[112:127]
  ds_read_b128 a[248:251], v30 offset:24576
  v_exp_f32 v166, v166
  v_add_f32 v38, v38, v164
  v_exp_f32 v167, v167
  v_add_f32 v38, v38, v165
  v_exp_f32 v168, v168
  v_add_f32 v38, v38, v166
  v_exp_f32 v169, v169
  v_add_f32 v38, v38, v167
  v_exp_f32 v170, v170
  v_add_f32 v38, v38, v168
  v_exp_f32 v171, v171
  v_add_f32 v38, v38, v169
  v_mfma_f32_32x32x16_bf16 v[112:127], a[252:255], a[28:31], v[112:127]
  ds_read_b128 a[252:255], v31 offset:24576
  s_waitcnt vmcnt(16)
  s_barrier
L_RS7:
  v_exp_f32 v172, v172
  v_add_f32 v38, v38, v170
  v_cvt_pk_bf16_f32 v144, v144, v145
  v_exp_f32 v173, v173
  v_add_f32 v38, v38, v171
  v_cvt_pk_bf16_f32 v145, v146, v147
  v_exp_f32 v174, v174
  v_add_f32 v38, v38, v172
  v_cvt_pk_bf16_f32 v146, v148, v149
  v_cvt_pk_bf16_f32 v147, v150, v151
  v_exp_f32 v175, v175
  v_add_f32 v38, v38, v173
  v_cvt_pk_bf16_f32 v148, v152, v153
  v_cvt_pk_bf16_f32 v149, v154, v155
  v_cvt_pk_bf16_f32 v150, v156, v157
  v_cvt_pk_bf16_f32 v151, v158, v159
  v_add_f32 v38, v38, v174
  v_add_f32 v38, v38, v175
  v_cvt_pk_bf16_f32 v152, v160, v161
  v_cvt_pk_bf16_f32 v153, v162, v163
  v_cvt_pk_bf16_f32 v154, v164, v165
  v_cvt_pk_bf16_f32 v155, v166, v167
  v_cvt_pk_bf16_f32 v156, v168, v169
  v_cvt_pk_bf16_f32 v157, v170, v171
  v_cvt_pk_bf16_f32 v158, v172, v173
  v_cvt_pk_bf16_f32 v159, v174, v175
  s_waitcnt lgkmcnt(6)
  v_mfma_f32_32x32x16_bf16 v[160:175], a[224:227], a[0:3], 0
  ds_read_b128 a[224:227], v32 offset:0
  buffer_load_dwordx4 a[92:95], v5, s[16:19], s56 offen offset:3072 nt
  v_subrev_u32 v34, 32768, v34
  v_subrev_u32 v35, 32768, v35
  v_mfma_f32_32x32x16_bf16 v[160:175], a[228:231], a[4:7], v[160:175]
  ds_read_b128 a[228:231], v36 offset:24576
  v_subrev_u32 v24, 32768, v24
  v_subrev_u32 v25, 32768, v25
  v_subrev_u32 v26, 32768, v26
  v_subrev_u32 v27, 32768, v27
  s_waitcnt lgkmcnt(6)
  v_mfma_f32_32x32x16_bf16 v[160:175], a[232:235], a[8:11], v[160:175]
  ds_read_b128 a[232:235], v33 offset:0
  v_subrev_u32 v28, 32768, v28
  v_subrev_u32 v29, 32768, v29
  v_subrev_u32 v30, 32768, v30
  v_subrev_u32 v31, 32768, v31
  v_add_u32 v7, 32768, v7
  v_mfma_f32_32x32x16_bf16 v[160:175], a[236:239], a[12:15], v[160:175]
  ds_read_b128 a[236:239], v36 offset:25600
  s_cbranch_vccnz L_fix10
L_ret10:
  v_exp_f32 v48, v48
  s_waitcnt lgkmcnt(6)
  v_mfma_f32_32x32x16_bf16 v[160:175], a[240:243], a[16:19], v[160:175]
  ds_read_b128 a[240:243], v34 offset:0
  v_exp_f32 v49, v49
  v_exp_f32 v50, v50
  v_add_f32 v39, v39, v48
  v_mfma_f32_32x32x16_bf16 v[160:175], a[244:247], a[20:23], v[160:175]
  ds_read_b128 a[244:247], v36 offset:26624
  v_exp_f32 v51, v51
  v_add_f32 v39, v39, v49
  v_add_f32 v39, v39, v50
  s_waitcnt lgkmcnt(6)
  v_mfma_f32_32x32x16_bf16 v[160:175], a[248:251], a[24:27], v[160:175]
  ds_read_b128 a[248:251], v35 offset:0
  v_exp_f32 v52, v52
  v_exp_f32 v53, v53
  v_add_f32 v39, v39, v51
  v_mfma_f32_32x32x16_bf16 v[160:175], a[252:255], a[28:31], v[160:175]
  ds_read_b128 a[252:255], v36 offset:27648
  s_xor_b32 s56, s44, 131072
  buffer_load_dwordx4 a[96:99], v2, s[16:19], s56 offen offset:0 nt
  s_waitcnt lgkmcnt(4)
  v_mfma_f32_32x32x16_bf16 v[208:223], a[224:227], a[228:231], v[208:223]
  ds_read_b128 a[224:227], v32 offset:512
  ds_read_b128 a[228:231], v36 offset:28672
  s_barrier
  v_exp_f32 v54, v54
  v_mfma_f32_32x32x16_bf16 v[208:223], a[232:235], a[236:239], v[208:223]
  ds_read_b128 a[232:235], v33 offset:512
  ds_read_b128 a[236:239], v36 offset:29696
  v_add_f32 v39, v39, v52
  v_exp_f32 v55, v55
  s_waitcnt lgkmcnt(6)
  v_mfma_f32_32x32x16_bf16 v[208:223], a[240:243], a[244:247], v[208:223]
  ds_read_b128 a[240:243], v34 offset:512
  ds_read_b128 a[244:247], v36 offset:30720
  v_add_f32 v39, v39, v53
  v_cvt_pk_bf16_f32 v48, v48, v49
  v_add_f32 v39, v39, v54
  s_waitcnt lgkmcnt(6)
  v_mfma_f32_32x32x16_bf16 v[208:223], a[248:251], a[252:255], v[208:223]
  ds_read_b128 a[248:251], v35 offset:512
  ds_read_b128 a[252:255], v36 offset:31744
  v_exp_f32 v56, v56
  v_cvt_pk_bf16_f32 v49, v50, v51
  s_waitcnt lgkmcnt(6)
  v_mfma_f32_32x32x16_bf16 v[208:223], a[224:227], a[228:231], v[208:223]
  ds_read_b128 a[224:227], v24 offset:0
  ds_read_b128 a[228:231], v25 offset:0
  v_exp_f32 v57, v57
  v_add_f32 v39, v39, v55
  s_waitcnt lgkmcnt(6)
  v_mfma_f32_32x32x16_bf16 v[208:223], a[232:235], a[236:239], v[208:223]
  ds_read_b128 a[232:235], v26 offset:0
  ds_read_b128 a[236:239], v27 offset:0
  buffer_load_dwordx4 a[100:103], v3, s[16:19], s56 offen offset:1024 nt
  s_waitcnt lgkmcnt(6)
  v_mfma_f32_32x32x16_bf16 v[208:223], a[240:243], a[244:247], v[208:223]
  ds_read_b128 a[240:243], v28 offset:0
  ds_read_b128 a[244:247], v29 offset:0
  v_exp_f32 v58, v58
  v_cvt_pk_bf16_f32 v50, v52, v53
  s_waitcnt lgkmcnt(6)
  v_mfma_f32_32x32x16_bf16 v[208:223], a[248:251], a[252:255], v[208:223]
  ds_read_b128 a[248:251], v30 offset:0
  ds_read_b128 a[252:255], v31 offset:0
  v_exp_f32 v59, v59
  v_cvt_pk_bf16_f32 v51, v54, v55
  s_waitcnt lgkmcnt(6)
  v_mfma_f32_32x32x16_bf16 v[128:143], a[224:227], a[32:35], v[128:143]
  ds_read_b128 a[224:227], v24 offset:8192
  v_exp_f32 v60, v60
  v_exp_f32 v61, v61
  v_cvt_pk_bf16_f32 v52, v56, v57
  v_mfma_f32_32x32x16_bf16 v[128:143], a[228:231], a[36:39], v[128:143]
  ds_read_b128 a[228:231], v25 offset:8192
  v_exp_f32 v62, v62
  v_exp_f32 v63, v63
  s_waitcnt lgkmcnt(6)
  v_mfma_f32_32x32x16_bf16 v[128:143], a[232:235], a[40:43], v[128:143]
  ds_read_b128 a[232:235], v26 offset:8192
  v_cvt_pk_bf16_f32 v53, v58, v59
  v_cvt_pk_bf16_f32 v54, v60, v61
  v_cvt_pk_bf16_f32 v55, v62, v63
  s_cbranch_vccnz L_fix13
L_ret13:
  v_mfma_f32_32x32x16_bf16 v[128:143], a[236:239], a[44:47], v[128:143]
  ds_read_b128 a[236:239], v27 offset:8192
  ds_write_b128 v37, v[48:51] offset:16384
  s_waitcnt lgkmcnt(7)
  v_mfma_f32_32x32x16_bf16 v[128:143], a[240:243], a[48:51], v[128:143]
  ds_read_b128 a[240:243], v28 offset:8192
  buffer_load_dwordx4 a[104:107], v4, s[16:19], s56 offen offset:2048 nt
  v_exp_f32 v192, v192
  v_mfma_f32_32x32x16_bf16 v[128:143], a[244:247], a[52:55], v[128:143]
  ds_read_b128 a[244:247], v29 offset:8192
  ds_write_b128 v37, v[52:55] offset:17408
  s_waitcnt lgkmcnt(8)
  v_mfma_f32_32x32x16_bf16 v[128:143], a[248:251], a[56:59], v[128:143]
  ds_read_b128 a[248:251], v30 offset:8192
  v_exp_f32 v193, v193
  v_exp_f32 v194, v194
  v_add_f32 v38, v38, v192
  v_mfma_f32_32x32x16_bf16 v[128:143], a[252:255], a[60:63], v[128:143]
  ds_read_b128 a[252:255], v31 offset:8192
  v_exp_f32 v195, v195
  v_add_f32 v38, v38, v193
  v_add_f32 v38, v38, v194
  s_waitcnt lgkmcnt(8)
  v_mfma_f32_32x32x16_bf16 v[80:95], a[224:227], a[32:35], v[80:95]
  ds_read_b128 a[224:227], v24 offset:16384
  v_exp_f32 v196, v196
  v_exp_f32 v197, v197
  v_cvt_pk_bf16_f32 v192, v192, v193
  v_mfma_f32_32x32x16_bf16 v[80:95], a[228:231], a[36:39], v[80:95]
  ds_read_b128 a[228:231], v25 offset:16384
  v_exp_f32 v198, v198
  v_exp_f32 v199, v199
  s_waitcnt lgkmcnt(8)
  v_mfma_f32_32x32x16_bf16 v[80:95], a[232:235], a[40:43], v[80:95]
  ds_read_b128 a[232:235], v26 offset:16384
  buffer_load_dwordx4 a[108:111], v5, s[16:19], s56 offen offset:3072 nt
  v_add_f32 v38, v38, v195
  v_cvt_pk_bf16_f32 v193, v194, v195
  v_mfma_f32_32x32x16_bf16 v[80:95], a[236:239], a[44:47], v[80:95]
  ds_read_b128 a[236:239], v27 offset:16384
  v_cvt_pk_bf16_f32 v194, v196, v197
  v_cvt_pk_bf16_f32 v195, v198, v199
  v_add_f32 v38, v38, v196
  v_add_f32 v38, v38, v197
  s_waitcnt lgkmcnt(7)
  v_mfma_f32_32x32x16_bf16 v[80:95], a[240:243], a[48:51], v[80:95]
  ds_read_b128 a[240:243], v28 offset:16384
  v_exp_f32 v200, v200
  v_exp_f32 v201, v201
  v_add_f32 v38, v38, v198
  v_mfma_f32_32x32x16_bf16 v[80:95], a[244:247], a[52:55], v[80:95]
  ds_read_b128 a[244:247], v29 offset:16384
  v_exp_f32 v202, v202
  v_exp_f32 v203, v203
  s_waitcnt lgkmcnt(6)
  v_mfma_f32_32x32x16_bf16 v[80:95], a[248:251], a[56:59], v[80:95]
  ds_read_b128 a[248:251], v30 offset:16384
  v_exp_f32 v204, v204
  v_exp_f32 v205, v205
  v_add_f32 v38, v38, v199
  v_mfma_f32_32x32x16_bf16 v[80:95], a[252:255], a[60:63], v[80:95]
  ds_read_b128 a[252:255], v31 offset:16384
  v_exp_f32 v206, v206
  v_exp_f32 v207, v207
  s_waitcnt lgkmcnt(6)
  v_mfma_f32_32x32x16_bf16 v[112:127], a[224:227], a[32:35], v[112:127]
  ds_read_b128 a[224:227], v24 offset:24576
  v_cvt_pk_bf16_f32 v196, v200, v201
  v_cvt_pk_bf16_f32 v197, v202, v203
  v_cvt_pk_bf16_f32 v198, v204, v205
  v_cvt_pk_bf16_f32 v199, v206, v207
  v_add_f32 v38, v38, v200
  v_mfma_f32_32x32x16_bf16 v[112:127], a[228:231], a[36:39], v[112:127]
  s_xor_b32 s56, s44, 163840
  buffer_load_dwordx4 a[112:115], v2, s[16:19], s56 offen offset:0 nt
  ds_read_b128 a[228:231], v25 offset:24576
  s_waitcnt lgkmcnt(6)
  v_mfma_f32_32x32x16_bf16 v[112:127], a[232:235], a[40:43], v[112:127]
  ds_read_b128 a[232:235], v26 offset:24576
  s_cbranch_vccnz L_fix14
L_ret14:
  v_add_f32 v38, v38, v201
  v_add_f32 v38, v38, v202
  v_add_f32 v38, v38, v203
  v_mfma_f32_32x32x16_bf16 v[112:127], a[236:239], a[44:47], v[112:127]
  ds_read_b128 a[236:239], v27 offset:24576
  v_exp_f32 v224, v224
  v_exp_f32 v225, v225
  s_waitcnt lgkmcnt(6)
  v_mfma_f32_32x32x16_bf16 v[112:127], a[240:243], a[48:51], v[112:127]
  ds_read_b128 a[240:243], v28 offset:24576
  v_exp_f32 v226, v226
  v_exp_f32 v227, v227
  v_cvt_pk_bf16_f32 v200, v224, v225
  v_mfma_f32_32x32x16_bf16 v[112:127], a[244:247], a[52:55], v[112:127]
  ds_read_b128 a[244:247], v29 offset:24576
  v_exp_f32 v228, v228
  v_exp_f32 v229, v229
  s_waitcnt lgkmcnt(6)
  v_mfma_f32_32x32x16_bf16 v[112:127], a[248:251], a[56:59], v[112:127]
  ds_read_b128 a[248:251], v30 offset:24576
  v_exp_f32 v230, v230
  v_exp_f32 v231, v231
  v_cvt_pk_bf16_f32 v201, v226, v227
  v_mfma_f32_32x32x16_bf16 v[112:127], a[252:255], a[60:63], v[112:127]
  ds_read_b128 a[252:255], v31 offset:24576
  s_waitcnt vmcnt(13)
  s_barrier
L_RS8:
  v_cvt_pk_bf16_f32 v202, v228, v229
  s_waitcnt lgkmcnt(6)
  v_mfma_f32_32x32x16_bf16 v[160:175], a[224:227], a[32:35], v[160:175]
  buffer_load_dwordx4 a[116:119], v3, s[16:19], s56 offen offset:1024 nt
  ds_read_b64_tr_b16 a[224:225], v12 offset:32768
  ds_read_b64_tr_b16 a[226:227], v12 offset:33792
  v_cvt_pk_bf16_f32 v203, v230, v231
  v_mfma_f32_32x32x16_bf16 v[160:175], a[228:231], a[36:39], v[160:175]
  ds_read_b128 a[228:231], v36 offset:0
  v_add_f32 v38, v38, v204
  v_add_f32 v38, v38, v205
  v_add_f32 v38, v38, v206
  v_add_f32 v38, v38, v207
  s_waitcnt lgkmcnt(7)
  v_mfma_f32_32x32x16_bf16 v[160:175], a[232:235], a[40:43], v[160:175]
  ds_read_b64_tr_b16 a[232:233], v12 offset:36864
  ds_read_b64_tr_b16 a[234:235], v12 offset:37888
  v_exp_f32 v232, v232
  v_exp_f32 v233, v233
  v_mfma_f32_32x32x16_bf16 v[160:175], a[236:239], a[44:47], v[160:175]
  ds_read_b128 a[236:239], v36 offset:1024
  v_exp_f32 v234, v234
  v_exp_f32 v235, v235
  s_waitcnt lgkmcnt(8)
  v_mfma_f32_32x32x16_bf16 v[160:175], a[240:243], a[48:51], v[160:175]
  ds_read_b64_tr_b16 a[240:241], v12 offset:40960
  ds_read_b64_tr_b16 a[242:243], v12 offset:41984
  v_exp_f32 v236, v236
  v_exp_f32 v237, v237
  v_mfma_f32_32x32x16_bf16 v[160:175], a[244:247], a[52:55], v[160:175]
  ds_read_b128 a[244:247], v36 offset:2048
  v_exp_f32 v238, v238
  v_exp_f32 v239, v239
  s_waitcnt lgkmcnt(9)
  v_mfma_f32_32x32x16_bf16 v[160:175], a[248:251], a[56:59], v[160:175]
  buffer_load_dwordx4 a[120:123], v4, s[16:19], s56 offen offset:2048 nt
  ds_read_b64_tr_b16 a[248:249], v12 offset:45056
  ds_read_b64_tr_b16 a[250:251], v12 offset:46080
  v_cvt_pk_bf16_f32 v204, v232, v233
  v_mfma_f32_32x32x16_bf16 v[160:175], a[252:255], a[60:63], v[160:175]
  ds_read_b128 a[252:255], v36 offset:3072
  v_cvt_pk_bf16_f32 v205, v234, v235
  v_cvt_pk_bf16_f32 v206, v236, v237
  v_cvt_pk_bf16_f32 v207, v238, v239
  v_add_f32 v39, v39, v56
  s_waitcnt lgkmcnt(9)
  v_mfma_f32_32x32x16_bf16 a[0:15], a[224:227], v[240:243], 0
  s_barrier
  v_add_f32 v39, v39, v57
  v_add_f32 v39, v39, v58
  v_add_f32 v39, v39, v59
  v_add_f32 v39, v39, v60
  v_mfma_f32_32x32x16_bf16 a[192:207], a[224:227], a[228:231], 0
  ds_read_b64_tr_b16 a[224:225], v12 offset:49152
  ds_read_b64_tr_b16 a[226:227], v12 offset:50176
  ds_read_b128 a[228:231], v36 offset:4096
  s_cbranch_vccnz L_fix15
L_ret15:
  s_waitcnt lgkmcnt(9)
  v_mfma_f32_32x32x16_bf16 a[0:15], a[232:235], v[244:247], a[0:15]
  v_add_f32 v39, v39, v61
  v_add_f32 v39, v39, v62
  v_exp_f32 v208, v208
  v_add_f32 v39, v39, v63
  v_add_f32 v39, v39, v208
  v_mfma_f32_32x32x16_bf16 a[192:207], a[232:235], a[236:239], a[192:207]
  ds_read_b64_tr_b16 a[232:233], v12 offset:53248
  ds_read_b64_tr_b16 a[234:235], v12 offset:54272
  ds_read_b128 a[236:239], v36 offset:5120
  v_exp_f32 v209, v209
  s_waitcnt lgkmcnt(9)
  v_mfma_f32_32x32x16_bf16 a[0:15], a[240:243], v[248:251], a[0:15]
  v_exp_f32 v210, v210
  v_exp_f32 v211, v211
  v_add_f32 v39, v39, v209
  v_add_f32 v39, v39, v210
  v_mfma_f32_32x32x16_bf16 a[192:207], a[240:243], a[244:247], a[192:207]
  buffer_load_dwordx4 a[124:127], v5, s[16:19], s56 offen offset:3072 nt
  ds_read_b64_tr_b16 a[240:241], v12 offset:57344
  ds_read_b64_tr_b16 a[242:243], v12 offset:58368
  s_waitcnt lgkmcnt(8)
  v_mfma_f32_32x32x16_bf16 a[0:15], a[248:251], v[252:255], a[0:15]
  ds_read_b128 a[244:247], v36 offset:6144
  v_exp_f32 v212, v212
  v_exp_f32 v213, v213
  v_add_f32 v39, v39, v211
  v_mfma_f32_32x32x16_bf16 a[192:207], a[248:251], a[252:255], a[192:207]
  ds_read_b64_tr_b16 a[248:249], v12 offset:61440
  ds_read_b64_tr_b16 a[250:251], v12 offset:62464
  ds_read_b128 a[252:255], v36 offset:7168
  v_exp_f32 v214, v214
  s_waitcnt lgkmcnt(9)
  v_mfma_f32_32x32x16_bf16 a[0:15], a[224:227], v[176:179], a[0:15]
  v_add_f32 v39, v39, v212
  v_exp_f32 v215, v215
  v_add_f32 v39, v39, v213
  v_cvt_pk_bf16_f32 v208, v208, v209
  v_add_f32 v39, v39, v214
  v_mfma_f32_32x32x16_bf16 a[192:207], a[224:227], a[228:231], a[192:207]
  ds_read_b64_tr_b16 a[224:225], v13 offset:32768
  ds_read_b64_tr_b16 a[226:227], v13 offset:33792
  ds_read_b64_tr_b16 a[228:229], v13 offset:36864
  v_exp_f32 v216, v216
  s_waitcnt lgkmcnt(9)
  v_mfma_f32_32x32x16_bf16 a[0:15], a[232:235], v[180:183], a[0:15]
  ds_read_b64_tr_b16 a[230:231], v13 offset:37888
  v_exp_f32 v217, v217
  v_exp_f32 v218, v218
  v_cvt_pk_bf16_f32 v209, v210, v211
  v_mfma_f32_32x32x16_bf16 a[192:207], a[232:235], a[236:239], a[192:207]
  ds_read_b64_tr_b16 a[232:233], v13 offset:40960
  ds_read_b64_tr_b16 a[234:235], v13 offset:41984
  ds_read_b64_tr_b16 a[236:237], v13 offset:45056
  v_exp_f32 v219, v219
  s_waitcnt lgkmcnt(10)
  v_mfma_f32_32x32x16_bf16 a[0:15], a[240:243], v[184:187], a[0:15]
  ds_read_b64_tr_b16 a[238:239], v13 offset:46080
  s_xor_b32 s56, s44, 196608
  buffer_load_dwordx4 a[128:131], v2, s[16:19], s56 offen offset:0 nt
  v_add_f32 v39, v39, v215
  v_mfma_f32_32x32x16_bf16 a[192:207], a[240:243], a[244:247], a[192:207]
  ds_read_b64_tr_b16 a[240:241], v13 offset:49152
  ds_read_b64_tr_b16 a[242:243], v13 offset:50176
  ds_read_b64_tr_b16 a[244:245], v13 offset:53248
  v_exp_f32 v220, v220
  s_waitcnt lgkmcnt(11)
  v_mfma_f32_32x32x16_bf16 a[0:15], a[248:251], v[188:191], a[0:15]
  ds_read_b64_tr_b16 a[246:247], v13 offset:54272
  s_waitcnt vmcnt(16)
  ds_write_b128 v7, a[64:67] offset:0
  v_mfma_f32_32x32x16_bf16 a[192:207], a[248:251], a[252:255], a[192:207]
  ds_read_b64_tr_b16 a[248:249], v13 offset:57344
  v_exp_f32 v221, v221
  v_exp_f32 v222, v222
  s_waitcnt lgkmcnt(10)
  v_mfma_f32_32x32x16_bf16 a[16:31], a[224:227], v[240:243], 0
  ds_read_b64_tr_b16 a[250:251], v13 offset:58368
  ds_read_b64_tr_b16 a[252:253], v13 offset:61440
  ds_read_b64_tr_b16 a[254:255], v13 offset:62464
  v_exp_f32 v223, v223
  v_cvt_pk_bf16_f32 v210, v212, v213
  v_mfma_f32_32x32x16_bf16 a[16:31], a[228:231], v[244:247], a[16:31]
  s_waitcnt vmcnt(15)
  ds_write_b128 v7, a[68:71] offset:1024
  s_waitcnt lgkmcnt(10)
  v_mfma_f32_32x32x16_bf16 a[16:31], a[232:235], v[248:251], a[16:31]
  ds_read_b64_tr_b16 a[224:225], v14 offset:32768
  ds_read_b64_tr_b16 a[226:227], v14 offset:33792
  buffer_load_dwordx4 a[132:135], v3, s[16:19], s56 offen offset:1024 nt
  ds_read_b64_tr_b16 a[228:229], v14 offset:36864
  v_mfma_f32_32x32x16_bf16 a[16:31], a[236:239], v[252:255], a[16:31]
  ds_read_b64_tr_b16 a[230:231], v14 offset:37888
  v_cvt_pk_bf16_f32 v211, v214, v215
  v_cvt_pk_bf16_f32 v212, v216, v217
  v_cvt_pk_bf16_f32 v213, v218, v219
  v_cvt_pk_bf16_f32 v214, v220, v221
  s_waitcnt lgkmcnt(10)
  v_mfma_f32_32x32x16_bf16 a[16:31], a[240:243], v[176:179], a[16:31]
  s_waitcnt vmcnt(15)
  ds_write_b128 v7, a[72:75] offset:2048
  ds_read_b64_tr_b16 a[232:233], v14 offset:40960
  ds_read_b64_tr_b16 a[234:235], v14 offset:41984
  v_mfma_f32_32x32x16_bf16 a[16:31], a[244:247], v[180:183], a[16:31]
  ds_read_b64_tr_b16 a[236:237], v14 offset:45056
  v_cvt_pk_bf16_f32 v215, v222, v223
  v_add_f32 v38, v38, v224
  v_add_f32 v38, v38, v225
  v_add_f32 v38, v38, v226
  s_waitcnt lgkmcnt(9)
  v_mfma_f32_32x32x16_bf16 a[16:31], a[248:251], v[184:187], a[16:31]
  ds_read_b64_tr_b16 a[238:239], v14 offset:46080
  s_waitcnt vmcnt(14)
  ds_write_b128 v7, a[76:79] offset:3072
  ds_read_b64_tr_b16 a[240:241], v14 offset:49152
  v_mfma_f32_32x32x16_bf16 a[16:31], a[252:255], v[188:191], a[16:31]
  ds_read_b64_tr_b16 a[242:243], v14 offset:50176
  ds_read_b64_tr_b16 a[244:245], v14 offset:53248
  v_add_f32 v38, v38, v227
  v_add_f32 v38, v38, v228
  v_add_f32 v38, v38, v229
  s_waitcnt lgkmcnt(9)
  v_mfma_f32_32x32x16_bf16 a[32:47], a[224:227], v[240:243], 0
  ds_read_b64_tr_b16 a[246:247], v14 offset:54272
  s_waitcnt vmcnt(13)
  ds_write_b128 v7, a[80:83] offset:4096
  ds_read_b64_tr_b16 a[248:249], v14 offset:57344
  v_mfma_f32_32x32x16_bf16 a[32:47], a[228:231], v[244:247], a[32:47]
  buffer_load_dwordx4 a[136:139], v4, s[16:19], s56 offen offset:2048 nt
  ds_read_b64_tr_b16 a[250:251], v14 offset:58368
  ds_read_b64_tr_b16 a[252:253], v14 offset:61440
  s_waitcnt lgkmcnt(9)
  v_mfma_f32_32x32x16_bf16 a[32:47], a[232:235], v[248:251], a[32:47]
  ds_read_b64_tr_b16 a[254:255], v14 offset:62464
  s_waitcnt vmcnt(13)
  ds_write_b128 v7, a[84:87] offset:5120
  ds_read_b64_tr_b16 a[224:225], v15 offset:32768
  v_mfma_f32_32x32x16_bf16 a[32:47], a[236:239], v[252:255], a[32:47]
  ds_read_b64_tr_b16 a[226:227], v15 offset:33792
  ds_read_b64_tr_b16 a[228:229], v15 offset:36864
  v_add_f32 v38, v38, v230
  v_add_f32 v38, v38, v231
  v_add_f32 v38, v38, v232
  s_waitcnt lgkmcnt(9)
  v_mfma_f32_32x32x16_bf16 a[32:47], a[240:243], v[176:179], a[32:47]
  ds_read_b64_tr_b16 a[230:231], v15 offset:37888
  s_waitcnt vmcnt(12)
  ds_write_b128 v7, a[88:91] offset:6144
  ds_read_b64_tr_b16 a[232:233], v15 offset:40960
  v_mfma_f32_32x32x16_bf16 a[32:47], a[244:247], v[180:183], a[32:47]
  ds_read_b64_tr_b16 a[234:235], v15 offset:41984
  ds_read_b64_tr_b16 a[236:237], v15 offset:45056
  v_add_f32 v38, v38, v233
  v_add_f32 v38, v38, v234
  v_add_f32 v38, v38, v235
  s_waitcnt lgkmcnt(9)
  v_mfma_f32_32x32x16_bf16 a[32:47], a[248:251], v[184:187], a[32:47]
  ds_read_b64_tr_b16 a[238:239], v15 offset:46080
  s_waitcnt vmcnt(11)
  ds_write_b128 v7, a[92:95] offset:7168
  ds_read_b64_tr_b16 a[240:241], v15 offset:49152
  v_mfma_f32_32x32x16_bf16 a[32:47], a[252:255], v[188:191], a[32:47]
  buffer_load_dwordx4 a[140:143], v5, s[16:19], s56 offen offset:3072 nt
  ds_read_b64_tr_b16 a[242:243], v15 offset:50176
  ds_read_b64_tr_b16 a[244:245], v15 offset:53248
  s_waitcnt lgkmcnt(9)
  v_mfma_f32_32x32x16_bf16 a[48:63], a[224:227], v[240:243], 0
  ds_read_b64_tr_b16 a[246:247], v15 offset:54272
  ds_read_b64_tr_b16 a[248:249], v15 offset:57344
  ds_read_b64_tr_b16 a[250:251], v15 offset:58368
  v_add_f32 v38, v38, v236
  s_cbranch_vccnz L_fix16
L_ret16:
  v_mfma_f32_32x32x16_bf16 a[48:63], a[228:231], v[244:247], a[48:63]
  ds_read_b64_tr_b16 a[252:253], v15 offset:61440
  ds_read_b64_tr_b16 a[254:255], v15 offset:62464
  s_waitcnt lgkmcnt(8)
  s_barrier
L_RS9:
  ds_read_b64_tr_b16 a[224:225], v12 offset:0
  v_mfma_f32_32x32x16_bf16 a[48:63], a[232:235], v[248:251], a[48:63]
  ds_read_b64_tr_b16 a[226:227], v12 offset:1024
  ds_read_b128 a[228:231], v36 offset:8192
  ds_read_b64_tr_b16 a[232:233], v12 offset:4096
  v_add_f32 v38, v38, v237
  v_add_f32 v38, v38, v238
  v_add_f32 v38, v38, v239
  v_mfma_f32_32x32x16_bf16 a[48:63], a[236:239], v[252:255], a[48:63]
  ds_read_b64_tr_b16 a[234:235], v12 offset:5120
  ds_read_b128 a[236:239], v36 offset:9216
  v_exp_f32 v128, v128
  v_add_f32 v39, v39, v216
  s_waitcnt lgkmcnt(10)
  v_mfma_f32_32x32x16_bf16 a[48:63], a[240:243], v[176:179], a[48:63]
  ds_read_b64_tr_b16 a[240:241], v12 offset:8192
  ds_read_b64_tr_b16 a[242:243], v12 offset:9216
  ds_write_b128 v37, v[208:211] offset:24576
  v_mfma_f32_32x32x16_bf16 a[48:63], a[244:247], v[180:183], a[48:63]
  ds_read_b128 a[244:247], v36 offset:10240
  v_exp_f32 v129, v129
  v_exp_f32 v130, v130
  s_waitcnt lgkmcnt(10)
  v_mfma_f32_32x32x16_bf16 a[48:63], a[248:251], v[184:187], a[48:63]
  s_xor_b32 s56, s44, 229376
  buffer_load_dwordx4 a[144:147], v2, s[16:19], s56 offen offset:0 nt
  ds_read_b64_tr_b16 a[248:249], v12 offset:12288
  ds_read_b64_tr_b16 a[250:251], v12 offset:13312
  v_mfma_f32_32x32x16_bf16 a[48:63], a[252:255], v[188:191], a[48:63]
  ds_read_b128 a[252:255], v36 offset:11264
  ds_write_b128 v37, v[212:215] offset:25600
  s_waitcnt lgkmcnt(11)
  v_mfma_f32_32x32x16_bf16 a[0:15], a[224:227], v[64:67], a[0:15]
  s_barrier
  v_add_f32 v38, v38, v128
  v_exp_f32 v131, v131
  v_add_f32 v38, v38, v129
  v_mfma_f32_32x32x16_bf16 a[192:207], a[224:227], a[228:231], a[192:207]
  ds_read_b64_tr_b16 a[224:225], v12 offset:16384
  ds_read_b64_tr_b16 a[226:227], v12 offset:17408
  ds_read_b128 a[228:231], v36 offset:12288
  v_exp_f32 v132, v132
  s_waitcnt lgkmcnt(11)
  v_mfma_f32_32x32x16_bf16 a[0:15], a[232:235], v[68:71], a[0:15]
  v_exp_f32 v133, v133
  v_exp_f32 v134, v134
  v_exp_f32 v135, v135
  v_mfma_f32_32x32x16_bf16 a[192:207], a[232:235], a[236:239], a[192:207]
  ds_read_b64_tr_b16 a[232:233], v12 offset:20480
  ds_read_b64_tr_b16 a[234:235], v12 offset:21504
  ds_read_b128 a[236:239], v36 offset:13312
  v_add_f32 v38, v38, v130
  v_cvt_pk_bf16_f32 v128, v128, v129
  s_waitcnt lgkmcnt(10)
  v_mfma_f32_32x32x16_bf16 a[0:15], a[240:243], v[72:75], a[0:15]
  buffer_load_dwordx4 a[148:151], v3, s[16:19], s56 offen offset:1024 nt
  v_add_f32 v38, v38, v131
  v_cvt_pk_bf16_f32 v129, v130, v131
  v_cvt_pk_bf16_f32 v130, v132, v133
  v_mfma_f32_32x32x16_bf16 a[192:207], a[240:243], a[244:247], a[192:207]
  ds_read_b64_tr_b16 a[240:241], v12 offset:24576
  ds_read_b64_tr_b16 a[242:243], v12 offset:25600
  ds_read_b128 a[244:247], v36 offset:14336
  v_cvt_pk_bf16_f32 v131, v134, v135
  v_add_f32 v38, v38, v132
  s_waitcnt lgkmcnt(10)
  v_mfma_f32_32x32x16_bf16 a[0:15], a[248:251], v[76:79], a[0:15]
  v_add_f32 v38, v38, v133
  v_exp_f32 v136, v136
  v_exp_f32 v137, v137
  v_add_f32 v38, v38, v134
  v_mfma_f32_32x32x16_bf16 a[192:207], a[248:251], a[252:255], a[192:207]
  ds_read_b64_tr_b16 a[248:249], v12 offset:28672
  ds_read_b64_tr_b16 a[250:251], v12 offset:29696
  ds_read_b128 a[252:255], v36 offset:15360
  v_exp_f32 v138, v138
  s_waitcnt lgkmcnt(9)
  v_mfma_f32_32x32x16_bf16 a[0:15], a[224:227], v[96:99], a[0:15]
  v_exp_f32 v139, v139
  v_exp_f32 v140, v140
  v_exp_f32 v141, v141
  v_mfma_f32_32x32x16_bf16 a[192:207], a[224:227], a[228:231], a[192:207]
  ds_read_b64_tr_b16 a[224:225], v13 offset:0
  ds_read_b64_tr_b16 a[226:227], v13 offset:1024
  ds_read_b64_tr_b16 a[228:229], v13 offset:4096
  v_exp_f32 v142, v142
  s_waitcnt lgkmcnt(9)
  v_mfma_f32_32x32x16_bf16 a[0:15], a[232:235], v[100:103], a[0:15]
  ds_read_b64_tr_b16 a[230:231], v13 offset:5120
  v_exp_f32 v143, v143
  v_add_f32 v38, v38, v135
  v_cvt_pk_bf16_f32 v132, v136, v137
  v_cvt_pk_bf16_f32 v133, v138, v139
  v_mfma_f32_32x32x16_bf16 a[192:207], a[232:235], a[236:239], a[192:207]
  buffer_load_dwordx4 a[152:155], v4, s[16:19], s56 offen offset:2048 nt
  ds_read_b64_tr_b16 a[232:233], v13 offset:8192
  ds_read_b64_tr_b16 a[234:235], v13 offset:9216
  s_waitcnt lgkmcnt(9)
  v_mfma_f32_32x32x16_bf16 a[0:15], a[240:243], v[104:107], a[0:15]
  ds_read_b64_tr_b16 a[236:237], v13 offset:12288
  ds_read_b64_tr_b16 a[238:239], v13 offset:13312
  v_cvt_pk_bf16_f32 v134, v140, v141
  v_cvt_pk_bf16_f32 v135, v142, v143
  v_add_f32 v38, v38, v136
  v_add_f32 v38, v38, v137
  v_mfma_f32_32x32x16_bf16 a[192:207], a[240:243], a[244:247], a[192:207]
  ds_read_b64_tr_b16 a[240:241], v13 offset:16384
  ds_read_b64_tr_b16 a[242:243], v13 offset:17408
  ds_read_b64_tr_b16 a[244:245], v13 offset:20480
  s_cbranch_vccnz L_fix17
L_ret17:
  s_waitcnt lgkmcnt(11)
  v_mfma_f32_32x32x16_bf16 a[0:15], a[248:251], v[108:111], a[0:15]
  ds_read_b64_tr_b16 a[246:247], v13 offset:21504
  s_waitcnt vmcnt(14)
  ds_write_b128 v7, a[96:99] offset:32768
  v_mfma_f32_32x32x16_bf16 a[192:207], a[248:251], a[252:255], a[192:207]
  ds_read_b64_tr_b16 a[248:249], v13 offset:24576
  v_add_f32 v38, v38, v138
  v_exp_f32 v80, v80
  v_add_f32 v38, v38, v139
  s_waitcnt lgkmcnt(10)
  v_mfma_f32_32x32x16_bf16 a[16:31], a[224:227], v[64:67], a[16:31]
  ds_read_b64_tr_b16 a[250:251], v13 offset:25600
  ds_read_b64_tr_b16 a[252:253], v13 offset:28672
  ds_read_b64_tr_b16 a[254:255], v13 offset:29696
  v_exp_f32 v81, v81
  v_add_f32 v38, v38, v140
  v_mfma_f32_32x32x16_bf16 a[16:31], a[228:231], v[68:71], a[16:31]
  s_waitcnt vmcnt(13)
  ds_write_b128 v7, a[100:103] offset:33792
  s_waitcnt lgkmcnt(10)
  v_mfma_f32_32x32x16_bf16 a[16:31], a[232:235], v[72:75], a[16:31]
  buffer_load_dwordx4 a[156:159], v5, s[16:19], s56 offen offset:3072 nt
  ds_read_b64_tr_b16 a[224:225], v14 offset:0
  ds_read_b64_tr_b16 a[226:227], v14 offset:1024
  ds_read_b64_tr_b16 a[228:229], v14 offset:4096
  v_mfma_f32_32x32x16_bf16 a[16:31], a[236:239], v[76:79], a[16:31]
  ds_read_b64_tr_b16 a[230:231], v14 offset:5120
  v_exp_f32 v82, v82
  v_exp_f32 v83, v83
  s_waitcnt lgkmcnt(10)
  v_mfma_f32_32x32x16_bf16 a[16:31], a[240:243], v[96:99], a[16:31]
  s_waitcnt vmcnt(13)
  ds_write_b128 v7, a[104:107] offset:34816
  ds_read_b64_tr_b16 a[232:233], v14 offset:8192
  ds_read_b64_tr_b16 a[234:235], v14 offset:9216
  v_mfma_f32_32x32x16_bf16 a[16:31], a[244:247], v[100:103], a[16:31]
  ds_read_b64_tr_b16 a[236:237], v14 offset:12288
  v_exp_f32 v84, v84
  v_exp_f32 v85, v85
  s_waitcnt lgkmcnt(9)
  v_mfma_f32_32x32x16_bf16 a[16:31], a[248:251], v[104:107], a[16:31]
  ds_read_b64_tr_b16 a[238:239], v14 offset:13312
  s_waitcnt vmcnt(12)
  ds_write_b128 v7, a[108:111] offset:35840
  ds_read_b64_tr_b16 a[240:241], v14 offset:16384
  v_mfma_f32_32x32x16_bf16 a[16:31], a[252:255], v[108:111], a[16:31]
  ds_read_b64_tr_b16 a[242:243], v14 offset:17408
  ds_read_b64_tr_b16 a[244:245], v14 offset:20480
  v_exp_f32 v86, v86
  v_cvt_pk_bf16_f32 v136, v80, v81
  s_waitcnt lgkmcnt(9)
  v_mfma_f32_32x32x16_bf16 a[32:47], a[224:227], v[64:67], a[32:47]
  ds_read_b64_tr_b16 a[246:247], v14 offset:21504
  s_waitcnt vmcnt(11)
  ds_write_b128 v7, a[112:115] offset:36864
  ds_read_b64_tr_b16 a[248:249], v14 offset:24576
  v_mfma_f32_32x32x16_bf16 a[32:47], a[228:231], v[68:71], a[32:47]
  ds_read_b64_tr_b16 a[250:251], v14 offset:25600
  ds_read_b64_tr_b16 a[252:253], v14 offset:28672
  s_add_u32 m0, s42, 32768
  s_xor_b32 s55, s44, 256
  buffer_load_dwordx4 v2, s[16:19], s55 offen offset:0 nt lds
  s_waitcnt lgkmcnt(9)
  v_mfma_f32_32x32x16_bf16 a[32:47], a[232:235], v[72:75], a[32:47]
  ds_read_b64_tr_b16 a[254:255], v14 offset:29696
  s_waitcnt vmcnt(11)
  ds_write_b128 v7, a[116:119] offset:37888
  ds_read_b64_tr_b16 a[224:225], v15 offset:0
  v_mfma_f32_32x32x16_bf16 a[32:47], a[236:239], v[76:79], a[32:47]
  ds_read_b64_tr_b16 a[226:227], v15 offset:1024
  ds_read_b64_tr_b16 a[228:229], v15 offset:4096
  v_exp_f32 v87, v87
  v_cvt_pk_bf16_f32 v137, v82, v83
  s_waitcnt lgkmcnt(9)
  v_mfma_f32_32x32x16_bf16 a[32:47], a[240:243], v[96:99], a[32:47]
  ds_read_b64_tr_b16 a[230:231], v15 offset:5120
  s_waitcnt vmcnt(10)
  ds_write_b128 v7, a[120:123] offset:38912
  ds_read_b64_tr_b16 a[232:233], v15 offset:8192
  v_mfma_f32_32x32x16_bf16 a[32:47], a[244:247], v[100:103], a[32:47]
  ds_read_b64_tr_b16 a[234:235], v15 offset:9216
  ds_read_b64_tr_b16 a[236:237], v15 offset:12288
  v_cvt_pk_bf16_f32 v138, v84, v85
  v_cvt_pk_bf16_f32 v139, v86, v87
  v_add_f32 v38, v38, v141
  s_waitcnt lgkmcnt(9)
  v_mfma_f32_32x32x16_bf16 a[32:47], a[248:251], v[104:107], a[32:47]
  ds_read_b64_tr_b16 a[238:239], v15 offset:13312
  s_waitcnt vmcnt(9)
  ds_write_b128 v7, a[124:127] offset:39936
  ds_read_b64_tr_b16 a[240:241], v15 offset:16384
  v_mfma_f32_32x32x16_bf16 a[32:47], a[252:255], v[108:111], a[32:47]
  ds_read_b64_tr_b16 a[242:243], v15 offset:17408
  buffer_load_dwordx4 v3, s[16:19], s55 offen offset:1024 nt lds
  ds_read_b64_tr_b16 a[244:245], v15 offset:20480
  s_waitcnt lgkmcnt(9)
  v_mfma_f32_32x32x16_bf16 a[48:63], a[224:227], v[64:67], a[48:63]
  ds_read_b64_tr_b16 a[246:247], v15 offset:21504
  ds_read_b64_tr_b16 a[248:249], v15 offset:24576
  ds_read_b64_tr_b16 a[250:251], v15 offset:25600
  v_add_f32 v38, v38, v142
  v_add_f32 v38, v38, v143
  v_add_f32 v38, v38, v80
  v_mfma_f32_32x32x16_bf16 a[48:63], a[228:231], v[68:71], a[48:63]
  ds_read_b64_tr_b16 a[252:253], v15 offset:28672
  ds_read_b64_tr_b16 a[254:255], v15 offset:29696
  s_waitcnt lgkmcnt(8)
  s_barrier
L_RS10:
  ds_read_b64_tr_b16 a[224:225], v12 offset:32768
  v_mfma_f32_32x32x16_bf16 a[48:63], a[232:235], v[72:75], a[48:63]
  ds_read_b64_tr_b16 a[226:227], v12 offset:33792
  ds_read_b128 a[228:231], v36 offset:16384
  ds_read_b64_tr_b16 a[232:233], v12 offset:36864
  v_add_f32 v38, v38, v81
  v_add_f32 v38, v38, v82
  v_add_f32 v38, v38, v83
  v_mfma_f32_32x32x16_bf16 a[48:63], a[236:239], v[76:79], a[48:63]
  ds_read_b64_tr_b16 a[234:235], v12 offset:37888
  ds_read_b128 a[236:239], v36 offset:17408
  v_add_f32 v38, v38, v84
  v_add_f32 v38, v38, v85
  v_add_f32 v38, v38, v86
  s_waitcnt lgkmcnt(10)
  v_mfma_f32_32x32x16_bf16 a[48:63], a[240:243], v[96:99], a[48:63]
  ds_read_b64_tr_b16 a[240:241], v12 offset:40960
  ds_read_b64_tr_b16 a[242:243], v12 offset:41984
  v_exp_f32 v88, v88
  v_exp_f32 v89, v89
  v_mfma_f32_32x32x16_bf16 a[48:63], a[244:247], v[100:103], a[48:63]
  buffer_load_dwordx4 v4, s[16:19], s55 offen offset:2048 nt lds
  ds_read_b128 a[244:247], v36 offset:18432
  s_waitcnt lgkmcnt(9)
  v_mfma_f32_32x32x16_bf16 a[48:63], a[248:251], v[104:107], a[48:63]
  ds_read_b64_tr_b16 a[248:249], v12 offset:45056
  ds_read_b64_tr_b16 a[250:251], v12 offset:46080
  v_exp_f32 v90, v90
  v_exp_f32 v91, v91
  v_mfma_f32_32x32x16_bf16 a[48:63], a[252:255], v[108:111], a[48:63]
  ds_read_b128 a[252:255], v36 offset:19456
  v_exp_f32 v92, v92
  v_exp_f32 v93, v93
  s_waitcnt lgkmcnt(9)
  v_mfma_f32_32x32x16_bf16 a[0:15], a[224:227], v[144:147], a[0:15]
  s_barrier
  v_exp_f32 v94, v94
  v_exp_f32 v95, v95
  v_mfma_f32_32x32x16_bf16 a[192:207], a[224:227], a[228:231], a[192:207]
  ds_read_b64_tr_b16 a[224:225], v12 offset:49152
  ds_read_b64_tr_b16 a[226:227], v12 offset:50176
  ds_read_b128 a[228:231], v36 offset:20480
  v_add_f32 v38, v38, v87
  v_cvt_pk_bf16_f32 v140, v88, v89
  s_waitcnt lgkmcnt(9)
  v_mfma_f32_32x32x16_bf16 a[0:15], a[232:235], v[148:151], a[0:15]
  s_lshl_b32 s98, s32, 12
  s_add_u32 s98, s98, L_RS16-L_pc+0
  v_lshlrev_b32 v46, 6, v0
  v_add_u32 v46, s98, v46
  v_min_u32 v46, s95, v46
  v_cvt_pk_bf16_f32 v141, v90, v91
  v_mfma_f32_32x32x16_bf16 a[192:207], a[232:235], a[236:239], a[192:207]
  v_mov_b32 v47, s97
  v_add_co_u32 v46, s[98:99], s96, v46
  s_nop 1
  v_addc_co_u32 v47, s[98:99], 0, v47, s[98:99]
  ds_read_b64_tr_b16 a[232:233], v12 offset:53248
  ds_read_b64_tr_b16 a[234:235], v12 offset:54272
  global_load_dword v46, v[46:47], off
  s_waitcnt lgkmcnt(8)
  v_mfma_f32_32x32x16_bf16 a[0:15], a[240:243], v[152:155], a[0:15]
  buffer_load_dwordx4 v5, s[16:19], s55 offen offset:3072 nt lds
  ds_read_b128 a[236:239], v36 offset:21504
  v_cvt_pk_bf16_f32 v142, v92, v93
  v_mfma_f32_32x32x16_bf16 a[192:207], a[240:243], a[244:247], a[192:207]
  ds_read_b64_tr_b16 a[240:241], v12 offset:57344
  ds_read_b64_tr_b16 a[242:243], v12 offset:58368
  ds_read_b128 a[244:247], v36 offset:22528
  v_cvt_pk_bf16_f32 v143, v94, v95
  v_add_f32 v38, v38, v88
  s_waitcnt lgkmcnt(9)
  v_mfma_f32_32x32x16_bf16 a[0:15], a[248:251], v[156:159], a[0:15]
  v_add_f32 v38, v38, v89
  v_add_f32 v38, v38, v90
  v_add_f32 v38, v38, v91
  v_add_f32 v38, v38, v92
  s_cbranch_vccnz L_fix18
L_ret18:
  v_mfma_f32_32x32x16_bf16 a[192:207], a[248:251], a[252:255], a[192:207]
  ds_read_b64_tr_b16 a[248:249], v12 offset:61440
  ds_read_b64_tr_b16 a[250:251], v12 offset:62464
  ds_read_b128 a[252:255], v36 offset:23552
  v_add_f32 v38, v38, v93
  v_add_f32 v38, v38, v94
  s_waitcnt lgkmcnt(9)
  v_mfma_f32_32x32x16_bf16 a[0:15], a[224:227], v[192:195], a[0:15]
  v_exp_f32 v112, v112
  v_add_f32 v38, v38, v95
  v_exp_f32 v113, v113
  v_add_f32 v38, v38, v112
  v_mfma_f32_32x32x16_bf16 a[192:207], a[224:227], a[228:231], a[192:207]
  ds_read_b64_tr_b16 a[224:225], v13 offset:32768
  ds_read_b64_tr_b16 a[226:227], v13 offset:33792
  ds_read_b64_tr_b16 a[228:229], v13 offset:36864
  v_exp_f32 v114, v114
  s_waitcnt lgkmcnt(9)
  v_mfma_f32_32x32x16_bf16 a[0:15], a[232:235], v[196:199], a[0:15]
  ds_read_b64_tr_b16 a[230:231], v13 offset:37888
  v_exp_f32 v115, v115
  v_add_f32 v38, v38, v113
  v_exp_f32 v116, v116
  v_mfma_f32_32x32x16_bf16 a[192:207], a[232:235], a[236:239], a[192:207]
  s_add_u32 m0, s42, 36864
  s_xor_b32 s55, s44, 33024
  buffer_load_dwordx4 v2, s[16:19], s55 offen offset:0 nt lds
  ds_read_b64_tr_b16 a[232:233], v13 offset:40960
  ds_read_b64_tr_b16 a[234:235], v13 offset:41984
  s_waitcnt lgkmcnt(9)
  v_mfma_f32_32x32x16_bf16 a[0:15], a[240:243], v[200:203], a[0:15]
  ds_read_b64_tr_b16 a[236:237], v13 offset:45056
  ds_read_b64_tr_b16 a[238:239], v13 offset:46080
  v_exp_f32 v117, v117
  v_exp_f32 v118, v118
  v_mfma_f32_32x32x16_bf16 a[192:207], a[240:243], a[244:247], a[192:207]
  ds_read_b64_tr_b16 a[240:241], v13 offset:49152
  ds_read_b64_tr_b16 a[242:243], v13 offset:50176
  ds_read_b64_tr_b16 a[244:245], v13 offset:53248
  v_exp_f32 v119, v119
  s_waitcnt lgkmcnt(11)
  v_mfma_f32_32x32x16_bf16 a[0:15], a[248:251], v[204:207], a[0:15]
  ds_read_b64_tr_b16 a[246:247], v13 offset:54272
  s_waitcnt vmcnt(13)
  ds_write_b128 v7, a[128:131] offset:0
  v_mfma_f32_32x32x16_bf16 a[192:207], a[248:251], a[252:255], a[192:207]
  ds_read_b64_tr_b16 a[248:249], v13 offset:57344
  v_add_f32 v38, v38, v114
  v_cvt_pk_bf16_f32 v112, v112, v113
  v_add_f32 v38, v38, v115
  v_cvt_pk_bf16_f32 v113, v114, v115
  s_waitcnt lgkmcnt(10)
  v_mfma_f32_32x32x16_bf16 a[16:31], a[224:227], v[144:147], a[16:31]
  ds_read_b64_tr_b16 a[250:251], v13 offset:58368
  ds_read_b64_tr_b16 a[252:253], v13 offset:61440
  ds_read_b64_tr_b16 a[254:255], v13 offset:62464
  v_cvt_pk_bf16_f32 v114, v116, v117
  v_cvt_pk_bf16_f32 v115, v118, v119
  v_add_f32 v38, v38, v116
  v_mfma_f32_32x32x16_bf16 a[16:31], a[228:231], v[148:151], a[16:31]
  buffer_load_dwordx4 v3, s[16:19], s55 offen offset:1024 nt lds
  s_waitcnt vmcnt(13)
  ds_write_b128 v7, a[132:135] offset:1024
  s_waitcnt lgkmcnt(10)
  v_mfma_f32_32x32x16_bf16 a[16:31], a[232:235], v[152:155], a[16:31]
  ds_read_b64_tr_b16 a[224:225], v14 offset:32768
  ds_read_b64_tr_b16 a[226:227], v14 offset:33792
  ds_read_b64_tr_b16 a[228:229], v14 offset:36864
  v_add_f32 v38, v38, v117
  v_exp_f32 v120, v120
  v_mfma_f32_32x32x16_bf16 a[16:31], a[236:239], v[156:159], a[16:31]
  ds_read_b64_tr_b16 a[230:231], v14 offset:37888
  v_exp_f32 v121, v121
  v_exp_f32 v122, v122
  s_waitcnt lgkmcnt(10)
  v_mfma_f32_32x32x16_bf16 a[16:31], a[240:243], v[192:195], a[16:31]
  s_waitcnt vmcnt(12)
  ds_write_b128 v7, a[136:139] offset:2048
  ds_read_b64_tr_b16 a[232:233], v14 offset:40960
  ds_read_b64_tr_b16 a[234:235], v14 offset:41984
  v_mfma_f32_32x32x16_bf16 a[16:31], a[244:247], v[196:199], a[16:31]
  ds_read_b64_tr_b16 a[236:237], v14 offset:45056
  v_exp_f32 v123, v123
  v_exp_f32 v124, v124
  s_waitcnt lgkmcnt(9)
  v_mfma_f32_32x32x16_bf16 a[16:31], a[248:251], v[200:203], a[16:31]
  ds_read_b64_tr_b16 a[238:239], v14 offset:46080
  s_waitcnt vmcnt(11)
  ds_write_b128 v7, a[140:143] offset:3072
  ds_read_b64_tr_b16 a[240:241], v14 offset:49152
  v_mfma_f32_32x32x16_bf16 a[16:31], a[252:255], v[204:207], a[16:31]
  ds_read_b64_tr_b16 a[242:243], v14 offset:50176
  ds_read_b64_tr_b16 a[244:245], v14 offset:53248
  v_exp_f32 v125, v125
  v_add_f32 v38, v38, v118
  s_waitcnt lgkmcnt(9)
  v_mfma_f32_32x32x16_bf16 a[32:47], a[224:227], v[144:147], a[32:47]
  buffer_load_dwordx4 v4, s[16:19], s55 offen offset:2048 nt lds
  ds_read_b64_tr_b16 a[246:247], v14 offset:54272
  s_waitcnt vmcnt(11)
  ds_write_b128 v7, a[144:147] offset:4096
  ds_read_b64_tr_b16 a[248:249], v14 offset:57344
  v_mfma_f32_32x32x16_bf16 a[32:47], a[228:231], v[148:151], a[32:47]
  ds_read_b64_tr_b16 a[250:251], v14 offset:58368
  ds_read_b64_tr_b16 a[252:253], v14 offset:61440
  v_exp_f32 v126, v126
  v_add_f32 v38, v38, v119
  s_waitcnt lgkmcnt(9)
  v_mfma_f32_32x32x16_bf16 a[32:47], a[232:235], v[152:155], a[32:47]
  ds_read_b64_tr_b16 a[254:255], v14 offset:62464
  s_waitcnt vmcnt(10)
  ds_write_b128 v7, a[148:151] offset:5120
  ds_read_b64_tr_b16 a[224:225], v15 offset:32768
  v_mfma_f32_32x32x16_bf16 a[32:47], a[236:239], v[156:159], a[32:47]
  ds_read_b64_tr_b16 a[226:227], v15 offset:33792
  ds_read_b64_tr_b16 a[228:229], v15 offset:36864
  v_exp_f32 v127, v127
  v_cvt_pk_bf16_f32 v116, v120, v121
  s_waitcnt lgkmcnt(9)
  v_mfma_f32_32x32x16_bf16 a[32:47], a[240:243], v[192:195], a[32:47]
  ds_read_b64_tr_b16 a[230:231], v15 offset:37888
  s_waitcnt vmcnt(9)
  ds_write_b128 v7, a[152:155] offset:6144
  ds_read_b64_tr_b16 a[232:233], v15 offset:40960
  v_mfma_f32_32x32x16_bf16 a[32:47], a[244:247], v[196:199], a[32:47]
  ds_read_b64_tr_b16 a[234:235], v15 offset:41984
  ds_read_b64_tr_b16 a[236:237], v15 offset:45056
  v_cvt_pk_bf16_f32 v117, v122, v123
  v_cvt_pk_bf16_f32 v118, v124, v125
  v_cvt_pk_bf16_f32 v119, v126, v127
  s_waitcnt lgkmcnt(9)
  v_mfma_f32_32x32x16_bf16 a[32:47], a[248:251], v[200:203], a[32:47]
  buffer_load_dwordx4 v5, s[16:19], s55 offen offset:3072 nt lds
  ds_read_b64_tr_b16 a[238:239], v15 offset:46080
  s_waitcnt vmcnt(9)
  ds_write_b128 v7, a[156:159] offset:7168
  ds_read_b64_tr_b16 a[240:241], v15 offset:49152
  v_mfma_f32_32x32x16_bf16 a[32:47], a[252:255], v[204:207], a[32:47]
  ds_read_b64_tr_b16 a[242:243], v15 offset:50176
  ds_read_b64_tr_b16 a[244:245], v15 offset:53248
  v_add_f32 v38, v38, v120
  s_cbranch_vccnz L_fix19
L_ret19:
  s_waitcnt lgkmcnt(9)
  v_mfma_f32_32x32x16_bf16 a[48:63], a[224:227], v[144:147], a[48:63]
  ds_read_b64_tr_b16 a[246:247], v15 offset:54272
  ds_read_b64_tr_b16 a[248:249], v15 offset:57344
  ds_read_b64_tr_b16 a[250:251], v15 offset:58368
  v_add_f32 v38, v38, v121
  v_add_f32 v38, v38, v122
  v_add_f32 v38, v38, v123
  v_mfma_f32_32x32x16_bf16 a[48:63], a[228:231], v[148:151], a[48:63]
  ds_read_b64_tr_b16 a[252:253], v15 offset:61440
  ds_read_b64_tr_b16 a[254:255], v15 offset:62464
  s_waitcnt lgkmcnt(8)
  s_barrier
L_RS11:
  ds_read_b64_tr_b16 a[224:225], v12 offset:0
  v_mfma_f32_32x32x16_bf16 a[48:63], a[232:235], v[152:155], a[48:63]
  ds_read_b64_tr_b16 a[226:227], v12 offset:1024
  ds_read_b128 a[228:231], v36 offset:24576
  ds_read_b64_tr_b16 a[232:233], v12 offset:4096
  v_exp_f32 v160, v160
  v_add_f32 v38, v38, v124
  v_mfma_f32_32x32x16_bf16 a[48:63], a[236:239], v[156:159], a[48:63]
  ds_read_b64_tr_b16 a[234:235], v12 offset:5120
  ds_read_b128 a[236:239], v36 offset:25600
  v_exp_f32 v161, v161
  v_add_f32 v38, v38, v125
  s_waitcnt lgkmcnt(10)
  v_mfma_f32_32x32x16_bf16 a[48:63], a[240:243], v[192:195], a[48:63]
  ds_read_b64_tr_b16 a[240:241], v12 offset:8192
  ds_read_b64_tr_b16 a[242:243], v12 offset:9216
  v_exp_f32 v162, v162
  v_exp_f32 v163, v163
  v_mfma_f32_32x32x16_bf16 a[48:63], a[244:247], v[196:199], a[48:63]
  s_add_u32 m0, s42, 0
  s_xor_b32 s55, s44, 65792
  buffer_load_dwordx4 v2, s[16:19], s55 offen offset:0 nt lds
  s_waitcnt lgkmcnt(8)
  v_mfma_f32_32x32x16_bf16 a[48:63], a[248:251], v[200:203], a[48:63]
  ds_read_b128 a[244:247], v36 offset:26624
  ds_read_b64_tr_b16 a[248:249], v12 offset:12288
  ds_read_b64_tr_b16 a[250:251], v12 offset:13312
  v_exp_f32 v164, v164
  v_cvt_pk_bf16_f32 v120, v160, v161
  v_mfma_f32_32x32x16_bf16 a[48:63], a[252:255], v[204:207], a[48:63]
  ds_read_b128 a[252:255], v36 offset:27648
  v_exp_f32 v165, v165
  v_exp_f32 v166, v166
  s_waitcnt lgkmcnt(9)
  v_mfma_f32_32x32x16_bf16 a[0:15], a[224:227], v[128:131], a[0:15]
  v_exp_f32 v167, v167
  v_cvt_pk_bf16_f32 v121, v162, v163
  v_cvt_pk_bf16_f32 v122, v164, v165
  v_cvt_pk_bf16_f32 v123, v166, v167
  v_add_f32 v38, v38, v126
  v_mfma_f32_32x32x16_bf16 a[192:207], a[224:227], a[228:231], a[192:207]
  ds_read_b64_tr_b16 a[224:225], v12 offset:16384
  ds_read_b64_tr_b16 a[226:227], v12 offset:17408
  ds_read_b128 a[228:231], v36 offset:28672
  v_exp_f32 v168, v168
  s_waitcnt lgkmcnt(9)
  v_mfma_f32_32x32x16_bf16 a[0:15], a[232:235], v[132:135], a[0:15]
  v_exp_f32 v169, v169
  v_exp_f32 v170, v170
  v_exp_f32 v171, v171
  v_mfma_f32_32x32x16_bf16 a[192:207], a[232:235], a[236:239], a[192:207]
  ds_read_b64_tr_b16 a[232:233], v12 offset:20480
  ds_read_b64_tr_b16 a[234:235], v12 offset:21504
  ds_read_b128 a[236:239], v36 offset:29696
  v_exp_f32 v172, v172
  s_waitcnt lgkmcnt(9)
  v_mfma_f32_32x32x16_bf16 a[0:15], a[240:243], v[136:139], a[0:15]
  buffer_load_dwordx4 v3, s[16:19], s55 offen offset:1024 nt lds
  v_exp_f32 v173, v173
  v_mfma_f32_32x32x16_bf16 a[192:207], a[240:243], a[244:247], a[192:207]
  ds_read_b64_tr_b16 a[240:241], v12 offset:24576
  ds_read_b64_tr_b16 a[242:243], v12 offset:25600
  ds_read_b128 a[244:247], v36 offset:30720
  v_exp_f32 v174, v174
  s_waitcnt lgkmcnt(9)
  v_mfma_f32_32x32x16_bf16 a[0:15], a[248:251], v[140:143], a[0:15]
  v_exp_f32 v175, v175
  v_add_f32 v38, v38, v127
  v_cvt_pk_bf16_f32 v124, v168, v169
  v_cvt_pk_bf16_f32 v125, v170, v171
  v_cvt_pk_bf16_f32 v126, v172, v173
  v_mfma_f32_32x32x16_bf16 a[192:207], a[248:251], a[252:255], a[192:207]
  ds_read_b64_tr_b16 a[248:249], v12 offset:28672
  ds_read_b64_tr_b16 a[250:251], v12 offset:29696
  ds_read_b128 a[252:255], v36 offset:31744
  v_cvt_pk_bf16_f32 v127, v174, v175
  v_subrev_u32 v12, 65536, v12
  s_waitcnt lgkmcnt(9)
  v_mfma_f32_32x32x16_bf16 a[0:15], a[224:227], v[112:115], a[0:15]
  v_add_f32 v39, v39, v217
  v_add_f32 v39, v39, v218
  v_add_f32 v39, v39, v219
  v_add_f32 v39, v39, v220
  v_add_f32 v39, v39, v221
  v_add_f32 v39, v39, v222
  v_mfma_f32_32x32x16_bf16 a[192:207], a[224:227], a[228:231], a[192:207]
  ds_read_b64_tr_b16 a[224:225], v13 offset:0
  ds_read_b64_tr_b16 a[226:227], v13 offset:1024
  ds_read_b64_tr_b16 a[228:229], v13 offset:4096
  v_add_f32 v39, v39, v223
  v_add_f32 v38, v38, v160
  s_waitcnt lgkmcnt(9)
  v_mfma_f32_32x32x16_bf16 a[0:15], a[232:235], v[116:119], a[0:15]
  buffer_load_dwordx4 v4, s[16:19], s55 offen offset:2048 nt lds
  ds_read_b64_tr_b16 a[230:231], v13 offset:5120
  v_add_f32 v38, v38, v161
  v_mfma_f32_32x32x16_bf16 a[192:207], a[232:235], a[236:239], a[192:207]
  ds_read_b64_tr_b16 a[232:233], v13 offset:8192
  ds_read_b64_tr_b16 a[234:235], v13 offset:9216
  ds_read_b64_tr_b16 a[236:237], v13 offset:12288
  v_add_f32 v38, v38, v162
  v_add_f32 v38, v38, v163
  s_waitcnt lgkmcnt(10)
  v_mfma_f32_32x32x16_bf16 a[0:15], a[240:243], v[120:123], a[0:15]
  ds_read_b64_tr_b16 a[238:239], v13 offset:13312
  v_add_f32 v38, v38, v164
  v_add_f32 v38, v38, v165
  v_add_f32 v38, v38, v166
  v_add_f32 v38, v38, v167
  v_xor_b32 v16, s36, v16
  v_mfma_f32_32x32x16_bf16 a[192:207], a[240:243], a[244:247], a[192:207]
  ds_read_b64_tr_b16 a[240:241], v13 offset:16384
  ds_read_b64_tr_b16 a[242:243], v13 offset:17408
  ds_read_b64_tr_b16 a[244:245], v13 offset:20480
  v_add_f32 v38, v38, v168
  s_add_u32 s36, s34, 1
  s_waitcnt lgkmcnt(11)
  v_mfma_f32_32x32x16_bf16 a[0:15], a[248:251], v[124:127], a[0:15]
  ds_read_b64_tr_b16 a[246:247], v13 offset:21504
  v_add_f32 v38, v38, v169
  s_and_b32 s36, s36, 3
  v_add_f32 v38, v38, v170
  s_sub_u32 s36, s36, s38
  v_and_b32 v8, 7, v0
  v_mfma_f32_32x32x16_bf16 a[192:207], a[248:251], a[252:255], a[192:207]
  ds_read_b64_tr_b16 a[248:249], v13 offset:24576
  ds_read_b64_tr_b16 a[250:251], v13 offset:25600
  v_add_f32 v38, v38, v171
  s_lshl_b32 s36, s36, 7
  v_xor_b32 v8, v8, v42
  s_waitcnt lgkmcnt(10)
  v_mfma_f32_32x32x16_bf16 a[16:31], a[224:227], v[128:131], a[16:31]
  ds_read_b64_tr_b16 a[252:253], v13 offset:28672
  ds_read_b64_tr_b16 a[254:255], v13 offset:29696
  ds_read_b64_tr_b16 a[224:225], v14 offset:0
  v_add_f32 v38, v38, v172
  s_add_u32 s54, s3, s36
  v_lshrrev_b32 v42, 3, v0
  v_mfma_f32_32x32x16_bf16 a[16:31], a[228:231], v[132:135], a[16:31]
  buffer_load_dwordx4 v5, s[16:19], s55 offen offset:3072 nt lds
  ds_read_b64_tr_b16 a[226:227], v14 offset:1024
  s_waitcnt lgkmcnt(10)
  v_mfma_f32_32x32x16_bf16 a[16:31], a[232:235], v[136:139], a[16:31]
  ds_read_b64_tr_b16 a[228:229], v14 offset:4096
  ds_read_b64_tr_b16 a[230:231], v14 offset:5120
  ds_read_b64_tr_b16 a[232:233], v14 offset:8192
  v_add_f32 v38, v38, v173
  s_mul_i32 s36, s32, 57344
  v_lshlrev_b32 v8, 4, v8
  v_mfma_f32_32x32x16_bf16 a[16:31], a[236:239], v[140:143], a[16:31]
  ds_read_b64_tr_b16 a[234:235], v14 offset:9216
  v_mul_u32_u24 v42, 896, v42
  v_add_f32 v38, v38, v174
  v_add3_u32 v8, v8, v42, s36
  v_add_f32 v38, v38, v175
  s_waitcnt lgkmcnt(10)
  v_mfma_f32_32x32x16_bf16 a[16:31], a[240:243], v[112:115], a[16:31]
  ds_read_b64_tr_b16 a[236:237], v14 offset:12288
  ds_read_b64_tr_b16 a[238:239], v14 offset:13312
  ds_read_b64_tr_b16 a[240:241], v14 offset:16384
  s_lshl_b32 s36, s32, 8
  v_mov_b32 v42, v38
  v_add_u32 v35, s36, v6
  v_mfma_f32_32x32x16_bf16 a[16:31], a[244:247], v[116:119], a[16:31]
  ds_read_b64_tr_b16 a[242:243], v14 offset:17408
  v_mov_b32 v43, v39
  v_permlane32_swap_b32 v42, v38
  s_and_b32 s37, s32, 1
  s_mul_i32 s36, s32, 14
  s_waitcnt lgkmcnt(10)
  v_mfma_f32_32x32x16_bf16 a[16:31], a[248:251], v[120:123], a[16:31]
  ds_read_b64_tr_b16 a[244:245], v14 offset:20480
  ds_read_b64_tr_b16 a[246:247], v14 offset:21504
  ds_read_b64_tr_b16 a[248:249], v14 offset:24576
  v_permlane32_swap_b32 v43, v39
  v_add_f32 v38, v42, v38
  s_add_u32 s36, s36, s37
  v_mfma_f32_32x32x16_bf16 a[16:31], a[252:255], v[124:127], a[16:31]
  s_add_u32 m0, s42, 4096
  s_xor_b32 s55, s44, 98560
  buffer_load_dwordx4 v2, s[16:19], s55 offen offset:0 nt lds
  ds_read_b64_tr_b16 a[250:251], v14 offset:25600
  s_waitcnt lgkmcnt(10)
  v_mfma_f32_32x32x16_bf16 a[32:47], a[224:227], v[128:131], a[32:47]
  ds_read_b64_tr_b16 a[252:253], v14 offset:28672
  ds_read_b64_tr_b16 a[254:255], v14 offset:29696
  ds_read_b64_tr_b16 a[224:225], v15 offset:0
  v_add_f32 v39, v43, v39
  v_subrev_u32 v42, s58, v38
  s_lshl_b32 s36, s36, 13
  v_mfma_f32_32x32x16_bf16 a[32:47], a[228:231], v[132:135], a[32:47]
  ds_read_b64_tr_b16 a[226:227], v15 offset:1024
  v_mov_b32 v43, 0x7f800000
  v_cmp_le_u32 vcc, s59, v42
  v_add_u32 v32, s36, v1
  s_lshr_b32 s36, s32, 1
  s_waitcnt lgkmcnt(10)
  v_mfma_f32_32x32x16_bf16 a[32:47], a[232:235], v[136:139], a[32:47]
  ds_read_b64_tr_b16 a[228:229], v15 offset:4096
  ds_read_b64_tr_b16 a[230:231], v15 offset:5120
  ds_read_b64_tr_b16 a[232:233], v15 offset:8192
  v_cndmask_b32 v39, v39, v43, vcc
  s_mul_i32 s36, s36, 14
  v_bfe_u32 v42, v0, 3, 2
  v_mfma_f32_32x32x16_bf16 a[32:47], a[236:239], v[140:143], a[32:47]
  ds_read_b64_tr_b16 a[234:235], v15 offset:9216
  v_bfe_u32 v43, v0, 1, 1
  v_subrev_u32 v13, 65536, v13
  s_add_u32 s36, s36, s37
  v_lshl_add_u32 v42, v42, 1, v43
  s_waitcnt lgkmcnt(10)
  v_mfma_f32_32x32x16_bf16 a[32:47], a[240:243], v[112:115], a[32:47]
  ds_read_b64_tr_b16 a[236:237], v15 offset:12288
  ds_read_b64_tr_b16 a[238:239], v15 offset:13312
  ds_read_b64_tr_b16 a[240:241], v15 offset:16384
  s_add_u32 s36, s36, 56
  v_lshrrev_b32 v43, 3, v0
  s_lshl_b32 s36, s36, 13
  v_mfma_f32_32x32x16_bf16 a[32:47], a[244:247], v[116:119], a[32:47]
  ds_read_b64_tr_b16 a[242:243], v15 offset:17408
  v_xor_b32 v43, v43, v0
  v_add_u32 v34, s36, v1
  v_and_b32 v43, 4, v43
  v_xor_b32 v33, 8192, v32
  s_waitcnt lgkmcnt(10)
  v_mfma_f32_32x32x16_bf16 a[32:47], a[248:251], v[120:123], a[32:47]
  buffer_load_dwordx4 v3, s[16:19], s55 offen offset:1024 nt lds
  ds_read_b64_tr_b16 a[244:245], v15 offset:20480
  ds_read_b64_tr_b16 a[246:247], v15 offset:21504
  v_mfma_f32_32x32x16_bf16 a[32:47], a[252:255], v[124:127], a[32:47]
  ds_read_b64_tr_b16 a[248:249], v15 offset:24576
  ds_read_b64_tr_b16 a[250:251], v15 offset:25600
  s_waitcnt vmcnt(6)
  s_barrier
L_RS12:
  s_waitcnt lgkmcnt(10)
  v_mfma_f32_32x32x16_bf16 a[48:63], a[224:227], v[128:131], a[48:63]
  ds_read_b64_tr_b16 a[252:253], v15 offset:28672
  ds_read_b64_tr_b16 a[254:255], v15 offset:29696
  ds_read_b64_tr_b16 a[224:225], v12 offset:32768
  v_lshlrev_b32 v1, 23, v0
  v_lshl_add_u32 v42, v43, 1, v42
  v_subrev_u32 v14, 65536, v14
  v_mfma_f32_32x32x16_bf16 a[48:63], a[228:231], v[132:135], a[48:63]
  ds_read_b64_tr_b16 a[226:227], v12 offset:33792
  v_cmp_eq_u32 s[8:9], 0, v42
  s_nop 1
  v_cndmask_b32 v24, 0, v45, s[8:9]
  v_subrev_u32 v15, 65536, v15
  s_waitcnt lgkmcnt(10)
  v_mfma_f32_32x32x16_bf16 a[48:63], a[232:235], v[136:139], a[48:63]
  ds_read_b128 a[228:231], v36 offset:0
  ds_read_b64_tr_b16 a[232:233], v12 offset:36864
  ds_read_b64_tr_b16 a[234:235], v12 offset:37888
  v_cmp_eq_u32 s[8:9], 1, v42
  s_nop 1
  v_cndmask_b32 v25, 0, v45, s[8:9]
  v_mfma_f32_32x32x16_bf16 a[48:63], a[236:239], v[140:143], a[48:63]
  ds_read_b128 a[236:239], v36 offset:1024
  v_cmp_eq_u32 s[8:9], 2, v42
  s_nop 1
  v_cndmask_b32 v26, 0, v45, s[8:9]
  v_add_u32 v9, 6144, v8
  s_waitcnt lgkmcnt(10)
  v_mfma_f32_32x32x16_bf16 a[48:63], a[240:243], v[112:115], a[48:63]
  ds_read_b64_tr_b16 a[240:241], v12 offset:40960
  ds_read_b64_tr_b16 a[242:243], v12 offset:41984
  v_cmp_eq_u32 s[8:9], 3, v42
  s_nop 1
  v_cndmask_b32 v27, 0, v45, s[8:9]
  v_add_u32 v10, 12288, v8
  v_mfma_f32_32x32x16_bf16 a[48:63], a[244:247], v[116:119], a[48:63]
  buffer_load_dwordx4 v4, s[16:19], s55 offen offset:2048 nt lds
  ds_read_b128 a[244:247], v36 offset:2048
  s_waitcnt lgkmcnt(9)
  v_mfma_f32_32x32x16_bf16 a[48:63], a[248:251], v[120:123], a[48:63]
  ds_read_b64_tr_b16 a[248:249], v12 offset:45056
  ds_read_b64_tr_b16 a[250:251], v12 offset:46080
  v_cmp_eq_u32 s[8:9], 4, v42
  s_nop 1
  v_cndmask_b32 v28, 0, v45, s[8:9]
  v_add_u32 v11, 18432, v8
  v_mfma_f32_32x32x16_bf16 a[48:63], a[252:255], v[124:127], a[48:63]
  ds_read_b128 a[252:255], v36 offset:3072
  v_cmp_eq_u32 s[8:9], 5, v42
  s_nop 1
  v_cndmask_b32 v29, 0, v45, s[8:9]
  v_accvgpr_read_b32 v44, a2
  s_waitcnt lgkmcnt(9)
  v_mfma_f32_32x32x16_bf16 v[48:63], a[224:227], v[240:243], 0
  s_barrier
  buffer_load_dword a65, off, s[60:63], s3 sc1
  v_rcp_f32 v38, v38
  v_mfma_f32_32x32x16_bf16 v[208:223], a[224:227], a[228:231], 0
  ds_read_b64_tr_b16 a[224:225], v12 offset:49152
  ds_read_b64_tr_b16 a[226:227], v12 offset:50176
  ds_read_b128 a[228:231], v36 offset:4096
  v_mul_f32 v44, v44, v38
  v_accvgpr_read_b32 v46, a4
  s_waitcnt lgkmcnt(9)
  v_mfma_f32_32x32x16_bf16 v[48:63], a[232:235], v[244:247], v[48:63]
  v_cmp_eq_u32 s[8:9], 6, v42
  s_nop 1
  v_cndmask_b32 v30, 0, v45, s[8:9]
  v_cmp_eq_u32 s[8:9], 7, v42
  s_nop 1
  v_cndmask_b32 v31, 0, v45, s[8:9]
  v_mfma_f32_32x32x16_bf16 v[208:223], a[232:235], a[236:239], v[208:223]
  buffer_load_dwordx4 v5, s[16:19], s55 offen offset:3072 nt lds
  ds_read_b64_tr_b16 a[232:233], v12 offset:53248
  ds_read_b64_tr_b16 a[234:235], v12 offset:54272
  s_waitcnt lgkmcnt(8)
  v_mfma_f32_32x32x16_bf16 v[48:63], a[240:243], v[248:251], v[48:63]
  ds_read_b128 a[236:239], v36 offset:5120
  v_accvgpr_read_b32 v45, a3
  v_mul_f32 v45, v45, v38
  v_accvgpr_read_b32 v47, a5
  v_mul_f32 v46, v46, v38
  v_mul_f32 v47, v47, v38
  v_mfma_f32_32x32x16_bf16 v[208:223], a[240:243], a[244:247], v[208:223]
  ds_read_b64_tr_b16 a[240:241], v12 offset:57344
  ds_read_b64_tr_b16 a[242:243], v12 offset:58368
  ds_read_b128 a[244:247], v36 offset:6144
  v_accvgpr_read_b32 v42, a0
  v_accvgpr_read_b32 v43, a1
  s_waitcnt lgkmcnt(9)
  v_mfma_f32_32x32x16_bf16 v[48:63], a[248:251], v[252:255], v[48:63]
  v_mul_f32 v42, v42, v38
  v_mul_f32 v43, v43, v38
  v_xor_b32 v18, 4096, v16
  v_xor_b32 v20, 8192, v16
  v_xor_b32 v22, 12288, v16
  v_xor_b32 v17, 64, v16
  v_mfma_f32_32x32x16_bf16 v[208:223], a[248:251], a[252:255], v[208:223]
  ds_read_b64_tr_b16 a[248:249], v12 offset:61440
  ds_read_b64_tr_b16 a[250:251], v12 offset:62464
  ds_read_b128 a[252:255], v36 offset:7168
  v_xor_b32 v19, 4160, v16
  v_xor_b32 v21, 8256, v16
  s_waitcnt lgkmcnt(9)
  v_mfma_f32_32x32x16_bf16 v[48:63], a[224:227], v[176:179], v[48:63]
  v_xor_b32 v23, 12352, v16
  v_mfma_f32_32x32x16_bf16 v[208:223], a[224:227], a[228:231], v[208:223]
  ds_read_b64_tr_b16 a[224:225], v13 offset:32768
  ds_read_b64_tr_b16 a[226:227], v13 offset:33792
  ds_read_b64_tr_b16 a[228:229], v13 offset:36864
  s_waitcnt lgkmcnt(9)
  v_mfma_f32_32x32x16_bf16 v[48:63], a[232:235], v[180:183], v[48:63]
  s_xor_b32 s56, s44, 131072
  buffer_load_dwordx4 a[160:163], v2, s[16:19], s56 offen offset:256 nt
  ds_read_b64_tr_b16 a[230:231], v13 offset:37888
  v_mfma_f32_32x32x16_bf16 v[208:223], a[232:235], a[236:239], v[208:223]
  ds_read_b64_tr_b16 a[232:233], v13 offset:40960
  ds_read_b64_tr_b16 a[234:235], v13 offset:41984
  ds_read_b64_tr_b16 a[236:237], v13 offset:45056
  buffer_load_dword a64, off, s[64:67], 0 sc1
  s_waitcnt lgkmcnt(10)
  v_mfma_f32_32x32x16_bf16 v[48:63], a[240:243], v[184:187], v[48:63]
  ds_read_b64_tr_b16 a[238:239], v13 offset:46080
  v_mfma_f32_32x32x16_bf16 v[208:223], a[240:243], a[244:247], v[208:223]
  ds_read_b64_tr_b16 a[240:241], v13 offset:49152
  ds_read_b64_tr_b16 a[242:243], v13 offset:50176
  ds_read_b64_tr_b16 a[244:245], v13 offset:53248
  s_waitcnt lgkmcnt(11)
  v_mfma_f32_32x32x16_bf16 v[48:63], a[248:251], v[188:191], v[48:63]
  ds_read_b64_tr_b16 a[246:247], v13 offset:54272
  v_mfma_f32_32x32x16_bf16 v[208:223], a[248:251], a[252:255], v[208:223]
  ds_read_b64_tr_b16 a[248:249], v13 offset:57344
  ds_read_b64_tr_b16 a[250:251], v13 offset:58368
  s_waitcnt lgkmcnt(10)
  v_mfma_f32_32x32x16_bf16 v[224:239], a[224:227], v[240:243], 0
  buffer_load_dwordx4 a[164:167], v3, s[16:19], s56 offen offset:1280 nt
  ds_read_b64_tr_b16 a[252:253], v13 offset:61440
  ds_read_b64_tr_b16 a[254:255], v13 offset:62464
  ds_read_b64_tr_b16 a[224:225], v14 offset:32768
  v_mfma_f32_32x32x16_bf16 v[224:239], a[228:231], v[244:247], v[224:239]
  ds_read_b64_tr_b16 a[226:227], v14 offset:33792
  s_waitcnt lgkmcnt(10)
  v_mfma_f32_32x32x16_bf16 v[224:239], a[232:235], v[248:251], v[224:239]
  ds_read_b64_tr_b16 a[228:229], v14 offset:36864
  ds_read_b64_tr_b16 a[230:231], v14 offset:37888
  ds_read_b64_tr_b16 a[232:233], v14 offset:40960
  v_mfma_f32_32x32x16_bf16 v[224:239], a[236:239], v[252:255], v[224:239]
  ds_read_b64_tr_b16 a[234:235], v14 offset:41984
  s_waitcnt lgkmcnt(10)
  v_mfma_f32_32x32x16_bf16 v[224:239], a[240:243], v[176:179], v[224:239]
  ds_read_b64_tr_b16 a[236:237], v14 offset:45056
  ds_read_b64_tr_b16 a[238:239], v14 offset:46080
  ds_read_b64_tr_b16 a[240:241], v14 offset:49152
  v_mfma_f32_32x32x16_bf16 v[224:239], a[244:247], v[180:183], v[224:239]
  ds_read_b64_tr_b16 a[242:243], v14 offset:50176
  s_waitcnt lgkmcnt(10)
  v_mfma_f32_32x32x16_bf16 v[224:239], a[248:251], v[184:187], v[224:239]
  ds_read_b64_tr_b16 a[244:245], v14 offset:53248
  ds_read_b64_tr_b16 a[246:247], v14 offset:54272
  ds_read_b64_tr_b16 a[248:249], v14 offset:57344
  v_mfma_f32_32x32x16_bf16 v[224:239], a[252:255], v[188:191], v[224:239]
  buffer_load_dwordx4 a[168:171], v4, s[16:19], s56 offen offset:2304 nt
  ds_read_b64_tr_b16 a[250:251], v14 offset:58368
  s_waitcnt lgkmcnt(10)
  v_mfma_f32_32x32x16_bf16 v[80:95], a[224:227], v[240:243], 0
  ds_read_b64_tr_b16 a[252:253], v14 offset:61440
  ds_read_b64_tr_b16 a[254:255], v14 offset:62464
  ds_read_b64_tr_b16 a[224:225], v15 offset:32768
  v_mfma_f32_32x32x16_bf16 v[80:95], a[228:231], v[244:247], v[80:95]
  ds_read_b64_tr_b16 a[226:227], v15 offset:33792
  s_waitcnt lgkmcnt(10)
  v_mfma_f32_32x32x16_bf16 v[80:95], a[232:235], v[248:251], v[80:95]
  ds_read_b64_tr_b16 a[228:229], v15 offset:36864
  ds_read_b64_tr_b16 a[230:231], v15 offset:37888
  ds_read_b64_tr_b16 a[232:233], v15 offset:40960
  v_mfma_f32_32x32x16_bf16 v[80:95], a[236:239], v[252:255], v[80:95]
  ds_read_b64_tr_b16 a[234:235], v15 offset:41984
  s_waitcnt lgkmcnt(10)
  v_mfma_f32_32x32x16_bf16 v[80:95], a[240:243], v[176:179], v[80:95]
  ds_read_b64_tr_b16 a[236:237], v15 offset:45056
  ds_read_b64_tr_b16 a[238:239], v15 offset:46080
  ds_read_b64_tr_b16 a[240:241], v15 offset:49152
  v_mfma_f32_32x32x16_bf16 v[80:95], a[244:247], v[180:183], v[80:95]
  ds_read_b64_tr_b16 a[242:243], v15 offset:50176
  s_waitcnt lgkmcnt(10)
  v_mfma_f32_32x32x16_bf16 v[80:95], a[248:251], v[184:187], v[80:95]
  buffer_load_dwordx4 a[172:175], v5, s[16:19], s56 offen offset:3328 nt
  ds_read_b64_tr_b16 a[244:245], v15 offset:53248
  ds_read_b64_tr_b16 a[246:247], v15 offset:54272
  ds_read_b64_tr_b16 a[248:249], v15 offset:57344
  v_mfma_f32_32x32x16_bf16 v[80:95], a[252:255], v[188:191], v[80:95]
  ds_read_b64_tr_b16 a[250:251], v15 offset:58368
  s_waitcnt vmcnt(5)
  s_barrier
L_RS13:
  s_waitcnt lgkmcnt(10)
  v_mfma_f32_32x32x16_bf16 v[160:175], a[224:227], v[240:243], 0
  ds_read_b64_tr_b16 a[252:253], v15 offset:61440
  ds_read_b64_tr_b16 a[254:255], v15 offset:62464
  ds_read_b64_tr_b16 a[224:225], v12 offset:0
  v_cvt_pk_bf16_f32 v241, v44, v45
  v_accvgpr_read_b32 v44, a8
  v_accvgpr_read_b32 v45, a9
  v_mfma_f32_32x32x16_bf16 v[160:175], a[228:231], v[244:247], v[160:175]
  ds_read_b64_tr_b16 a[226:227], v12 offset:1024
  v_mul_f32 v44, v44, v38
  v_mul_f32 v45, v45, v38
  v_cvt_pk_bf16_f32 v242, v46, v47
  v_cvt_pk_bf16_f32 v244, v44, v45
  s_waitcnt lgkmcnt(10)
  v_mfma_f32_32x32x16_bf16 v[160:175], a[232:235], v[248:251], v[160:175]
  ds_read_b128 a[228:231], v36 offset:8192
  ds_read_b64_tr_b16 a[232:233], v12 offset:4096
  ds_read_b64_tr_b16 a[234:235], v12 offset:5120
  v_accvgpr_read_b32 v46, a10
  v_accvgpr_read_b32 v47, a11
  v_accvgpr_read_b32 v44, a14
  v_mfma_f32_32x32x16_bf16 v[160:175], a[236:239], v[252:255], v[160:175]
  ds_read_b128 a[236:239], v36 offset:9216
  v_accvgpr_read_b32 v45, a15
  v_mul_f32 v46, v46, v38
  v_mul_f32 v47, v47, v38
  v_mul_f32 v44, v44, v38
  s_waitcnt lgkmcnt(10)
  v_mfma_f32_32x32x16_bf16 v[160:175], a[240:243], v[176:179], v[160:175]
  s_xor_b32 s56, s44, 163840
  buffer_load_dwordx4 a[176:179], v2, s[16:19], s56 offen offset:256 nt
  ds_read_b64_tr_b16 a[240:241], v12 offset:8192
  ds_read_b64_tr_b16 a[242:243], v12 offset:9216
  v_mfma_f32_32x32x16_bf16 v[160:175], a[244:247], v[180:183], v[160:175]
  ds_read_b128 a[244:247], v36 offset:10240
  v_mul_f32 v45, v45, v38
  v_cvt_pk_bf16_f32 v245, v46, v47
  v_cvt_pk_bf16_f32 v247, v44, v45
  v_accvgpr_read_b32 v46, a16
  s_waitcnt lgkmcnt(9)
  v_mfma_f32_32x32x16_bf16 v[160:175], a[248:251], v[184:187], v[160:175]
  ds_read_b64_tr_b16 a[248:249], v12 offset:12288
  ds_read_b64_tr_b16 a[250:251], v12 offset:13312
  v_accvgpr_read_b32 v47, a17
  v_accvgpr_read_b32 v44, a20
  v_accvgpr_read_b32 v45, a21
  v_mul_f32 v46, v46, v38
  v_mfma_f32_32x32x16_bf16 v[160:175], a[252:255], v[188:191], v[160:175]
  ds_read_b128 a[252:255], v36 offset:11264
  v_mul_f32 v47, v47, v38
  v_mul_f32 v44, v44, v38
  v_mul_f32 v45, v45, v38
  v_cvt_pk_bf16_f32 v248, v46, v47
  s_waitcnt lgkmcnt(9)
  v_mfma_f32_32x32x16_bf16 v[48:63], a[224:227], v[64:67], v[48:63]
  s_barrier
  ds_write_b32 v35, v39
  v_cvt_pk_bf16_f32 v250, v44, v45
  v_accvgpr_read_b32 v46, a22
  v_accvgpr_read_b32 v47, a23
  v_mfma_f32_32x32x16_bf16 v[208:223], a[224:227], a[228:231], v[208:223]
  ds_read_b64_tr_b16 a[224:225], v12 offset:16384
  ds_read_b64_tr_b16 a[226:227], v12 offset:17408
  ds_read_b128 a[228:231], v36 offset:12288
  v_accvgpr_read_b32 v44, a26
  v_accvgpr_read_b32 v45, a27
  s_waitcnt lgkmcnt(10)
  v_mfma_f32_32x32x16_bf16 v[48:63], a[232:235], v[68:71], v[48:63]
  v_mul_f32 v46, v46, v38
  v_mul_f32 v47, v47, v38
  v_mul_f32 v44, v44, v38
  v_mul_f32 v45, v45, v38
  v_cvt_pk_bf16_f32 v251, v46, v47
  v_cvt_pk_bf16_f32 v253, v44, v45
  v_mfma_f32_32x32x16_bf16 v[208:223], a[232:235], a[236:239], v[208:223]
  buffer_load_dwordx4 a[180:183], v3, s[16:19], s56 offen offset:1280 nt
  ds_read_b64_tr_b16 a[232:233], v12 offset:20480
  ds_read_b64_tr_b16 a[234:235], v12 offset:21504
  s_waitcnt lgkmcnt(9)
  v_mfma_f32_32x32x16_bf16 v[48:63], a[240:243], v[72:75], v[48:63]
  ds_read_b128 a[236:239], v36 offset:13312
  v_accvgpr_read_b32 v46, a28
  v_accvgpr_read_b32 v47, a29
  v_accvgpr_read_b32 v44, a32
  v_accvgpr_read_b32 v45, a33
  v_mul_f32 v46, v46, v38
  v_mfma_f32_32x32x16_bf16 v[208:223], a[240:243], a[244:247], v[208:223]
  ds_read_b64_tr_b16 a[240:241], v12 offset:24576
  ds_read_b64_tr_b16 a[242:243], v12 offset:25600
  ds_read_b128 a[244:247], v36 offset:14336
  v_mul_f32 v47, v47, v38
  v_mul_f32 v44, v44, v38
  s_waitcnt lgkmcnt(10)
  v_mfma_f32_32x32x16_bf16 v[48:63], a[248:251], v[76:79], v[48:63]
  v_mul_f32 v45, v45, v38
  v_cvt_pk_bf16_f32 v254, v46, v47
  v_cvt_pk_bf16_f32 v176, v44, v45
  v_accvgpr_read_b32 v46, a34
  v_accvgpr_read_b32 v47, a35
  v_accvgpr_read_b32 v44, a38
  v_mfma_f32_32x32x16_bf16 v[208:223], a[248:251], a[252:255], v[208:223]
  ds_read_b64_tr_b16 a[248:249], v12 offset:28672
  ds_read_b64_tr_b16 a[250:251], v12 offset:29696
  ds_read_b128 a[252:255], v36 offset:15360
  v_add_u32 v12, 65536, v12
  v_accvgpr_read_b32 v45, a39
  s_waitcnt lgkmcnt(9)
  v_mfma_f32_32x32x16_bf16 v[48:63], a[224:227], v[96:99], v[48:63]
  v_mul_f32 v46, v46, v38
  v_mul_f32 v47, v47, v38
  v_mul_f32 v44, v44, v38
  v_mul_f32 v45, v45, v38
  v_cvt_pk_bf16_f32 v177, v46, v47
  v_cvt_pk_bf16_f32 v179, v44, v45
  v_mfma_f32_32x32x16_bf16 v[208:223], a[224:227], a[228:231], v[208:223]
  buffer_load_dwordx4 a[184:187], v4, s[16:19], s56 offen offset:2304 nt
  ds_read_b64_tr_b16 a[224:225], v13 offset:0
  ds_read_b64_tr_b16 a[226:227], v13 offset:1024
  s_waitcnt lgkmcnt(8)
  v_mfma_f32_32x32x16_bf16 v[48:63], a[232:235], v[100:103], v[48:63]
  ds_read_b64_tr_b16 a[228:229], v13 offset:4096
  ds_read_b64_tr_b16 a[230:231], v13 offset:5120
  v_accvgpr_read_b32 v46, a40
  v_accvgpr_read_b32 v47, a41
  v_accvgpr_read_b32 v44, a44
  v_accvgpr_read_b32 v45, a45
  v_mfma_f32_32x32x16_bf16 v[208:223], a[232:235], a[236:239], v[208:223]
  ds_read_b64_tr_b16 a[232:233], v13 offset:8192
  ds_read_b64_tr_b16 a[234:235], v13 offset:9216
  ds_read_b64_tr_b16 a[236:237], v13 offset:12288
  v_mul_f32 v46, v46, v38
  v_mul_f32 v47, v47, v38
  s_waitcnt lgkmcnt(10)
  v_mfma_f32_32x32x16_bf16 v[48:63], a[240:243], v[104:107], v[48:63]
  ds_read_b64_tr_b16 a[238:239], v13 offset:13312
  v_mul_f32 v44, v44, v38
  v_mul_f32 v45, v45, v38
  v_cvt_pk_bf16_f32 v180, v46, v47
  v_cvt_pk_bf16_f32 v182, v44, v45
  v_accvgpr_read_b32 v46, a46
  v_mfma_f32_32x32x16_bf16 v[208:223], a[240:243], a[244:247], v[208:223]
  ds_read_b64_tr_b16 a[240:241], v13 offset:16384
  ds_read_b64_tr_b16 a[242:243], v13 offset:17408
  ds_read_b64_tr_b16 a[244:245], v13 offset:20480
  v_accvgpr_read_b32 v47, a47
  v_accvgpr_read_b32 v44, a50
  s_waitcnt lgkmcnt(11)
  v_mfma_f32_32x32x16_bf16 v[48:63], a[248:251], v[108:111], v[48:63]
  ds_read_b64_tr_b16 a[246:247], v13 offset:21504
  s_waitcnt vmcnt(7)
  ds_write_b128 v7, a[160:163] offset:32768
  v_mfma_f32_32x32x16_bf16 v[208:223], a[248:251], a[252:255], v[208:223]
  ds_read_b64_tr_b16 a[248:249], v13 offset:24576
  v_accvgpr_read_b32 v45, a51
  v_mul_f32 v46, v46, v38
  v_mul_f32 v47, v47, v38
  v_mul_f32 v44, v44, v38
  s_waitcnt lgkmcnt(10)
  v_mfma_f32_32x32x16_bf16 v[224:239], a[224:227], v[64:67], v[224:239]
  buffer_load_dwordx4 a[188:191], v5, s[16:19], s56 offen offset:3328 nt
  ds_read_b64_tr_b16 a[250:251], v13 offset:25600
  ds_read_b64_tr_b16 a[252:253], v13 offset:28672
  ds_read_b64_tr_b16 a[254:255], v13 offset:29696
  v_mfma_f32_32x32x16_bf16 v[224:239], a[228:231], v[68:71], v[224:239]
  s_waitcnt vmcnt(6)
  ds_write_b128 v7, a[164:167] offset:33792
  s_waitcnt lgkmcnt(10)
  v_mfma_f32_32x32x16_bf16 v[224:239], a[232:235], v[72:75], v[224:239]
  ds_read_b64_tr_b16 a[224:225], v14 offset:0
  ds_read_b64_tr_b16 a[226:227], v14 offset:1024
  ds_read_b64_tr_b16 a[228:229], v14 offset:4096
  v_add_u32 v13, 65536, v13
  v_mul_f32 v45, v45, v38
  v_cvt_pk_bf16_f32 v183, v46, v47
  v_mfma_f32_32x32x16_bf16 v[224:239], a[236:239], v[76:79], v[224:239]
  ds_read_b64_tr_b16 a[230:231], v14 offset:5120
  v_cvt_pk_bf16_f32 v185, v44, v45
  v_accvgpr_read_b32 v46, a52
  v_accvgpr_read_b32 v47, a53
  v_accvgpr_read_b32 v44, a56
  s_waitcnt lgkmcnt(10)
  v_mfma_f32_32x32x16_bf16 v[224:239], a[240:243], v[96:99], v[224:239]
  s_waitcnt vmcnt(5)
  ds_write_b128 v7, a[168:171] offset:34816
  ds_read_b64_tr_b16 a[232:233], v14 offset:8192
  ds_read_b64_tr_b16 a[234:235], v14 offset:9216
  v_mfma_f32_32x32x16_bf16 v[224:239], a[244:247], v[100:103], v[224:239]
  ds_read_b64_tr_b16 a[236:237], v14 offset:12288
  v_accvgpr_read_b32 v45, a57
  v_mul_f32 v46, v46, v38
  v_mul_f32 v47, v47, v38
  v_mul_f32 v44, v44, v38
  s_waitcnt lgkmcnt(9)
  v_mfma_f32_32x32x16_bf16 v[224:239], a[248:251], v[104:107], v[224:239]
  ds_read_b64_tr_b16 a[238:239], v14 offset:13312
  s_waitcnt vmcnt(4)
  ds_write_b128 v7, a[172:175] offset:35840
  ds_read_b64_tr_b16 a[240:241], v14 offset:16384
  v_mfma_f32_32x32x16_bf16 v[224:239], a[252:255], v[108:111], v[224:239]
  s_add_u32 m0, s42, 65536
  s_xor_b32 s55, s44, 196864
  buffer_load_dwordx4 v2, s[16:19], s55 offen offset:0 nt lds
  ds_read_b64_tr_b16 a[242:243], v14 offset:17408
  ds_read_b64_tr_b16 a[244:245], v14 offset:20480
  s_waitcnt lgkmcnt(9)
  v_mfma_f32_32x32x16_bf16 v[80:95], a[224:227], v[64:67], v[80:95]
  ds_read_b64_tr_b16 a[246:247], v14 offset:21504
  s_waitcnt vmcnt(4)
  ds_write_b128 v7, a[176:179] offset:36864
  ds_read_b64_tr_b16 a[248:249], v14 offset:24576
  v_mfma_f32_32x32x16_bf16 v[80:95], a[228:231], v[68:71], v[80:95]
  ds_read_b64_tr_b16 a[250:251], v14 offset:25600
  ds_read_b64_tr_b16 a[252:253], v14 offset:28672
  v_mul_f32 v45, v45, v38
  v_cvt_pk_bf16_f32 v186, v46, v47
  v_cvt_pk_bf16_f32 v188, v44, v45
  s_waitcnt lgkmcnt(9)
  v_mfma_f32_32x32x16_bf16 v[80:95], a[232:235], v[72:75], v[80:95]
  ds_read_b64_tr_b16 a[254:255], v14 offset:29696
  s_waitcnt vmcnt(3)
  ds_write_b128 v7, a[180:183] offset:37888
  ds_read_b64_tr_b16 a[224:225], v15 offset:0
  v_mfma_f32_32x32x16_bf16 v[80:95], a[236:239], v[76:79], v[80:95]
  ds_read_b64_tr_b16 a[226:227], v15 offset:1024
  ds_read_b64_tr_b16 a[228:229], v15 offset:4096
  v_add_u32 v14, 65536, v14
  v_accvgpr_read_b32 v46, a58
  v_accvgpr_read_b32 v47, a59
  s_waitcnt lgkmcnt(9)
  v_mfma_f32_32x32x16_bf16 v[80:95], a[240:243], v[96:99], v[80:95]
  ds_read_b64_tr_b16 a[230:231], v15 offset:5120
  s_waitcnt vmcnt(2)
  ds_write_b128 v7, a[184:187] offset:38912
  ds_read_b64_tr_b16 a[232:233], v15 offset:8192
  v_mfma_f32_32x32x16_bf16 v[80:95], a[244:247], v[100:103], v[80:95]
  buffer_load_dwordx4 v3, s[16:19], s55 offen offset:1024 nt lds
  ds_read_b64_tr_b16 a[234:235], v15 offset:9216
  ds_read_b64_tr_b16 a[236:237], v15 offset:12288
  s_waitcnt lgkmcnt(9)
  v_mfma_f32_32x32x16_bf16 v[80:95], a[248:251], v[104:107], v[80:95]
  ds_read_b64_tr_b16 a[238:239], v15 offset:13312
  s_waitcnt vmcnt(2)
  ds_write_b128 v7, a[188:191] offset:39936
  ds_read_b64_tr_b16 a[240:241], v15 offset:16384
  v_mfma_f32_32x32x16_bf16 v[80:95], a[252:255], v[108:111], v[80:95]
  ds_read_b64_tr_b16 a[242:243], v15 offset:17408
  ds_read_b64_tr_b16 a[244:245], v15 offset:20480
  v_accvgpr_read_b32 v44, a62
  v_accvgpr_read_b32 v45, a63
  v_mul_f32 v46, v46, v38
  s_waitcnt lgkmcnt(9)
  v_mfma_f32_32x32x16_bf16 v[160:175], a[224:227], v[64:67], v[160:175]
  ds_read_b64_tr_b16 a[246:247], v15 offset:21504
  ds_read_b64_tr_b16 a[248:249], v15 offset:24576
  ds_read_b64_tr_b16 a[250:251], v15 offset:25600
  v_mul_f32 v47, v47, v38
  v_mul_f32 v44, v44, v38
  v_mul_f32 v45, v45, v38
  v_mfma_f32_32x32x16_bf16 v[160:175], a[228:231], v[68:71], v[160:175]
  ds_read_b64_tr_b16 a[252:253], v15 offset:28672
  ds_read_b64_tr_b16 a[254:255], v15 offset:29696
  s_waitcnt lgkmcnt(8)
  s_barrier
L_RS14:
  ds_read_b64_tr_b16 a[224:225], v12 offset:32768
  v_mfma_f32_32x32x16_bf16 v[160:175], a[232:235], v[72:75], v[160:175]
  ds_read_b64_tr_b16 a[226:227], v12 offset:33792
  ds_read_b128 a[228:231], v36 offset:16384
  ds_read_b64_tr_b16 a[232:233], v12 offset:36864
  v_add_u32 v15, 65536, v15
  v_cvt_pk_bf16_f32 v189, v46, v47
  v_cvt_pk_bf16_f32 v191, v44, v45
  v_mfma_f32_32x32x16_bf16 v[160:175], a[236:239], v[76:79], v[160:175]
  ds_read_b64_tr_b16 a[234:235], v12 offset:37888
  ds_read_b128 a[236:239], v36 offset:17408
  v_cvt_pk_bf16_f32 v240, v42, v43
  v_accvgpr_read_b32 v42, a6
  v_accvgpr_read_b32 v43, a7
  s_waitcnt lgkmcnt(10)
  v_mfma_f32_32x32x16_bf16 v[160:175], a[240:243], v[96:99], v[160:175]
  buffer_load_dwordx4 v4, s[16:19], s55 offen offset:2048 nt lds
  ds_read_b64_tr_b16 a[240:241], v12 offset:40960
  ds_read_b64_tr_b16 a[242:243], v12 offset:41984
  v_mfma_f32_32x32x16_bf16 v[160:175], a[244:247], v[100:103], v[160:175]
  ds_read_b128 a[244:247], v36 offset:18432
  ds_read_b32 v44, v6 offset:0
  v_mul_f32 v42, v42, v38
  v_mul_f32 v43, v43, v38
  v_cvt_pk_bf16_f32 v243, v42, v43
  s_waitcnt lgkmcnt(10)
  v_mfma_f32_32x32x16_bf16 v[160:175], a[248:251], v[104:107], v[160:175]
  ds_read_b64_tr_b16 a[248:249], v12 offset:45056
  ds_read_b64_tr_b16 a[250:251], v12 offset:46080
  ds_read_b32 v45, v6 offset:256
  v_accvgpr_read_b32 v42, a12
  v_accvgpr_read_b32 v43, a13
  v_mul_f32 v42, v42, v38
  v_mfma_f32_32x32x16_bf16 v[160:175], a[252:255], v[108:111], v[160:175]
  ds_read_b128 a[252:255], v36 offset:19456
  v_mul_f32 v43, v43, v38
  v_cvt_pk_bf16_f32 v246, v42, v43
  v_accvgpr_read_b32 v42, a18
  v_accvgpr_read_b32 v43, a19
  s_waitcnt lgkmcnt(11)
  v_mfma_f32_32x32x16_bf16 v[48:63], a[224:227], v[144:147], v[48:63]
  s_barrier
  ds_read_b32 v46, v6 offset:512
  ds_read_b32 v47, v6 offset:768
  v_mul_f32 v42, v42, v38
  v_mul_f32 v43, v43, v38
  v_mfma_f32_32x32x16_bf16 v[208:223], a[224:227], a[228:231], v[208:223]
  ds_read_b64_tr_b16 a[224:225], v12 offset:49152
  v_cvt_pk_bf16_f32 v249, v42, v43
  v_accvgpr_read_b32 v42, a24
  v_accvgpr_read_b32 v43, a25
  v_mul_f32 v42, v42, v38
  s_waitcnt lgkmcnt(11)
  v_mfma_f32_32x32x16_bf16 v[48:63], a[232:235], v[148:151], v[48:63]
  buffer_load_dwordx4 v5, s[16:19], s55 offen offset:3072 nt lds
  ds_read_b64_tr_b16 a[226:227], v12 offset:50176
  ds_read_b128 a[228:231], v36 offset:20480
  v_mfma_f32_32x32x16_bf16 v[208:223], a[232:235], a[236:239], v[208:223]
  ds_read_b64_tr_b16 a[232:233], v12 offset:53248
  s_waitcnt lgkmcnt(7)
  v_add_f32 v44, v44, v45
  ds_read_b64_tr_b16 a[234:235], v12 offset:54272
  ds_read_b128 a[236:239], v36 offset:21504
  v_mfma_f32_32x32x16_bf16 v[48:63], a[240:243], v[152:155], v[48:63]
  s_waitcnt lgkmcnt(6)
  v_add_f32 v46, v46, v47
  v_add_f32 v39, v44, v46
  v_subrev_u32 v44, s58, v39
  v_mul_f32 v43, v43, v38
  v_cvt_pk_bf16_f32 v252, v42, v43
  v_mfma_f32_32x32x16_bf16 v[208:223], a[240:243], a[244:247], v[208:223]
  ds_read_b64_tr_b16 a[240:241], v12 offset:57344
  ds_read_b64_tr_b16 a[242:243], v12 offset:58368
  ds_read_b128 a[244:247], v36 offset:22528
  v_accvgpr_read_b32 v42, a30
  v_accvgpr_read_b32 v43, a31
  v_mul_f32 v42, v42, v38
  v_mfma_f32_32x32x16_bf16 v[48:63], a[248:251], v[156:159], v[48:63]
  v_cmp_le_u32 vcc, s59, v44
  s_nop 1
  s_cbranch_vccnz L_slow
L_checked:
  v_mul_f32 v43, v43, v38
  v_cvt_pk_bf16_f32 v255, v42, v43
  v_mfma_f32_32x32x16_bf16 v[208:223], a[248:251], a[252:255], v[208:223]
  ds_read_b64_tr_b16 a[248:249], v12 offset:61440
  ds_read_b64_tr_b16 a[250:251], v12 offset:62464
  ds_read_b128 a[252:255], v36 offset:23552
  v_accvgpr_read_b32 v42, a36
  v_accvgpr_read_b32 v43, a37
  s_waitcnt lgkmcnt(9)
  v_mfma_f32_32x32x16_bf16 v[48:63], a[224:227], v[192:195], v[48:63]
  v_mul_f32 v42, v42, v38
  v_mul_f32 v43, v43, v38
  v_cvt_pk_bf16_f32 v178, v42, v43
  v_accvgpr_read_b32 v42, a42
  v_accvgpr_read_b32 v43, a43
  v_mul_f32 v42, v42, v38
  v_mfma_f32_32x32x16_bf16 v[208:223], a[224:227], a[228:231], v[208:223]
  s_add_u32 m0, s42, 69632
  s_xor_b32 s55, s44, 229632
  buffer_load_dwordx4 v2, s[16:19], s55 offen offset:0 nt lds
  ds_read_b64_tr_b16 a[224:225], v13 offset:32768
  ds_read_b64_tr_b16 a[226:227], v13 offset:33792
  s_waitcnt lgkmcnt(8)
  v_mfma_f32_32x32x16_bf16 v[48:63], a[232:235], v[196:199], v[48:63]
  ds_read_b64_tr_b16 a[228:229], v13 offset:36864
  ds_read_b64_tr_b16 a[230:231], v13 offset:37888
  v_mul_f32 v43, v43, v38
  v_cvt_pk_bf16_f32 v181, v42, v43
  v_accvgpr_read_b32 v42, a48
  v_accvgpr_read_b32 v43, a49
  v_mfma_f32_32x32x16_bf16 v[208:223], a[232:235], a[236:239], v[208:223]
  ds_read_b64_tr_b16 a[232:233], v13 offset:40960
  ds_read_b64_tr_b16 a[234:235], v13 offset:41984
  ds_read_b64_tr_b16 a[236:237], v13 offset:45056
  v_mul_f32 v42, v42, v38
  v_mul_f32 v43, v43, v38
  s_waitcnt lgkmcnt(10)
  v_mfma_f32_32x32x16_bf16 v[48:63], a[240:243], v[200:203], v[48:63]
  ds_read_b64_tr_b16 a[238:239], v13 offset:46080
  v_cvt_pk_bf16_f32 v184, v42, v43
  v_accvgpr_read_b32 v42, a54
  v_accvgpr_read_b32 v43, a55
  v_mul_f32 v42, v42, v38
  v_mul_f32 v43, v43, v38
  v_mfma_f32_32x32x16_bf16 v[208:223], a[240:243], a[244:247], v[208:223]
  ds_read_b64_tr_b16 a[240:241], v13 offset:49152
  ds_read_b64_tr_b16 a[242:243], v13 offset:50176
  ds_read_b64_tr_b16 a[244:245], v13 offset:53248
  v_cvt_pk_bf16_f32 v187, v42, v43
  v_accvgpr_read_b32 v42, a60
  s_waitcnt lgkmcnt(11)
  v_mfma_f32_32x32x16_bf16 v[48:63], a[248:251], v[204:207], v[48:63]
  ds_read_b64_tr_b16 a[246:247], v13 offset:54272
  v_accvgpr_read_b32 v43, a61
  v_mul_f32 v42, v42, v38
  v_mul_f32 v43, v43, v38
  v_cvt_pk_bf16_f32 v190, v42, v43
  v_accvgpr_read_b32 v46, a192
  v_mfma_f32_32x32x16_bf16 v[208:223], a[248:251], a[252:255], v[208:223]
  ds_read_b64_tr_b16 a[248:249], v13 offset:57344
  ds_read_b64_tr_b16 a[250:251], v13 offset:58368
  v_rcp_f32 v39, v39
  v_accvgpr_read_b32 v47, a193
  s_waitcnt lgkmcnt(10)
  v_mfma_f32_32x32x16_bf16 v[224:239], a[224:227], v[144:147], v[224:239]
  buffer_load_dwordx4 v3, s[16:19], s55 offen offset:1024 nt lds
  ds_read_b64_tr_b16 a[252:253], v13 offset:61440
  ds_read_b64_tr_b16 a[254:255], v13 offset:62464
  v_mfma_f32_32x32x16_bf16 v[224:239], a[228:231], v[148:151], v[224:239]
  ds_read_b64_tr_b16 a[224:225], v14 offset:32768
  ds_read_b64_tr_b16 a[226:227], v14 offset:33792
  v_accvgpr_read_b32 v42, a194
  v_accvgpr_read_b32 v43, a195
  v_mul_f32 v46, v46, v39
  s_waitcnt lgkmcnt(10)
  v_mfma_f32_32x32x16_bf16 v[224:239], a[232:235], v[152:155], v[224:239]
  ds_read_b64_tr_b16 a[228:229], v14 offset:36864
  ds_read_b64_tr_b16 a[230:231], v14 offset:37888
  ds_read_b64_tr_b16 a[232:233], v14 offset:40960
  v_mul_f32 v47, v47, v39
  v_mul_f32 v42, v42, v39
  v_mul_f32 v43, v43, v39
  v_mfma_f32_32x32x16_bf16 v[224:239], a[236:239], v[156:159], v[224:239]
  ds_read_b64_tr_b16 a[234:235], v14 offset:41984
  v_cvt_pk_bf16_f32 v64, v46, v47
  v_cvt_pk_bf16_f32 v65, v42, v43
  v_accvgpr_read_b32 v44, a196
  v_accvgpr_read_b32 v45, a197
  s_waitcnt lgkmcnt(10)
  v_mfma_f32_32x32x16_bf16 v[224:239], a[240:243], v[192:195], v[224:239]
  ds_read_b64_tr_b16 a[236:237], v14 offset:45056
  ds_read_b64_tr_b16 a[238:239], v14 offset:46080
  ds_read_b64_tr_b16 a[240:241], v14 offset:49152
  v_accvgpr_read_b32 v46, a198
  v_accvgpr_read_b32 v47, a199
  v_accvgpr_read_b32 v42, a200
  v_mfma_f32_32x32x16_bf16 v[224:239], a[244:247], v[196:199], v[224:239]
  ds_read_b64_tr_b16 a[242:243], v14 offset:50176
  v_accvgpr_read_b32 v43, a201
  v_mul_f32 v44, v44, v39
  v_mul_f32 v45, v45, v39
  v_mul_f32 v46, v46, v39
  s_waitcnt lgkmcnt(10)
  v_mfma_f32_32x32x16_bf16 v[224:239], a[248:251], v[200:203], v[224:239]
  buffer_load_dwordx4 v4, s[16:19], s55 offen offset:2048 nt lds
  ds_read_b64_tr_b16 a[244:245], v14 offset:53248
  ds_read_b64_tr_b16 a[246:247], v14 offset:54272
  v_mfma_f32_32x32x16_bf16 v[224:239], a[252:255], v[204:207], v[224:239]
  ds_read_b64_tr_b16 a[248:249], v14 offset:57344
  ds_read_b64_tr_b16 a[250:251], v14 offset:58368
  v_mul_f32 v47, v47, v39
  v_mul_f32 v42, v42, v39
  v_mul_f32 v43, v43, v39
  s_waitcnt lgkmcnt(10)
  v_mfma_f32_32x32x16_bf16 v[80:95], a[224:227], v[144:147], v[80:95]
  ds_read_b64_tr_b16 a[252:253], v14 offset:61440
  ds_read_b64_tr_b16 a[254:255], v14 offset:62464
  ds_read_b64_tr_b16 a[224:225], v15 offset:32768
  v_cvt_pk_bf16_f32 v66, v44, v45
  v_cvt_pk_bf16_f32 v67, v46, v47
  v_cvt_pk_bf16_f32 v68, v42, v43
  v_mfma_f32_32x32x16_bf16 v[80:95], a[228:231], v[148:151], v[80:95]
  ds_read_b64_tr_b16 a[226:227], v15 offset:33792
  v_accvgpr_read_b32 v44, a202
  v_accvgpr_read_b32 v45, a203
  v_accvgpr_read_b32 v46, a204
  v_accvgpr_read_b32 v47, a205
  s_waitcnt lgkmcnt(10)
  v_mfma_f32_32x32x16_bf16 v[80:95], a[232:235], v[152:155], v[80:95]
  ds_read_b64_tr_b16 a[228:229], v15 offset:36864
  ds_read_b64_tr_b16 a[230:231], v15 offset:37888
  ds_read_b64_tr_b16 a[232:233], v15 offset:40960
  v_accvgpr_read_b32 v42, a206
  v_accvgpr_read_b32 v43, a207
  v_mul_f32 v44, v44, v39
  v_mfma_f32_32x32x16_bf16 v[80:95], a[236:239], v[156:159], v[80:95]
  ds_read_b64_tr_b16 a[234:235], v15 offset:41984
  v_mul_f32 v45, v45, v39
  v_mul_f32 v46, v46, v39
  v_mul_f32 v47, v47, v39
  v_mul_f32 v42, v42, v39
  s_waitcnt lgkmcnt(10)
  v_mfma_f32_32x32x16_bf16 v[80:95], a[240:243], v[192:195], v[80:95]
  ds_read_b64_tr_b16 a[236:237], v15 offset:45056
  ds_read_b64_tr_b16 a[238:239], v15 offset:46080
  ds_read_b64_tr_b16 a[240:241], v15 offset:49152
  v_mul_f32 v43, v43, v39
  v_cvt_pk_bf16_f32 v69, v44, v45
  v_cvt_pk_bf16_f32 v70, v46, v47
  v_mfma_f32_32x32x16_bf16 v[80:95], a[244:247], v[196:199], v[80:95]
  buffer_load_dwordx4 v5, s[16:19], s55 offen offset:3072 nt lds
  ds_read_b64_tr_b16 a[242:243], v15 offset:50176
  s_waitcnt lgkmcnt(10)
  v_mfma_f32_32x32x16_bf16 v[80:95], a[248:251], v[200:203], v[80:95]
  ds_read_b64_tr_b16 a[244:245], v15 offset:53248
  ds_read_b64_tr_b16 a[246:247], v15 offset:54272
  ds_read_b64_tr_b16 a[248:249], v15 offset:57344
  v_cvt_pk_bf16_f32 v71, v42, v43
  v_xor_b32 v6, 0x800, v37
  s_mov_b32 s16, s28
  v_mfma_f32_32x32x16_bf16 v[80:95], a[252:255], v[204:207], v[80:95]
  ds_read_b64_tr_b16 a[250:251], v15 offset:58368
  s_waitcnt vmcnt(0)
  s_barrier
L_RS15:
  s_mov_b32 s17, s29
  s_waitcnt lgkmcnt(10)
  v_mfma_f32_32x32x16_bf16 v[160:175], a[224:227], v[144:147], v[160:175]
  ds_read_b64_tr_b16 a[252:253], v15 offset:61440
  ds_read_b64_tr_b16 a[254:255], v15 offset:62464
  ds_read_b64_tr_b16 a[224:225], v12 offset:0
  v_mov_b32 v40, 1
  v_mfma_f32_32x32x16_bf16 v[160:175], a[228:231], v[148:151], v[160:175]
  ds_read_b64_tr_b16 a[226:227], v12 offset:1024
  s_waitcnt lgkmcnt(10)
  v_mfma_f32_32x32x16_bf16 v[160:175], a[232:235], v[152:155], v[160:175]
  ds_read_b128 a[228:231], v36 offset:24576
  ds_read_b64_tr_b16 a[232:233], v12 offset:4096
  ds_read_b64_tr_b16 a[234:235], v12 offset:5120
  v_mfma_f32_32x32x16_bf16 v[160:175], a[236:239], v[156:159], v[160:175]
  s_add_u32 m0, s42, 32768
  s_add_u32 s55, s47, 0
  buffer_load_dwordx4 v8, s[24:27], s55 offen offset:0  lds
  s_waitcnt lgkmcnt(9)
  v_mfma_f32_32x32x16_bf16 v[160:175], a[240:243], v[192:195], v[160:175]
  ds_read_b128 a[236:239], v36 offset:25600
  ds_read_b64_tr_b16 a[240:241], v12 offset:8192
  ds_read_b64_tr_b16 a[242:243], v12 offset:9216
  v_mfma_f32_32x32x16_bf16 v[160:175], a[244:247], v[196:199], v[160:175]
  ds_read_b128 a[244:247], v36 offset:26624
  ds_write_b128 v37, v[64:67] offset:8192
  s_waitcnt lgkmcnt(10)
  v_mfma_f32_32x32x16_bf16 v[160:175], a[248:251], v[200:203], v[160:175]
  ds_read_b64_tr_b16 a[248:249], v12 offset:12288
  ds_read_b64_tr_b16 a[250:251], v12 offset:13312
  ds_write_b128 v37, v[68:71] offset:9216
  v_mfma_f32_32x32x16_bf16 v[160:175], a[252:255], v[204:207], v[160:175]
  buffer_load_dwordx4 v9, s[24:27], s55 offen offset:1024  lds
  ds_read_b128 a[252:255], v36 offset:27648
  s_waitcnt lgkmcnt(11)
  v_mfma_f32_32x32x16_bf16 v[48:63], a[224:227], v[128:131], v[48:63]
  s_barrier
  v_mfma_f32_32x32x16_bf16 v[208:223], a[224:227], a[228:231], v[208:223]
  ds_read_b64_tr_b16 a[224:225], v12 offset:16384
  ds_read_b64_tr_b16 a[226:227], v12 offset:17408
  ds_read_b128 a[228:231], v36 offset:28672
  s_waitcnt lgkmcnt(11)
  v_mfma_f32_32x32x16_bf16 v[48:63], a[232:235], v[132:135], v[48:63]
  buffer_load_dwordx4 v10, s[24:27], s55 offen offset:2048  lds
  v_mfma_f32_32x32x16_bf16 v[208:223], a[232:235], a[236:239], v[208:223]
  ds_read_b64_tr_b16 a[232:233], v12 offset:20480
  ds_read_b64_tr_b16 a[234:235], v12 offset:21504
  ds_read_b128 a[236:239], v36 offset:29696
  s_waitcnt lgkmcnt(11)
  v_mfma_f32_32x32x16_bf16 v[48:63], a[240:243], v[136:139], v[48:63]
  v_mfma_f32_32x32x16_bf16 v[208:223], a[240:243], a[244:247], v[208:223]
  ds_read_b64_tr_b16 a[240:241], v12 offset:24576
  ds_read_b64_tr_b16 a[242:243], v12 offset:25600
  ds_read_b128 a[244:247], v36 offset:30720
  s_waitcnt lgkmcnt(9)
  v_mfma_f32_32x32x16_bf16 v[48:63], a[248:251], v[140:143], v[48:63]
  buffer_load_dwordx4 v11, s[24:27], s55 offen offset:3072  lds
  v_mfma_f32_32x32x16_bf16 v[208:223], a[248:251], a[252:255], v[208:223]
  ds_read_b64_tr_b16 a[248:249], v12 offset:28672
  ds_read_b64_tr_b16 a[250:251], v12 offset:29696
  ds_read_b128 a[252:255], v36 offset:31744
  s_waitcnt lgkmcnt(9)
  v_mfma_f32_32x32x16_bf16 v[48:63], a[224:227], v[112:115], v[48:63]
  v_mfma_f32_32x32x16_bf16 v[208:223], a[224:227], a[228:231], v[208:223]
  s_add_u32 m0, s42, 36864
  s_add_u32 s55, s47, 28672
  buffer_load_dwordx4 v8, s[24:27], s55 offen offset:0  lds
  ds_read_b64_tr_b16 a[224:225], v13 offset:0
  ds_read_b64_tr_b16 a[226:227], v13 offset:1024
  s_waitcnt lgkmcnt(8)
  v_mfma_f32_32x32x16_bf16 v[48:63], a[232:235], v[116:119], v[48:63]
  ds_read_b64_tr_b16 a[228:229], v13 offset:4096
  ds_read_b64_tr_b16 a[230:231], v13 offset:5120
  v_mfma_f32_32x32x16_bf16 v[208:223], a[232:235], a[236:239], v[208:223]
  ds_read_b64_tr_b16 a[232:233], v13 offset:8192
  ds_read_b64_tr_b16 a[234:235], v13 offset:9216
  ds_read_b64_tr_b16 a[236:237], v13 offset:12288
  s_waitcnt lgkmcnt(10)
  v_mfma_f32_32x32x16_bf16 v[48:63], a[240:243], v[120:123], v[48:63]
  ds_read_b64_tr_b16 a[238:239], v13 offset:13312
  v_mfma_f32_32x32x16_bf16 v[208:223], a[240:243], a[244:247], v[208:223]
  buffer_load_dwordx4 v9, s[24:27], s55 offen offset:1024  lds
  ds_read_b64_tr_b16 a[240:241], v13 offset:16384
  ds_read_b64_tr_b16 a[242:243], v13 offset:17408
  s_waitcnt lgkmcnt(10)
  v_mfma_f32_32x32x16_bf16 v[48:63], a[248:251], v[124:127], v[48:63]
  ds_read_b64_tr_b16 a[244:245], v13 offset:20480
  ds_read_b64_tr_b16 a[246:247], v13 offset:21504
  v_mfma_f32_32x32x16_bf16 v[208:223], a[248:251], a[252:255], v[208:223]
  ds_read_b64_tr_b16 a[248:249], v13 offset:24576
  ds_read_b64_tr_b16 a[250:251], v13 offset:25600
  s_waitcnt lgkmcnt(10)
  v_mfma_f32_32x32x16_bf16 v[224:239], a[224:227], v[128:131], v[224:239]
  buffer_load_dwordx4 v10, s[24:27], s55 offen offset:2048  lds
  ds_read_b64_tr_b16 a[252:253], v13 offset:28672
  ds_read_b64_tr_b16 a[254:255], v13 offset:29696
  v_mfma_f32_32x32x16_bf16 v[224:239], a[228:231], v[132:135], v[224:239]
  ds_read_b64_tr_b16 a[224:225], v14 offset:0
  ds_read_b64_tr_b16 a[226:227], v14 offset:1024
  v_mul_f32 v48, v48, v38
  v_mul_f32 v49, v49, v38
  v_mul_f32 v208, v208, v39
  s_waitcnt lgkmcnt(10)
  v_mfma_f32_32x32x16_bf16 v[224:239], a[232:235], v[136:139], v[224:239]
  ds_read_b64_tr_b16 a[228:229], v14 offset:4096
  ds_read_b64_tr_b16 a[230:231], v14 offset:5120
  ds_read_b64_tr_b16 a[232:233], v14 offset:8192
  v_mul_f32 v209, v209, v39
  v_mul_f32 v210, v210, v39
  v_mul_f32 v211, v211, v39
  v_mfma_f32_32x32x16_bf16 v[224:239], a[236:239], v[140:143], v[224:239]
  ds_read_b64_tr_b16 a[234:235], v14 offset:9216
  v_cvt_pk_bf16_f32 v208, v208, v209
  v_mul_f32 v212, v212, v39
  v_mul_f32 v213, v213, v39
  v_mul_f32 v214, v214, v39
  s_waitcnt lgkmcnt(10)
  v_mfma_f32_32x32x16_bf16 v[224:239], a[240:243], v[112:115], v[224:239]
  buffer_load_dwordx4 v11, s[24:27], s55 offen offset:3072  lds
  ds_read_b64_tr_b16 a[236:237], v14 offset:12288
  ds_read_b64_tr_b16 a[238:239], v14 offset:13312
  v_mfma_f32_32x32x16_bf16 v[224:239], a[244:247], v[116:119], v[224:239]
  ds_read_b64_tr_b16 a[240:241], v14 offset:16384
  ds_read_b64_tr_b16 a[242:243], v14 offset:17408
  v_mul_f32 v215, v215, v39
  v_cvt_pk_bf16_f32 v209, v210, v211
  v_mul_f32 v216, v216, v39
  s_waitcnt lgkmcnt(10)
  v_mfma_f32_32x32x16_bf16 v[224:239], a[248:251], v[120:123], v[224:239]
  ds_read_b64_tr_b16 a[244:245], v14 offset:20480
  ds_read_b64_tr_b16 a[246:247], v14 offset:21504
  ds_read_b64_tr_b16 a[248:249], v14 offset:24576
  v_mul_f32 v217, v217, v39
  v_mul_f32 v218, v218, v39
  v_mul_f32 v219, v219, v39
  v_mfma_f32_32x32x16_bf16 v[224:239], a[252:255], v[124:127], v[224:239]
  s_add_u32 m0, s42, 0
  s_add_u32 s55, s48, 0
  buffer_load_dwordx4 v8, s[24:27], s55 offen offset:0  lds
  ds_read_b64_tr_b16 a[250:251], v14 offset:25600
  s_waitcnt lgkmcnt(10)
  v_mfma_f32_32x32x16_bf16 v[80:95], a[224:227], v[128:131], v[80:95]
  ds_read_b64_tr_b16 a[252:253], v14 offset:28672
  ds_read_b64_tr_b16 a[254:255], v14 offset:29696
  ds_read_b64_tr_b16 a[224:225], v15 offset:0
  v_mul_f32 v220, v220, v39
  v_mul_f32 v221, v221, v39
  v_mul_f32 v222, v222, v39
  v_mfma_f32_32x32x16_bf16 v[80:95], a[228:231], v[132:135], v[80:95]
  ds_read_b64_tr_b16 a[226:227], v15 offset:1024
  v_mul_f32 v223, v223, v39
  v_cvt_pk_bf16_f32 v210, v212, v213
  v_cvt_pk_bf16_f32 v211, v214, v215
  v_cvt_pk_bf16_f32 v212, v216, v217
  s_waitcnt lgkmcnt(10)
  v_mfma_f32_32x32x16_bf16 v[80:95], a[232:235], v[136:139], v[80:95]
  ds_read_b64_tr_b16 a[228:229], v15 offset:4096
  ds_read_b64_tr_b16 a[230:231], v15 offset:5120
  ds_read_b64_tr_b16 a[232:233], v15 offset:8192
  v_cvt_pk_bf16_f32 v213, v218, v219
  v_cvt_pk_bf16_f32 v214, v220, v221
  v_cvt_pk_bf16_f32 v215, v222, v223
  v_mfma_f32_32x32x16_bf16 v[80:95], a[236:239], v[140:143], v[80:95]
  buffer_load_dwordx4 v9, s[24:27], s55 offen offset:1024  lds
  ds_read_b64_tr_b16 a[234:235], v15 offset:9216
  s_waitcnt lgkmcnt(10)
  v_mfma_f32_32x32x16_bf16 v[80:95], a[240:243], v[112:115], v[80:95]
  ds_read_b64_tr_b16 a[236:237], v15 offset:12288
  ds_read_b64_tr_b16 a[238:239], v15 offset:13312
  ds_read_b64_tr_b16 a[240:241], v15 offset:16384
  v_mul_f32 v50, v50, v38
  v_mul_f32 v51, v51, v38
  v_cvt_pk_bf16_f32 v48, v48, v49
  v_mfma_f32_32x32x16_bf16 v[80:95], a[244:247], v[116:119], v[80:95]
  ds_read_b64_tr_b16 a[242:243], v15 offset:17408
  v_mul_f32 v52, v52, v38
  v_mul_f32 v53, v53, v38
  v_mul_f32 v54, v54, v38
  v_mul_f32 v55, v55, v38
  s_waitcnt lgkmcnt(10)
  v_mfma_f32_32x32x16_bf16 v[80:95], a[248:251], v[120:123], v[80:95]
  buffer_load_dwordx4 v10, s[24:27], s55 offen offset:2048  lds
  ds_read_b64_tr_b16 a[244:245], v15 offset:20480
  ds_write_b128 v37, v[208:211] offset:16384
  ds_write_b128 v37, v[212:215] offset:17408
  v_mfma_f32_32x32x16_bf16 v[80:95], a[252:255], v[124:127], v[80:95]
  ds_read_b64_tr_b16 a[246:247], v15 offset:21504
  v_cvt_pk_bf16_f32 v49, v50, v51
  v_cvt_pk_bf16_f32 v50, v52, v53
  v_cvt_pk_bf16_f32 v51, v54, v55
  v_mul_f32 v56, v56, v38
  s_waitcnt lgkmcnt(10)
  v_mfma_f32_32x32x16_bf16 v[160:175], a[224:227], v[128:131], v[160:175]
  ds_read_b64_tr_b16 a[248:249], v15 offset:24576
  ds_read_b64_tr_b16 a[250:251], v15 offset:25600
  ds_read_b64_tr_b16 a[252:253], v15 offset:28672
  v_mul_f32 v57, v57, v38
  v_mul_f32 v58, v58, v38
  v_mul_f32 v59, v59, v38
  v_mfma_f32_32x32x16_bf16 v[160:175], a[228:231], v[132:135], v[160:175]
  ds_read_b64_tr_b16 a[254:255], v15 offset:29696
  s_waitcnt vmcnt(3) lgkmcnt(5)
  s_barrier
L_RS16:
  ds_read_b64_tr_b16 a[224:225], v16 offset:32768
  ds_read_b64_tr_b16 a[226:227], v16 offset:33280
  v_mfma_f32_32x32x16_bf16 v[160:175], a[232:235], v[136:139], v[160:175]
  buffer_load_dwordx4 v11, s[24:27], s55 offen offset:3072  lds
  ds_read_b128 a[192:195], v37 offset:8192
  ds_read_b64_tr_b16 a[228:229], v16 offset:34816
  v_mfma_f32_32x32x16_bf16 v[160:175], a[236:239], v[140:143], v[160:175]
  ds_read_b64_tr_b16 a[230:231], v16 offset:35328
  ds_read_b128 a[196:199], v37 offset:9216
  ds_read_b64_tr_b16 a[232:233], v18 offset:32768
  v_mul_f32 v60, v60, v38
  v_mul_f32 v61, v61, v38
  v_mul_f32 v62, v62, v38
  v_mfma_f32_32x32x16_bf16 v[160:175], a[240:243], v[112:115], v[160:175]
  ds_read_b64_tr_b16 a[234:235], v18 offset:33280
  ds_read_b128 a[200:203], v6 offset:8192
  v_mul_f32 v63, v63, v38
  v_cvt_pk_bf16_f32 v52, v56, v57
  v_cvt_pk_bf16_f32 v53, v58, v59
  s_waitcnt lgkmcnt(11)
  v_mfma_f32_32x32x16_bf16 v[160:175], a[244:247], v[116:119], v[160:175]
  s_add_u32 m0, s42, 4096
  s_add_u32 s55, s48, 28672
  buffer_load_dwordx4 v8, s[24:27], s55 offen offset:0  lds
  v_mfma_f32_32x32x16_bf16 v[160:175], a[248:251], v[120:123], v[160:175]
  ds_read_b64_tr_b16 a[236:237], v18 offset:34816
  ds_read_b64_tr_b16 a[238:239], v18 offset:35328
  ds_read_b128 a[204:207], v6 offset:9216
  v_cvt_pk_bf16_f32 v54, v60, v61
  v_cvt_pk_bf16_f32 v55, v62, v63
  s_waitcnt lgkmcnt(10)
  v_mfma_f32_32x32x16_bf16 v[160:175], a[252:255], v[124:127], v[160:175]
  ds_read_b64_tr_b16 a[240:241], v20 offset:32768
  ds_read_b64_tr_b16 a[242:243], v20 offset:33280
  ds_read_b64_tr_b16 a[244:245], v20 offset:34816
  v_mul_f32 v224, v224, v38
  v_mul_f32 v225, v225, v38
  v_mul_f32 v226, v226, v38
  v_mfma_f32_32x32x16_bf16 v[64:79], a[224:227], v[240:243], 0
  ds_read_b64_tr_b16 a[246:247], v20 offset:35328
  v_mul_f32 v227, v227, v38
  v_mul_f32 v228, v228, v38
  v_mul_f32 v229, v229, v38
  v_mul_f32 v230, v230, v38
  s_waitcnt lgkmcnt(11)
  v_mfma_f32_32x32x16_bf16 v[96:111], a[224:227], a[192:195], 0
  buffer_load_dwordx4 v9, s[24:27], s55 offen offset:1024  lds
  ds_read_b64_tr_b16 a[248:249], v22 offset:32768
  ds_read_b64_tr_b16 a[250:251], v22 offset:33280
  v_mfma_f32_32x32x16_bf16 v[64:79], a[228:231], v[244:247], v[64:79]
  ds_read_b64_tr_b16 a[252:253], v22 offset:34816
  v_mul_f32 v231, v231, v38
  v_cvt_pk_bf16_f32 v56, v224, v225
  v_cvt_pk_bf16_f32 v57, v226, v227
  v_cvt_pk_bf16_f32 v58, v228, v229
  s_waitcnt lgkmcnt(11)
  v_mfma_f32_32x32x16_bf16 v[96:111], a[228:231], a[196:199], v[96:111]
  ds_read_b64_tr_b16 a[254:255], v22 offset:35328
  ds_read_b64_tr_b16 a[224:225], v17 offset:32768
  ds_read_b64_tr_b16 a[226:227], v17 offset:33280
  v_cvt_pk_bf16_f32 v59, v230, v231
  v_mul_f32 v232, v232, v38
  v_mul_f32 v233, v233, v38
  v_mfma_f32_32x32x16_bf16 v[64:79], a[232:235], v[248:251], v[64:79]
  buffer_load_dwordx4 v10, s[24:27], s55 offen offset:2048  lds
  v_mul_f32 v234, v234, v38
  s_waitcnt lgkmcnt(11)
  v_mfma_f32_32x32x16_bf16 v[96:111], a[232:235], a[200:203], v[96:111]
  ds_read_b64_tr_b16 a[228:229], v17 offset:34816
  ds_read_b64_tr_b16 a[230:231], v17 offset:35328
  ds_read_b64_tr_b16 a[232:233], v19 offset:32768
  v_mul_f32 v235, v235, v38
  v_mul_f32 v236, v236, v38
  v_mul_f32 v237, v237, v38
  v_mfma_f32_32x32x16_bf16 v[64:79], a[236:239], v[252:255], v[64:79]
  v_mul_f32 v238, v238, v38
  v_mul_f32 v239, v239, v38
  v_cvt_pk_bf16_f32 v60, v232, v233
  v_cvt_pk_bf16_f32 v61, v234, v235
  v_cvt_pk_bf16_f32 v62, v236, v237
  s_waitcnt lgkmcnt(11)
  v_mfma_f32_32x32x16_bf16 v[96:111], a[236:239], a[204:207], v[96:111]
  ds_read_b64_tr_b16 a[234:235], v19 offset:33280
  ds_read_b64_tr_b16 a[236:237], v19 offset:34816
  ds_read_b64_tr_b16 a[238:239], v19 offset:35328
  v_cvt_pk_bf16_f32 v63, v238, v239
  v_mul_f32 v80, v80, v38
  v_mul_f32 v81, v81, v38
  v_mfma_f32_32x32x16_bf16 v[64:79], a[240:243], v[176:179], v[64:79]
  buffer_load_dwordx4 v11, s[24:27], s55 offen offset:3072  lds
  v_mul_f32 v82, v82, v38
  s_waitcnt lgkmcnt(10)
  v_mfma_f32_32x32x16_bf16 v[64:79], a[244:247], v[180:183], v[64:79]
  ds_read_b64_tr_b16 a[240:241], v21 offset:32768
  ds_read_b64_tr_b16 a[242:243], v21 offset:33280
  ds_read_b64_tr_b16 a[244:245], v21 offset:34816
  v_mul_f32 v83, v83, v38
  v_cvt_pk_bf16_f32 v80, v80, v81
  v_mul_f32 v84, v84, v38
  v_mfma_f32_32x32x16_bf16 v[64:79], a[248:251], v[184:187], v[64:79]
  ds_read_b64_tr_b16 a[246:247], v21 offset:35328
  v_mul_f32 v85, v85, v38
  v_mul_f32 v86, v86, v38
  v_mul_f32 v87, v87, v38
  v_cvt_pk_bf16_f32 v81, v82, v83
  s_waitcnt lgkmcnt(10)
  v_mfma_f32_32x32x16_bf16 v[64:79], a[252:255], v[188:191], v[64:79]
  s_add_u32 m0, s42, 98304
  s_add_u32 s55, s49, 0
  buffer_load_dwordx4 v8, s[24:27], s55 offen offset:0  lds
  ds_read_b64_tr_b16 a[248:249], v23 offset:32768
  ds_read_b64_tr_b16 a[250:251], v23 offset:33280
  v_mfma_f32_32x32x16_bf16 v[144:159], a[224:227], v[240:243], 0
  ds_read_b64_tr_b16 a[252:253], v23 offset:34816
  ds_read_b64_tr_b16 a[254:255], v23 offset:35328
  v_cvt_pk_bf16_f32 v82, v84, v85
  v_cvt_pk_bf16_f32 v83, v86, v87
  v_mul_f32 v88, v88, v38
  s_waitcnt lgkmcnt(10)
  v_mfma_f32_32x32x16_bf16 v[144:159], a[228:231], v[244:247], v[144:159]
  ds_read_b64_tr_b16 a[224:225], v16 offset:49152
  ds_read_b64_tr_b16 a[226:227], v16 offset:49664
  ds_read_b128 a[208:211], v37 offset:16384
  v_mul_f32 v89, v89, v38
  v_mul_f32 v90, v90, v38
  v_mul_f32 v91, v91, v38
  v_mfma_f32_32x32x16_bf16 v[144:159], a[232:235], v[248:251], v[144:159]
  ds_read_b64_tr_b16 a[228:229], v16 offset:51200
  v_mul_f32 v92, v92, v38
  v_mul_f32 v93, v93, v38
  v_mul_f32 v94, v94, v38
  v_mul_f32 v95, v95, v38
  s_waitcnt lgkmcnt(10)
  v_mfma_f32_32x32x16_bf16 v[144:159], a[236:239], v[252:255], v[144:159]
  buffer_load_dwordx4 v9, s[24:27], s55 offen offset:1024  lds
  ds_read_b64_tr_b16 a[230:231], v16 offset:51712
  ds_read_b128 a[212:215], v37 offset:17408
  v_mfma_f32_32x32x16_bf16 v[144:159], a[240:243], v[176:179], v[144:159]
  ds_read_b64_tr_b16 a[232:233], v18 offset:49152
  ds_read_b64_tr_b16 a[234:235], v18 offset:49664
  v_cvt_pk_bf16_f32 v84, v88, v89
  v_cvt_pk_bf16_f32 v85, v90, v91
  v_cvt_pk_bf16_f32 v86, v92, v93
  s_waitcnt lgkmcnt(10)
  v_mfma_f32_32x32x16_bf16 v[144:159], a[244:247], v[180:183], v[144:159]
  ds_read_b128 a[216:219], v6 offset:16384
  ds_read_b64_tr_b16 a[236:237], v18 offset:51200
  ds_read_b64_tr_b16 a[238:239], v18 offset:51712
  v_cvt_pk_bf16_f32 v87, v94, v95
  v_mul_f32 v160, v160, v38
  v_mul_f32 v161, v161, v38
  v_mfma_f32_32x32x16_bf16 v[144:159], a[248:251], v[184:187], v[144:159]
  buffer_load_dwordx4 v10, s[24:27], s55 offen offset:2048  lds
  ds_read_b128 a[220:223], v6 offset:17408
  s_waitcnt lgkmcnt(10)
  v_mfma_f32_32x32x16_bf16 v[144:159], a[252:255], v[188:191], v[144:159]
  ds_read_b64_tr_b16 a[240:241], v20 offset:49152
  ds_read_b64_tr_b16 a[242:243], v20 offset:49664
  ds_read_b64_tr_b16 a[244:245], v20 offset:51200
  v_mul_f32 v162, v162, v38
  v_mul_f32 v163, v163, v38
  v_mul_f32 v164, v164, v38
  v_mfma_f32_32x32x16_bf16 v[64:79], a[224:227], v[48:51], v[64:79]
  ds_read_b64_tr_b16 a[246:247], v20 offset:51712
  v_mul_f32 v165, v165, v38
  v_mul_f32 v166, v166, v38
  v_mul_f32 v167, v167, v38
  v_cvt_pk_bf16_f32 v88, v160, v161
  s_waitcnt lgkmcnt(11)
  v_mfma_f32_32x32x16_bf16 v[96:111], a[224:227], a[208:211], v[96:111]
  ds_read_b64_tr_b16 a[248:249], v22 offset:49152
  ds_read_b64_tr_b16 a[250:251], v22 offset:49664
  ds_read_b64_tr_b16 a[252:253], v22 offset:51200
  v_cvt_pk_bf16_f32 v89, v162, v163
  v_cvt_pk_bf16_f32 v90, v164, v165
  v_cvt_pk_bf16_f32 v91, v166, v167
  v_mfma_f32_32x32x16_bf16 v[64:79], a[228:231], v[52:55], v[64:79]
  buffer_load_dwordx4 v11, s[24:27], s55 offen offset:3072  lds
  v_mul_f32 v168, v168, v38
  s_waitcnt lgkmcnt(11)
  v_mfma_f32_32x32x16_bf16 v[96:111], a[228:231], a[212:215], v[96:111]
  ds_read_b64_tr_b16 a[254:255], v22 offset:51712
  ds_read_b64_tr_b16 a[224:225], v17 offset:49152
  ds_read_b64_tr_b16 a[226:227], v17 offset:49664
  v_mul_f32 v169, v169, v38
  v_mul_f32 v170, v170, v38
  v_mul_f32 v171, v171, v38
  v_mfma_f32_32x32x16_bf16 v[64:79], a[232:235], v[56:59], v[64:79]
  v_mul_f32 v172, v172, v38
  v_mul_f32 v173, v173, v38
  v_mul_f32 v174, v174, v38
  v_mul_f32 v175, v175, v38
  v_cvt_pk_bf16_f32 v92, v168, v169
  s_waitcnt lgkmcnt(11)
  v_mfma_f32_32x32x16_bf16 v[96:111], a[232:235], a[216:219], v[96:111]
  s_add_u32 m0, s42, 102400
  s_add_u32 s55, s49, 28672
  buffer_load_dwordx4 v8, s[24:27], s55 offen offset:0  lds
  v_mfma_f32_32x32x16_bf16 v[64:79], a[236:239], v[60:63], v[64:79]
  ds_read_b64_tr_b16 a[228:229], v17 offset:51200
  ds_read_b64_tr_b16 a[230:231], v17 offset:51712
  ds_read_b64_tr_b16 a[232:233], v19 offset:49152
  v_cvt_pk_bf16_f32 v93, v170, v171
  v_cvt_pk_bf16_f32 v94, v172, v173
  s_waitcnt lgkmcnt(11)
  v_mfma_f32_32x32x16_bf16 v[96:111], a[236:239], a[220:223], v[96:111]
  ds_read_b64_tr_b16 a[234:235], v19 offset:49664
  ds_read_b64_tr_b16 a[236:237], v19 offset:51200
  ds_read_b64_tr_b16 a[238:239], v19 offset:51712
  v_cvt_pk_bf16_f32 v95, v174, v175
  v_accvgpr_read_b32 v41, a64
  v_mfma_f32_32x32x16_bf16 v[64:79], a[240:243], v[80:83], v[64:79]
  v_readfirstlane_b32 s100, v41
  s_nop 0
  s_cmp_lg_u32 s100, s94
  s_cbranch_scc1 L_decide
L_decided:
  s_waitcnt lgkmcnt(10)
  v_mfma_f32_32x32x16_bf16 v[64:79], a[244:247], v[84:87], v[64:79]
  buffer_load_dwordx4 v9, s[24:27], s55 offen offset:1024  lds
  ds_read_b64_tr_b16 a[240:241], v21 offset:49152
  ds_read_b64_tr_b16 a[242:243], v21 offset:49664
  v_mfma_f32_32x32x16_bf16 v[64:79], a[248:251], v[88:91], v[64:79]
  ds_read_b64_tr_b16 a[244:245], v21 offset:51200
  ds_read_b64_tr_b16 a[246:247], v21 offset:51712
  v_cvt_pk_bf16_f32 v96, v96, v97
  v_cvt_pk_bf16_f32 v97, v98, v99
  v_cvt_pk_bf16_f32 v98, v100, v101
  s_waitcnt lgkmcnt(10)
  v_mfma_f32_32x32x16_bf16 v[64:79], a[252:255], v[92:95], v[64:79]
  ds_read_b64_tr_b16 a[248:249], v23 offset:49152
  ds_read_b64_tr_b16 a[250:251], v23 offset:49664
  ds_read_b64_tr_b16 a[252:253], v23 offset:51200
  s_waitcnt vmcnt(6)
  s_barrier
L_RS17:
  v_mfma_f32_32x32x16_bf16 v[144:159], a[224:227], v[48:51], v[144:159]
  buffer_load_dwordx4 v10, s[24:27], s55 offen offset:2048  lds
  ds_read_b64_tr_b16 a[254:255], v23 offset:51712
  s_waitcnt lgkmcnt(10)
  v_mfma_f32_32x32x16_bf16 v[144:159], a[228:231], v[52:55], v[144:159]
  ds_read_b64_tr_b16 a[224:225], v16 offset:0
  ds_read_b64_tr_b16 a[226:227], v16 offset:512
  ds_read_b64_tr_b16 a[228:229], v16 offset:2048
  v_cvt_pk_bf16_f32 v99, v102, v103
  v_cvt_pk_bf16_f32 v100, v104, v105
  v_cvt_pk_bf16_f32 v101, v106, v107
  v_mfma_f32_32x32x16_bf16 v[144:159], a[232:235], v[56:59], v[144:159]
  ds_read_b64_tr_b16 a[230:231], v16 offset:2560
  v_cvt_pk_bf16_f32 v102, v108, v109
  v_cvt_pk_bf16_f32 v103, v110, v111
  v_cvt_pk_bf16_f32 v64, v64, v65
  v_cvt_pk_bf16_f32 v65, v66, v67
  s_waitcnt lgkmcnt(10)
  v_mfma_f32_32x32x16_bf16 v[144:159], a[236:239], v[60:63], v[144:159]
  buffer_store_dwordx4 v[96:99], v34, s[28:31], s20 offen offset:0
  v_mfma_f32_32x32x16_bf16 v[144:159], a[240:243], v[80:83], v[144:159]
  buffer_load_dwordx4 v11, s[24:27], s55 offen offset:3072  lds
  ds_read_b64_tr_b16 a[232:233], v18 offset:0
  s_waitcnt lgkmcnt(7)
  v_mfma_f32_32x32x16_bf16 v[144:159], a[244:247], v[84:87], v[144:159]
  buffer_store_dwordx4 v[100:103], v34, s[28:31], s20 offen offset:1024
  ds_read_b64_tr_b16 a[234:235], v18 offset:512
  v_mfma_f32_32x32x16_bf16 v[144:159], a[248:251], v[88:91], v[144:159]
  ds_read_b64_tr_b16 a[236:237], v18 offset:2048
  ds_read_b64_tr_b16 a[238:239], v18 offset:2560
  v_cvt_pk_bf16_f32 v66, v68, v69
  v_cvt_pk_bf16_f32 v67, v70, v71
  v_cvt_pk_bf16_f32 v68, v72, v73
  s_waitcnt lgkmcnt(6)
  v_mfma_f32_32x32x16_bf16 v[144:159], a[252:255], v[92:95], v[144:159]
  v_cvt_pk_bf16_f32 v69, v74, v75
  v_cvt_pk_bf16_f32 v70, v76, v77
  v_cvt_pk_bf16_f32 v71, v78, v79
  ds_read_b64_tr_b16 a[240:241], v20 offset:0
  ds_read_b64_tr_b16 a[242:243], v20 offset:512
  ds_read_b64_tr_b16 a[244:245], v20 offset:2048
  v_mfma_f32_32x32x16_bf16 v[192:207], a[224:227], v[240:243], 0
  buffer_store_dwordx4 v[64:67], v32, s[28:31], s20 offen offset:0
  v_mfma_f32_32x32x16_bf16 v[128:143], a[224:227], a[192:195], 0
  buffer_store_dwordx4 v[68:71], v32, s[28:31], s20 offen offset:1024
  s_waitcnt lgkmcnt(7)
  v_mfma_f32_32x32x16_bf16 v[192:207], a[228:231], v[244:247], v[192:207]
  ds_read_b64_tr_b16 a[246:247], v20 offset:2560
  buffer_load_dword v41, off, s[60:63], s54 sc1
  ds_read_b64_tr_b16 a[248:249], v22 offset:0
  ds_read_b64_tr_b16 a[250:251], v22 offset:512
  v_cvt_pk_bf16_f32 v144, v144, v145
  v_mfma_f32_32x32x16_bf16 v[128:143], a[228:231], a[196:199], v[128:143]
  ds_read_b64_tr_b16 a[252:253], v22 offset:2048
  ds_read_b64_tr_b16 a[254:255], v22 offset:2560
  ds_read_b64_tr_b16 a[224:225], v16 offset:16384
  v_cvt_pk_bf16_f32 v145, v146, v147
  v_cvt_pk_bf16_f32 v146, v148, v149
  s_waitcnt lgkmcnt(11)
  v_mfma_f32_32x32x16_bf16 v[192:207], a[232:235], v[248:251], v[192:207]
  ds_read_b64_tr_b16 a[226:227], v16 offset:16896
  ds_read_b64_tr_b16 a[228:229], v16 offset:18432
  ds_read_b64_tr_b16 a[230:231], v16 offset:18944
  v_cvt_pk_bf16_f32 v147, v150, v151
  v_cvt_pk_bf16_f32 v148, v152, v153
  v_cvt_pk_bf16_f32 v149, v154, v155
  v_mfma_f32_32x32x16_bf16 v[128:143], a[232:235], a[200:203], v[128:143]
  v_cvt_pk_bf16_f32 v150, v156, v157
  v_cvt_pk_bf16_f32 v151, v158, v159
  s_cmp_ge_u32 1, s46
  s_cselect_b32 s18, 688128, 0
  s_sub_u32 s35, 2, s46
  s_waitcnt lgkmcnt(12)
  v_mfma_f32_32x32x16_bf16 v[192:207], a[236:239], v[252:255], v[192:207]
  buffer_store_dwordx4 v[144:147], v33, s[28:31], s20 offen offset:0
  v_mfma_f32_32x32x16_bf16 v[128:143], a[236:239], a[204:207], v[128:143]
  ds_read_b64_tr_b16 a[232:233], v18 offset:16384
  ds_read_b64_tr_b16 a[234:235], v18 offset:16896
  v_add_u32 v2, 65536, v16
  v_add_u32 v3, 65536, v17
  v_add_u32 v4, 65536, v18
  s_waitcnt lgkmcnt(10)
  v_mfma_f32_32x32x16_bf16 v[192:207], a[240:243], v[176:179], v[192:207]
  buffer_store_dwordx4 v[148:151], v33, s[28:31], s20 offen offset:1024
  v_mfma_f32_32x32x16_bf16 v[192:207], a[244:247], v[180:183], v[192:207]
  ds_read_b64_tr_b16 a[236:237], v18 offset:18432
  ds_read_b64_tr_b16 a[238:239], v18 offset:18944
  ds_read_b64_tr_b16 a[240:241], v20 offset:16384
  v_add_u32 v5, 65536, v19
  v_add_u32 v7, 65536, v20
  s_waitcnt lgkmcnt(9)
  v_mfma_f32_32x32x16_bf16 v[192:207], a[248:251], v[184:187], v[192:207]
  ds_read_b64_tr_b16 a[242:243], v20 offset:16896
  ds_read_b64_tr_b16 a[244:245], v20 offset:18432
  ds_read_b64_tr_b16 a[246:247], v20 offset:18944
  v_add_u32 v35, 65536, v21
  v_add_u32 v46, 65536, v22
  v_add_u32 v47, 65536, v23
  v_mfma_f32_32x32x16_bf16 v[192:207], a[252:255], v[188:191], v[192:207]
  ds_read_b64_tr_b16 a[248:249], v22 offset:16384
  ds_read_b64_tr_b16 a[250:251], v22 offset:16896
  s_waitcnt lgkmcnt(12)
  v_mfma_f32_32x32x16_bf16 v[192:207], a[224:227], v[48:51], v[192:207]
  ds_read_b64_tr_b16 a[252:253], v22 offset:18432
  ds_read_b64_tr_b16 a[254:255], v22 offset:18944
  v_mfma_f32_32x32x16_bf16 v[128:143], a[224:227], a[208:211], v[128:143]
  s_waitcnt lgkmcnt(12)
  v_mfma_f32_32x32x16_bf16 v[192:207], a[228:231], v[52:55], v[192:207]
  s_waitcnt vmcnt(2)
  v_cmp_gt_i32 vcc, s35, v41
  s_nop 1
  s_cbranch_vccnz L_sp1
L_go1:
  ds_read_b64_tr_b16 a[224:225], v17 offset:0
  ds_read_b64_tr_b16 a[226:227], v17 offset:512
  v_mfma_f32_32x32x16_bf16 v[128:143], a[228:231], a[212:215], v[128:143]
  buffer_load_dwordx4 a[24:27], v32, s[16:19], s21 offen offset:0 sc1
  s_waitcnt lgkmcnt(12)
  v_mfma_f32_32x32x16_bf16 v[192:207], a[232:235], v[56:59], v[192:207]
  ds_read_b64_tr_b16 a[228:229], v17 offset:2048
  ds_read_b64_tr_b16 a[230:231], v17 offset:2560
  v_mfma_f32_32x32x16_bf16 v[128:143], a[232:235], a[216:219], v[128:143]
  buffer_load_dwordx4 a[28:31], v32, s[16:19], s21 offen offset:1024 sc1
  s_waitcnt lgkmcnt(12)
  v_mfma_f32_32x32x16_bf16 v[192:207], a[236:239], v[60:63], v[192:207]
  ds_read_b64_tr_b16 a[232:233], v19 offset:0
  ds_read_b64_tr_b16 a[234:235], v19 offset:512
  v_mfma_f32_32x32x16_bf16 v[128:143], a[236:239], a[220:223], v[128:143]
  buffer_load_dwordx4 a[40:43], v34, s[16:19], s21 offen offset:0 sc1
  s_waitcnt lgkmcnt(10)
  v_mfma_f32_32x32x16_bf16 v[192:207], a[240:243], v[80:83], v[192:207]
  s_waitcnt vmcnt(3)
  buffer_store_dword v40, v1, s[60:63], s3 offen
  ds_read_b64_tr_b16 a[236:237], v19 offset:2048
  ds_read_b64_tr_b16 a[238:239], v19 offset:2560
  ds_read_b64_tr_b16 a[240:241], v21 offset:0
  v_mfma_f32_32x32x16_bf16 v[192:207], a[244:247], v[84:87], v[192:207]
  ds_read_b64_tr_b16 a[242:243], v21 offset:512
  v_mov_b32 v40, 2
  s_waitcnt lgkmcnt(10)
  v_mfma_f32_32x32x16_bf16 v[192:207], a[248:251], v[88:91], v[192:207]
  ds_read_b64_tr_b16 a[244:245], v21 offset:2048
  ds_read_b64_tr_b16 a[246:247], v21 offset:2560
  ds_read_b64_tr_b16 a[248:249], v23 offset:0
  v_mfma_f32_32x32x16_bf16 v[192:207], a[252:255], v[92:95], v[192:207]
  buffer_load_dwordx4 a[44:47], v34, s[16:19], s21 offen offset:1024 sc1
  ds_read_b64_tr_b16 a[250:251], v23 offset:512
  s_waitcnt lgkmcnt(10)
  v_mfma_f32_32x32x16_bf16 v[112:127], a[224:227], v[240:243], 0
  buffer_load_dwordx4 a[32:35], v33, s[16:19], s21 offen offset:0 sc1
  ds_read_b64_tr_b16 a[252:253], v23 offset:2048
  ds_read_b64_tr_b16 a[254:255], v23 offset:2560
  v_mfma_f32_32x32x16_bf16 v[112:127], a[228:231], v[244:247], v[112:127]
  buffer_load_dwordx4 a[36:39], v33, s[16:19], s21 offen offset:1024 sc1
  s_waitcnt lgkmcnt(8)
  v_mfma_f32_32x32x16_bf16 v[112:127], a[232:235], v[248:251], v[112:127]
  s_add_u32 m0, s42, 65536
  s_add_u32 s55, s50, 0
  buffer_load_dwordx4 v8, s[24:27], s55 offen offset:0  lds
  v_mfma_f32_32x32x16_bf16 v[112:127], a[236:239], v[252:255], v[112:127]
  ds_read_b64_tr_b16 a[224:225], v17 offset:16384
  ds_read_b64_tr_b16 a[226:227], v17 offset:16896
  buffer_load_dwordx4 v9, s[24:27], s55 offen offset:1024  lds
  s_waitcnt lgkmcnt(6)
  v_mfma_f32_32x32x16_bf16 v[112:127], a[240:243], v[176:179], v[112:127]
  ds_read_b64_tr_b16 a[228:229], v17 offset:18432
  ds_read_b64_tr_b16 a[230:231], v17 offset:18944
  buffer_load_dwordx4 v10, s[24:27], s55 offen offset:2048  lds
  v_mfma_f32_32x32x16_bf16 v[112:127], a[244:247], v[180:183], v[112:127]
  ds_read_b64_tr_b16 a[232:233], v19 offset:16384
  ds_read_b64_tr_b16 a[234:235], v19 offset:16896
  ds_read_b64_tr_b16 a[236:237], v19 offset:18432
  s_waitcnt lgkmcnt(7)
  v_mfma_f32_32x32x16_bf16 v[112:127], a[248:251], v[184:187], v[112:127]
  buffer_load_dwordx4 v11, s[24:27], s55 offen offset:3072  lds
  ds_read_b64_tr_b16 a[238:239], v19 offset:18944
  ds_read_b64_tr_b16 a[240:241], v21 offset:16384
  v_mfma_f32_32x32x16_bf16 v[112:127], a[252:255], v[188:191], v[112:127]
  ds_read_b64_tr_b16 a[242:243], v21 offset:16896
  ds_read_b64_tr_b16 a[244:245], v21 offset:18432
  ds_read_b64_tr_b16 a[246:247], v21 offset:18944
  s_waitcnt vmcnt(10)
  v_mfma_f32_32x32x16_bf16 v[192:207], v[24:27], a[24:27], v[192:207]
  ds_read_b64_tr_b16 a[248:249], v23 offset:16384
  ds_read_b64_tr_b16 a[250:251], v23 offset:16896
  s_cmp_ge_u32 2, s46
  s_cselect_b32 s18, 688128, 0
  s_sub_u32 s35, 3, s46
  s_waitcnt vmcnt(9)
  v_mfma_f32_32x32x16_bf16 v[192:207], v[28:31], a[28:31], v[192:207]
  s_add_u32 m0, s42, 69632
  s_add_u32 s55, s50, 28672
  buffer_load_dwordx4 v8, s[24:27], s55 offen offset:0  lds
  s_waitcnt lgkmcnt(10)
  v_mfma_f32_32x32x16_bf16 v[112:127], a[224:227], v[48:51], v[112:127]
  buffer_load_dwordx4 v9, s[24:27], s55 offen offset:1024  lds
  ds_read_b64_tr_b16 a[252:253], v23 offset:18432
  ds_read_b64_tr_b16 a[254:255], v23 offset:18944
  v_mfma_f32_32x32x16_bf16 v[112:127], a[228:231], v[52:55], v[112:127]
  s_waitcnt vmcnt(10)
  v_mfma_f32_32x32x16_bf16 v[128:143], v[24:27], a[40:43], v[128:143]
  buffer_load_dwordx4 v10, s[24:27], s55 offen offset:2048  lds
  v_cvt_pk_bf16_f32 v192, v192, v193
  s_waitcnt vmcnt(9)
  v_mfma_f32_32x32x16_bf16 v[128:143], v[28:31], a[44:47], v[128:143]
  s_barrier
L_RS18:
  ds_read_b64_tr_b16 a[224:225], v2 offset:32768
  ds_read_b64_tr_b16 a[226:227], v2 offset:33280
  v_cvt_pk_bf16_f32 v193, v194, v195
  s_waitcnt lgkmcnt(10)
  v_mfma_f32_32x32x16_bf16 v[112:127], a[232:235], v[56:59], v[112:127]
  buffer_load_dwordx4 v11, s[24:27], s55 offen offset:3072  lds
  ds_read_b64_tr_b16 a[228:229], v2 offset:34816
  ds_read_b64_tr_b16 a[230:231], v2 offset:35328
  v_mfma_f32_32x32x16_bf16 v[112:127], a[236:239], v[60:63], v[112:127]
  v_cvt_pk_bf16_f32 v194, v196, v197
  v_cvt_pk_bf16_f32 v195, v198, v199
  v_cvt_pk_bf16_f32 v196, v200, v201
  v_cvt_pk_bf16_f32 v197, v202, v203
  v_cvt_pk_bf16_f32 v198, v204, v205
  s_waitcnt vmcnt(9)
  v_mfma_f32_32x32x16_bf16 v[112:127], v[24:27], a[32:35], v[112:127]
  v_cvt_pk_bf16_f32 v199, v206, v207
  ds_read_b64_tr_b16 a[232:233], v4 offset:32768
  ds_read_b64_tr_b16 a[234:235], v4 offset:33280
  v_cvt_pk_bf16_f32 v128, v128, v129
  v_cvt_pk_bf16_f32 v129, v130, v131
  s_waitcnt vmcnt(8)
  v_mfma_f32_32x32x16_bf16 v[112:127], v[28:31], a[36:39], v[112:127]
  v_cvt_pk_bf16_f32 v130, v132, v133
  v_cvt_pk_bf16_f32 v131, v134, v135
  v_cvt_pk_bf16_f32 v132, v136, v137
  v_cvt_pk_bf16_f32 v133, v138, v139
  v_cvt_pk_bf16_f32 v134, v140, v141
  s_waitcnt lgkmcnt(10)
  v_mfma_f32_32x32x16_bf16 v[112:127], a[240:243], v[80:83], v[112:127]
  buffer_store_dwordx4 v[192:195], v32, s[28:31], s21 offen offset:0
  v_mfma_f32_32x32x16_bf16 v[112:127], a[244:247], v[84:87], v[112:127]
  buffer_store_dwordx4 v[196:199], v32, s[28:31], s21 offen offset:1024
  s_waitcnt lgkmcnt(6)
  v_mfma_f32_32x32x16_bf16 v[112:127], a[248:251], v[88:91], v[112:127]
  ds_read_b64_tr_b16 a[236:237], v4 offset:34816
  ds_read_b64_tr_b16 a[238:239], v4 offset:35328
  v_cvt_pk_bf16_f32 v135, v142, v143
  ds_read_b64_tr_b16 a[240:241], v7 offset:32768
  v_mfma_f32_32x32x16_bf16 v[112:127], a[252:255], v[92:95], v[112:127]
  ds_read_b64_tr_b16 a[242:243], v7 offset:33280
  ds_read_b64_tr_b16 a[244:245], v7 offset:34816
  ds_read_b64_tr_b16 a[246:247], v7 offset:35328
  s_waitcnt lgkmcnt(10)
  v_mfma_f32_32x32x16_bf16 v[208:223], a[224:227], v[240:243], 0
  buffer_store_dwordx4 v[128:131], v34, s[28:31], s21 offen offset:0
  v_mfma_f32_32x32x16_bf16 v[224:239], a[224:227], a[192:195], 0
  buffer_store_dwordx4 v[132:135], v34, s[28:31], s21 offen offset:1024
  s_waitcnt lgkmcnt(8)
  v_mfma_f32_32x32x16_bf16 v[208:223], a[228:231], v[244:247], v[208:223]
  buffer_load_dword v41, off, s[60:63], s54 sc1
  ds_read_b64_tr_b16 a[248:249], v46 offset:32768
  ds_read_b64_tr_b16 a[250:251], v46 offset:33280
  ds_read_b64_tr_b16 a[252:253], v46 offset:34816
  v_cvt_pk_bf16_f32 v112, v112, v113
  v_mfma_f32_32x32x16_bf16 v[224:239], a[228:231], a[196:199], v[224:239]
  ds_read_b64_tr_b16 a[254:255], v46 offset:35328
  ds_read_b64_tr_b16 a[224:225], v2 offset:49152
  ds_read_b64_tr_b16 a[226:227], v2 offset:49664
  v_cvt_pk_bf16_f32 v113, v114, v115
  v_cvt_pk_bf16_f32 v114, v116, v117
  s_waitcnt lgkmcnt(12)
  v_mfma_f32_32x32x16_bf16 v[208:223], a[232:235], v[248:251], v[208:223]
  ds_read_b64_tr_b16 a[228:229], v2 offset:51200
  ds_read_b64_tr_b16 a[230:231], v2 offset:51712
  v_cvt_pk_bf16_f32 v115, v118, v119
  v_cvt_pk_bf16_f32 v116, v120, v121
  v_cvt_pk_bf16_f32 v117, v122, v123
  v_cvt_pk_bf16_f32 v118, v124, v125
  v_mfma_f32_32x32x16_bf16 v[224:239], a[232:235], a[200:203], v[224:239]
  v_cvt_pk_bf16_f32 v119, v126, v127
  s_waitcnt lgkmcnt(12)
  v_mfma_f32_32x32x16_bf16 v[208:223], a[236:239], v[252:255], v[208:223]
  buffer_store_dwordx4 v[112:115], v33, s[28:31], s21 offen offset:0
  v_mfma_f32_32x32x16_bf16 v[224:239], a[236:239], a[204:207], v[224:239]
  ds_read_b64_tr_b16 a[232:233], v4 offset:49152
  ds_read_b64_tr_b16 a[234:235], v4 offset:49664
  s_waitcnt lgkmcnt(10)
  v_mfma_f32_32x32x16_bf16 v[208:223], a[240:243], v[176:179], v[208:223]
  buffer_store_dwordx4 v[116:119], v33, s[28:31], s21 offen offset:1024
  v_mfma_f32_32x32x16_bf16 v[208:223], a[244:247], v[180:183], v[208:223]
  ds_read_b64_tr_b16 a[236:237], v4 offset:51200
  ds_read_b64_tr_b16 a[238:239], v4 offset:51712
  ds_read_b64_tr_b16 a[240:241], v7 offset:49152
  s_waitcnt lgkmcnt(9)
  v_mfma_f32_32x32x16_bf16 v[208:223], a[248:251], v[184:187], v[208:223]
  ds_read_b64_tr_b16 a[242:243], v7 offset:49664
  ds_read_b64_tr_b16 a[244:245], v7 offset:51200
  ds_read_b64_tr_b16 a[246:247], v7 offset:51712
  v_mfma_f32_32x32x16_bf16 v[208:223], a[252:255], v[188:191], v[208:223]
  ds_read_b64_tr_b16 a[248:249], v46 offset:49152
  ds_read_b64_tr_b16 a[250:251], v46 offset:49664
  s_waitcnt lgkmcnt(12)
  v_mfma_f32_32x32x16_bf16 v[208:223], a[224:227], v[48:51], v[208:223]
  ds_read_b64_tr_b16 a[252:253], v46 offset:51200
  ds_read_b64_tr_b16 a[254:255], v46 offset:51712
  v_mfma_f32_32x32x16_bf16 v[224:239], a[224:227], a[208:211], v[224:239]
  s_waitcnt lgkmcnt(12)
  v_mfma_f32_32x32x16_bf16 v[208:223], a[228:231], v[52:55], v[208:223]
  s_waitcnt vmcnt(2)
  v_cmp_gt_i32 vcc, s35, v41
  s_nop 1
  s_cbranch_vccnz L_sp2
L_go2:
  ds_read_b64_tr_b16 a[224:225], v3 offset:32768
  ds_read_b64_tr_b16 a[226:227], v3 offset:33280
  v_mfma_f32_32x32x16_bf16 v[224:239], a[228:231], a[212:215], v[224:239]
  buffer_load_dwordx4 a[0:3], v32, s[16:19], s22 offen offset:0 sc1
  s_waitcnt lgkmcnt(12)
  v_mfma_f32_32x32x16_bf16 v[208:223], a[232:235], v[56:59], v[208:223]
  ds_read_b64_tr_b16 a[228:229], v3 offset:34816
  ds_read_b64_tr_b16 a[230:231], v3 offset:35328
  v_mfma_f32_32x32x16_bf16 v[224:239], a[232:235], a[216:219], v[224:239]
  buffer_load_dwordx4 a[4:7], v32, s[16:19], s22 offen offset:1024 sc1
  s_waitcnt lgkmcnt(12)
  v_mfma_f32_32x32x16_bf16 v[208:223], a[236:239], v[60:63], v[208:223]
  ds_read_b64_tr_b16 a[232:233], v5 offset:32768
  ds_read_b64_tr_b16 a[234:235], v5 offset:33280
  v_mfma_f32_32x32x16_bf16 v[224:239], a[236:239], a[220:223], v[224:239]
  buffer_load_dwordx4 a[16:19], v34, s[16:19], s22 offen offset:0 sc1
  s_waitcnt lgkmcnt(10)
  v_mfma_f32_32x32x16_bf16 v[208:223], a[240:243], v[80:83], v[208:223]
  s_waitcnt vmcnt(3)
  buffer_store_dword v40, v1, s[60:63], s3 offen
  ds_read_b64_tr_b16 a[236:237], v5 offset:34816
  ds_read_b64_tr_b16 a[238:239], v5 offset:35328
  ds_read_b64_tr_b16 a[240:241], v35 offset:32768
  v_mfma_f32_32x32x16_bf16 v[208:223], a[244:247], v[84:87], v[208:223]
  ds_read_b64_tr_b16 a[242:243], v35 offset:33280
  v_mov_b32 v40, 3
  s_waitcnt lgkmcnt(10)
  v_mfma_f32_32x32x16_bf16 v[208:223], a[248:251], v[88:91], v[208:223]
  ds_read_b64_tr_b16 a[244:245], v35 offset:34816
  ds_read_b64_tr_b16 a[246:247], v35 offset:35328
  ds_read_b64_tr_b16 a[248:249], v47 offset:32768
  v_mfma_f32_32x32x16_bf16 v[208:223], a[252:255], v[92:95], v[208:223]
  buffer_load_dwordx4 a[20:23], v34, s[16:19], s22 offen offset:1024 sc1
  ds_read_b64_tr_b16 a[250:251], v47 offset:33280
  s_waitcnt lgkmcnt(10)
  v_mfma_f32_32x32x16_bf16 v[160:175], a[224:227], v[240:243], 0
  buffer_load_dwordx4 a[8:11], v33, s[16:19], s22 offen offset:0 sc1
  ds_read_b64_tr_b16 a[252:253], v47 offset:34816
  ds_read_b64_tr_b16 a[254:255], v47 offset:35328
  v_mfma_f32_32x32x16_bf16 v[160:175], a[228:231], v[244:247], v[160:175]
  buffer_load_dwordx4 a[12:15], v33, s[16:19], s22 offen offset:1024 sc1
  s_waitcnt lgkmcnt(8)
  v_mfma_f32_32x32x16_bf16 v[160:175], a[232:235], v[248:251], v[160:175]
  s_add_u32 m0, s42, 32768
  s_add_u32 s55, s51, 0
  buffer_load_dwordx4 v8, s[24:27], s55 offen offset:0  lds
  v_mfma_f32_32x32x16_bf16 v[160:175], a[236:239], v[252:255], v[160:175]
  ds_read_b64_tr_b16 a[224:225], v3 offset:49152
  ds_read_b64_tr_b16 a[226:227], v3 offset:49664
  buffer_load_dwordx4 v9, s[24:27], s55 offen offset:1024  lds
  s_waitcnt lgkmcnt(6)
  v_mfma_f32_32x32x16_bf16 v[160:175], a[240:243], v[176:179], v[160:175]
  ds_read_b64_tr_b16 a[228:229], v3 offset:51200
  ds_read_b64_tr_b16 a[230:231], v3 offset:51712
  buffer_load_dwordx4 v10, s[24:27], s55 offen offset:2048  lds
  v_mfma_f32_32x32x16_bf16 v[160:175], a[244:247], v[180:183], v[160:175]
  ds_read_b64_tr_b16 a[232:233], v5 offset:49152
  ds_read_b64_tr_b16 a[234:235], v5 offset:49664
  ds_read_b64_tr_b16 a[236:237], v5 offset:51200
  s_waitcnt lgkmcnt(7)
  v_mfma_f32_32x32x16_bf16 v[160:175], a[248:251], v[184:187], v[160:175]
  buffer_load_dwordx4 v11, s[24:27], s55 offen offset:3072  lds
  ds_read_b64_tr_b16 a[238:239], v5 offset:51712
  ds_read_b64_tr_b16 a[240:241], v35 offset:49152
  v_mfma_f32_32x32x16_bf16 v[160:175], a[252:255], v[188:191], v[160:175]
  ds_read_b64_tr_b16 a[242:243], v35 offset:49664
  ds_read_b64_tr_b16 a[244:245], v35 offset:51200
  ds_read_b64_tr_b16 a[246:247], v35 offset:51712
  s_waitcnt vmcnt(10)
  v_mfma_f32_32x32x16_bf16 v[208:223], v[24:27], a[0:3], v[208:223]
  ds_read_b64_tr_b16 a[248:249], v47 offset:49152
  ds_read_b64_tr_b16 a[250:251], v47 offset:49664
  s_cmp_ge_u32 3, s46
  s_cselect_b32 s18, 688128, 0
  s_sub_u32 s35, 4, s46
  s_waitcnt vmcnt(9)
  v_mfma_f32_32x32x16_bf16 v[208:223], v[28:31], a[4:7], v[208:223]
  s_add_u32 m0, s42, 36864
  s_add_u32 s55, s51, 28672
  buffer_load_dwordx4 v8, s[24:27], s55 offen offset:0  lds
  s_waitcnt lgkmcnt(10)
  v_mfma_f32_32x32x16_bf16 v[160:175], a[224:227], v[48:51], v[160:175]
  buffer_load_dwordx4 v9, s[24:27], s55 offen offset:1024  lds
  ds_read_b64_tr_b16 a[252:253], v47 offset:51200
  ds_read_b64_tr_b16 a[254:255], v47 offset:51712
  v_mfma_f32_32x32x16_bf16 v[160:175], a[228:231], v[52:55], v[160:175]
  s_waitcnt vmcnt(10)
  v_mfma_f32_32x32x16_bf16 v[224:239], v[24:27], a[16:19], v[224:239]
  buffer_load_dwordx4 v10, s[24:27], s55 offen offset:2048  lds
  v_cvt_pk_bf16_f32 v208, v208, v209
  s_waitcnt vmcnt(9)
  v_mfma_f32_32x32x16_bf16 v[224:239], v[28:31], a[20:23], v[224:239]
  s_barrier
L_RS19:
  ds_read_b64_tr_b16 a[224:225], v2 offset:0
  ds_read_b64_tr_b16 a[226:227], v2 offset:512
  v_cvt_pk_bf16_f32 v209, v210, v211
  s_waitcnt lgkmcnt(10)
  v_mfma_f32_32x32x16_bf16 v[160:175], a[232:235], v[56:59], v[160:175]
  buffer_load_dwordx4 v11, s[24:27], s55 offen offset:3072  lds
  ds_read_b64_tr_b16 a[228:229], v2 offset:2048
  ds_read_b64_tr_b16 a[230:231], v2 offset:2560
  v_mfma_f32_32x32x16_bf16 v[160:175], a[236:239], v[60:63], v[160:175]
  v_cvt_pk_bf16_f32 v210, v212, v213
  v_cvt_pk_bf16_f32 v211, v214, v215
  v_cvt_pk_bf16_f32 v212, v216, v217
  v_cvt_pk_bf16_f32 v213, v218, v219
  v_cvt_pk_bf16_f32 v214, v220, v221
  s_waitcnt vmcnt(9)
  v_mfma_f32_32x32x16_bf16 v[160:175], v[24:27], a[8:11], v[160:175]
  v_cvt_pk_bf16_f32 v215, v222, v223
  ds_read_b64_tr_b16 a[232:233], v4 offset:0
  ds_read_b64_tr_b16 a[234:235], v4 offset:512
  v_cvt_pk_bf16_f32 v224, v224, v225
  v_cvt_pk_bf16_f32 v225, v226, v227
  s_waitcnt vmcnt(8)
  v_mfma_f32_32x32x16_bf16 v[160:175], v[28:31], a[12:15], v[160:175]
  v_cvt_pk_bf16_f32 v226, v228, v229
  v_cvt_pk_bf16_f32 v227, v230, v231
  v_cvt_pk_bf16_f32 v228, v232, v233
  v_cvt_pk_bf16_f32 v229, v234, v235
  v_cvt_pk_bf16_f32 v230, v236, v237
  s_waitcnt lgkmcnt(10)
  v_mfma_f32_32x32x16_bf16 v[160:175], a[240:243], v[80:83], v[160:175]
  buffer_store_dwordx4 v[208:211], v32, s[28:31], s22 offen offset:0
  v_mfma_f32_32x32x16_bf16 v[160:175], a[244:247], v[84:87], v[160:175]
  buffer_store_dwordx4 v[212:215], v32, s[28:31], s22 offen offset:1024
  s_waitcnt lgkmcnt(6)
  v_mfma_f32_32x32x16_bf16 v[160:175], a[248:251], v[88:91], v[160:175]
  ds_read_b64_tr_b16 a[236:237], v4 offset:2048
  ds_read_b64_tr_b16 a[238:239], v4 offset:2560
  v_cvt_pk_bf16_f32 v231, v238, v239
  ds_read_b64_tr_b16 a[240:241], v7 offset:0
  v_mfma_f32_32x32x16_bf16 v[160:175], a[252:255], v[92:95], v[160:175]
  ds_read_b64_tr_b16 a[242:243], v7 offset:512
  ds_read_b64_tr_b16 a[244:245], v7 offset:2048
  ds_read_b64_tr_b16 a[246:247], v7 offset:2560
  s_waitcnt lgkmcnt(10)
  v_mfma_f32_32x32x16_bf16 v[64:79], a[224:227], v[240:243], 0
  buffer_store_dwordx4 v[224:227], v34, s[28:31], s22 offen offset:0
  v_mfma_f32_32x32x16_bf16 v[96:111], a[224:227], a[192:195], 0
  buffer_store_dwordx4 v[228:231], v34, s[28:31], s22 offen offset:1024
  s_waitcnt lgkmcnt(8)
  v_mfma_f32_32x32x16_bf16 v[64:79], a[228:231], v[244:247], v[64:79]
  buffer_load_dword v41, off, s[60:63], s54 sc1
  ds_read_b64_tr_b16 a[248:249], v46 offset:0
  ds_read_b64_tr_b16 a[250:251], v46 offset:512
  ds_read_b64_tr_b16 a[252:253], v46 offset:2048
  v_cvt_pk_bf16_f32 v160, v160, v161
  v_mfma_f32_32x32x16_bf16 v[96:111], a[228:231], a[196:199], v[96:111]
  ds_read_b64_tr_b16 a[254:255], v46 offset:2560
  ds_read_b64_tr_b16 a[224:225], v2 offset:16384
  ds_read_b64_tr_b16 a[226:227], v2 offset:16896
  v_cvt_pk_bf16_f32 v161, v162, v163
  v_cvt_pk_bf16_f32 v162, v164, v165
  s_waitcnt lgkmcnt(12)
  v_mfma_f32_32x32x16_bf16 v[64:79], a[232:235], v[248:251], v[64:79]
  ds_read_b64_tr_b16 a[228:229], v2 offset:18432
  ds_read_b64_tr_b16 a[230:231], v2 offset:18944
  v_cvt_pk_bf16_f32 v163, v166, v167
  v_cvt_pk_bf16_f32 v164, v168, v169
  v_cvt_pk_bf16_f32 v165, v170, v171
  v_cvt_pk_bf16_f32 v166, v172, v173
  v_mfma_f32_32x32x16_bf16 v[96:111], a[232:235], a[200:203], v[96:111]
  v_cvt_pk_bf16_f32 v167, v174, v175
  s_waitcnt lgkmcnt(12)
  v_mfma_f32_32x32x16_bf16 v[64:79], a[236:239], v[252:255], v[64:79]
  buffer_store_dwordx4 v[160:163], v33, s[28:31], s22 offen offset:0
  v_mfma_f32_32x32x16_bf16 v[96:111], a[236:239], a[204:207], v[96:111]
  ds_read_b64_tr_b16 a[232:233], v4 offset:16384
  ds_read_b64_tr_b16 a[234:235], v4 offset:16896
  s_waitcnt lgkmcnt(10)
  v_mfma_f32_32x32x16_bf16 v[64:79], a[240:243], v[176:179], v[64:79]
  buffer_store_dwordx4 v[164:167], v33, s[28:31], s22 offen offset:1024
  v_mfma_f32_32x32x16_bf16 v[64:79], a[244:247], v[180:183], v[64:79]
  ds_read_b64_tr_b16 a[236:237], v4 offset:18432
  ds_read_b64_tr_b16 a[238:239], v4 offset:18944
  ds_read_b64_tr_b16 a[240:241], v7 offset:16384
  s_waitcnt lgkmcnt(9)
  v_mfma_f32_32x32x16_bf16 v[64:79], a[248:251], v[184:187], v[64:79]
  ds_read_b64_tr_b16 a[242:243], v7 offset:16896
  ds_read_b64_tr_b16 a[244:245], v7 offset:18432
  ds_read_b64_tr_b16 a[246:247], v7 offset:18944
  v_mfma_f32_32x32x16_bf16 v[64:79], a[252:255], v[188:191], v[64:79]
  ds_read_b64_tr_b16 a[248:249], v46 offset:16384
  ds_read_b64_tr_b16 a[250:251], v46 offset:16896
  s_waitcnt lgkmcnt(12)
  v_mfma_f32_32x32x16_bf16 v[64:79], a[224:227], v[48:51], v[64:79]
  ds_read_b64_tr_b16 a[252:253], v46 offset:18432
  ds_read_b64_tr_b16 a[254:255], v46 offset:18944
  v_mfma_f32_32x32x16_bf16 v[96:111], a[224:227], a[208:211], v[96:111]
  s_waitcnt lgkmcnt(12)
  v_mfma_f32_32x32x16_bf16 v[64:79], a[228:231], v[52:55], v[64:79]
  s_waitcnt vmcnt(2)
  v_cmp_gt_i32 vcc, s35, v41
  s_nop 1
  s_cbranch_vccnz L_sp3
L_go3:
  ds_read_b64_tr_b16 a[224:225], v3 offset:0
  ds_read_b64_tr_b16 a[226:227], v3 offset:512
  v_mfma_f32_32x32x16_bf16 v[96:111], a[228:231], a[212:215], v[96:111]
  buffer_load_dwordx4 a[24:27], v32, s[16:19], s23 offen offset:0 sc1
  s_waitcnt lgkmcnt(12)
  v_mfma_f32_32x32x16_bf16 v[64:79], a[232:235], v[56:59], v[64:79]
  ds_read_b64_tr_b16 a[228:229], v3 offset:2048
  ds_read_b64_tr_b16 a[230:231], v3 offset:2560
  v_mfma_f32_32x32x16_bf16 v[96:111], a[232:235], a[216:219], v[96:111]
  buffer_load_dwordx4 a[28:31], v32, s[16:19], s23 offen offset:1024 sc1
  s_waitcnt lgkmcnt(12)
  v_mfma_f32_32x32x16_bf16 v[64:79], a[236:239], v[60:63], v[64:79]
  ds_read_b64_tr_b16 a[232:233], v5 offset:0
  ds_read_b64_tr_b16 a[234:235], v5 offset:512
  v_mfma_f32_32x32x16_bf16 v[96:111], a[236:239], a[220:223], v[96:111]
  buffer_load_dwordx4 a[40:43], v34, s[16:19], s23 offen offset:0 sc1
  s_waitcnt lgkmcnt(10)
  v_mfma_f32_32x32x16_bf16 v[64:79], a[240:243], v[80:83], v[64:79]
  s_waitcnt vmcnt(3)
  buffer_store_dword v40, v1, s[60:63], s3 offen
  ds_read_b64_tr_b16 a[236:237], v5 offset:2048
  ds_read_b64_tr_b16 a[238:239], v5 offset:2560
  ds_read_b64_tr_b16 a[240:241], v35 offset:0
  v_mfma_f32_32x32x16_bf16 v[64:79], a[244:247], v[84:87], v[64:79]
  ds_read_b64_tr_b16 a[242:243], v35 offset:512
  v_mov_b32 v40, 4
  s_waitcnt lgkmcnt(10)
  v_mfma_f32_32x32x16_bf16 v[64:79], a[248:251], v[88:91], v[64:79]
  ds_read_b64_tr_b16 a[244:245], v35 offset:2048
  ds_read_b64_tr_b16 a[246:247], v35 offset:2560
  ds_read_b64_tr_b16 a[248:249], v47 offset:0
  v_mfma_f32_32x32x16_bf16 v[64:79], a[252:255], v[92:95], v[64:79]
  buffer_load_dwordx4 a[44:47], v34, s[16:19], s23 offen offset:1024 sc1
  ds_read_b64_tr_b16 a[250:251], v47 offset:512
  s_waitcnt lgkmcnt(10)
  v_mfma_f32_32x32x16_bf16 v[144:159], a[224:227], v[240:243], 0
  buffer_load_dwordx4 a[32:35], v33, s[16:19], s23 offen offset:0 sc1
  ds_read_b64_tr_b16 a[252:253], v47 offset:2048
  ds_read_b64_tr_b16 a[254:255], v47 offset:2560
  v_mfma_f32_32x32x16_bf16 v[144:159], a[228:231], v[244:247], v[144:159]
  buffer_load_dwordx4 a[36:39], v33, s[16:19], s23 offen offset:1024 sc1
  s_waitcnt lgkmcnt(8)
  v_mfma_f32_32x32x16_bf16 v[144:159], a[232:235], v[248:251], v[144:159]
  s_add_u32 m0, s42, 0
  s_add_u32 s55, s52, 0
  buffer_load_dwordx4 v8, s[24:27], s55 offen offset:0  lds
  v_mfma_f32_32x32x16_bf16 v[144:159], a[236:239], v[252:255], v[144:159]
  ds_read_b64_tr_b16 a[224:225], v3 offset:16384
  ds_read_b64_tr_b16 a[226:227], v3 offset:16896
  buffer_load_dwordx4 v9, s[24:27], s55 offen offset:1024  lds
  s_waitcnt lgkmcnt(6)
  v_mfma_f32_32x32x16_bf16 v[144:159], a[240:243], v[176:179], v[144:159]
  ds_read_b64_tr_b16 a[228:229], v3 offset:18432
  ds_read_b64_tr_b16 a[230:231], v3 offset:18944
  buffer_load_dwordx4 v10, s[24:27], s55 offen offset:2048  lds
  v_mfma_f32_32x32x16_bf16 v[144:159], a[244:247], v[180:183], v[144:159]
  ds_read_b64_tr_b16 a[232:233], v5 offset:16384
  ds_read_b64_tr_b16 a[234:235], v5 offset:16896
  ds_read_b64_tr_b16 a[236:237], v5 offset:18432
  s_waitcnt lgkmcnt(7)
  v_mfma_f32_32x32x16_bf16 v[144:159], a[248:251], v[184:187], v[144:159]
  buffer_load_dwordx4 v11, s[24:27], s55 offen offset:3072  lds
  ds_read_b64_tr_b16 a[238:239], v5 offset:18944
  ds_read_b64_tr_b16 a[240:241], v35 offset:16384
  v_mfma_f32_32x32x16_bf16 v[144:159], a[252:255], v[188:191], v[144:159]
  ds_read_b64_tr_b16 a[242:243], v35 offset:16896
  ds_read_b64_tr_b16 a[244:245], v35 offset:18432
  ds_read_b64_tr_b16 a[246:247], v35 offset:18944
  s_waitcnt vmcnt(10)
  v_mfma_f32_32x32x16_bf16 v[64:79], v[24:27], a[24:27], v[64:79]
  ds_read_b64_tr_b16 a[248:249], v47 offset:16384
  ds_read_b64_tr_b16 a[250:251], v47 offset:16896
  s_cmp_ge_u32 4, s46
  s_cselect_b32 s18, 688128, 0
  s_sub_u32 s35, 5, s46
  s_waitcnt vmcnt(9)
  v_mfma_f32_32x32x16_bf16 v[64:79], v[28:31], a[28:31], v[64:79]
  s_add_u32 m0, s42, 4096
  s_add_u32 s55, s52, 28672
  buffer_load_dwordx4 v8, s[24:27], s55 offen offset:0  lds
  s_waitcnt lgkmcnt(10)
  v_mfma_f32_32x32x16_bf16 v[144:159], a[224:227], v[48:51], v[144:159]
  buffer_load_dwordx4 v9, s[24:27], s55 offen offset:1024  lds
  ds_read_b64_tr_b16 a[252:253], v47 offset:18432
  ds_read_b64_tr_b16 a[254:255], v47 offset:18944
  v_mfma_f32_32x32x16_bf16 v[144:159], a[228:231], v[52:55], v[144:159]
  s_waitcnt vmcnt(10)
  v_mfma_f32_32x32x16_bf16 v[96:111], v[24:27], a[40:43], v[96:111]
  buffer_load_dwordx4 v10, s[24:27], s55 offen offset:2048  lds
  v_cvt_pk_bf16_f32 v64, v64, v65
  s_waitcnt vmcnt(9)
  v_mfma_f32_32x32x16_bf16 v[96:111], v[28:31], a[44:47], v[96:111]
  s_barrier
L_RS20:
  ds_read_b64_tr_b16 a[224:225], v16 offset:32768
  ds_read_b64_tr_b16 a[226:227], v16 offset:33280
  v_cvt_pk_bf16_f32 v65, v66, v67
  s_waitcnt lgkmcnt(10)
  v_mfma_f32_32x32x16_bf16 v[144:159], a[232:235], v[56:59], v[144:159]
  buffer_load_dwordx4 v11, s[24:27], s55 offen offset:3072  lds
  ds_read_b64_tr_b16 a[228:229], v16 offset:34816
  ds_read_b64_tr_b16 a[230:231], v16 offset:35328
  v_mfma_f32_32x32x16_bf16 v[144:159], a[236:239], v[60:63], v[144:159]
  v_cvt_pk_bf16_f32 v66, v68, v69
  v_cvt_pk_bf16_f32 v67, v70, v71
  v_cvt_pk_bf16_f32 v68, v72, v73
  v_cvt_pk_bf16_f32 v69, v74, v75
  v_cvt_pk_bf16_f32 v70, v76, v77
  s_waitcnt vmcnt(9)
  v_mfma_f32_32x32x16_bf16 v[144:159], v[24:27], a[32:35], v[144:159]
  v_cvt_pk_bf16_f32 v71, v78, v79
  ds_read_b64_tr_b16 a[232:233], v18 offset:32768
  ds_read_b64_tr_b16 a[234:235], v18 offset:33280
  v_cvt_pk_bf16_f32 v96, v96, v97
  v_cvt_pk_bf16_f32 v97, v98, v99
  s_waitcnt vmcnt(8)
  v_mfma_f32_32x32x16_bf16 v[144:159], v[28:31], a[36:39], v[144:159]
  v_cvt_pk_bf16_f32 v98, v100, v101
  v_cvt_pk_bf16_f32 v99, v102, v103
  v_cvt_pk_bf16_f32 v100, v104, v105
  v_cvt_pk_bf16_f32 v101, v106, v107
  v_cvt_pk_bf16_f32 v102, v108, v109
  s_waitcnt lgkmcnt(10)
  v_mfma_f32_32x32x16_bf16 v[144:159], a[240:243], v[80:83], v[144:159]
  buffer_store_dwordx4 v[64:67], v32, s[28:31], s23 offen offset:0
  v_mfma_f32_32x32x16_bf16 v[144:159], a[244:247], v[84:87], v[144:159]
  buffer_store_dwordx4 v[68:71], v32, s[28:31], s23 offen offset:1024
  s_waitcnt lgkmcnt(6)
  v_mfma_f32_32x32x16_bf16 v[144:159], a[248:251], v[88:91], v[144:159]
  ds_read_b64_tr_b16 a[236:237], v18 offset:34816
  ds_read_b64_tr_b16 a[238:239], v18 offset:35328
  v_cvt_pk_bf16_f32 v103, v110, v111
  ds_read_b64_tr_b16 a[240:241], v20 offset:32768
  v_mfma_f32_32x32x16_bf16 v[144:159], a[252:255], v[92:95], v[144:159]
  ds_read_b64_tr_b16 a[242:243], v20 offset:33280
  ds_read_b64_tr_b16 a[244:245], v20 offset:34816
  ds_read_b64_tr_b16 a[246:247], v20 offset:35328
  s_waitcnt lgkmcnt(10)
  v_mfma_f32_32x32x16_bf16 v[192:207], a[224:227], v[240:243], 0
  buffer_store_dwordx4 v[96:99], v34, s[28:31], s23 offen offset:0
  v_mfma_f32_32x32x16_bf16 v[128:143], a[224:227], a[192:195], 0
  buffer_store_dwordx4 v[100:103], v34, s[28:31], s23 offen offset:1024
  s_waitcnt lgkmcnt(8)
  v_mfma_f32_32x32x16_bf16 v[192:207], a[228:231], v[244:247], v[192:207]
  buffer_load_dword v41, off, s[60:63], s54 sc1
  ds_read_b64_tr_b16 a[248:249], v22 offset:32768
  ds_read_b64_tr_b16 a[250:251], v22 offset:33280
  ds_read_b64_tr_b16 a[252:253], v22 offset:34816
  v_cvt_pk_bf16_f32 v144, v144, v145
  v_mfma_f32_32x32x16_bf16 v[128:143], a[228:231], a[196:199], v[128:143]
  ds_read_b64_tr_b16 a[254:255], v22 offset:35328
  ds_read_b64_tr_b16 a[224:225], v16 offset:49152
  ds_read_b64_tr_b16 a[226:227], v16 offset:49664
  v_cvt_pk_bf16_f32 v145, v146, v147
  v_cvt_pk_bf16_f32 v146, v148, v149
  s_waitcnt lgkmcnt(12)
  v_mfma_f32_32x32x16_bf16 v[192:207], a[232:235], v[248:251], v[192:207]
  ds_read_b64_tr_b16 a[228:229], v16 offset:51200
  ds_read_b64_tr_b16 a[230:231], v16 offset:51712
  v_cvt_pk_bf16_f32 v147, v150, v151
  v_cvt_pk_bf16_f32 v148, v152, v153
  v_cvt_pk_bf16_f32 v149, v154, v155
  v_cvt_pk_bf16_f32 v150, v156, v157
  v_mfma_f32_32x32x16_bf16 v[128:143], a[232:235], a[200:203], v[128:143]
  v_cvt_pk_bf16_f32 v151, v158, v159
  s_waitcnt lgkmcnt(12)
  v_mfma_f32_32x32x16_bf16 v[192:207], a[236:239], v[252:255], v[192:207]
  buffer_store_dwordx4 v[144:147], v33, s[28:31], s23 offen offset:0
  v_mfma_f32_32x32x16_bf16 v[128:143], a[236:239], a[204:207], v[128:143]
  ds_read_b64_tr_b16 a[232:233], v18 offset:49152
  ds_read_b64_tr_b16 a[234:235], v18 offset:49664
  s_waitcnt lgkmcnt(10)
  v_mfma_f32_32x32x16_bf16 v[192:207], a[240:243], v[176:179], v[192:207]
  buffer_store_dwordx4 v[148:151], v33, s[28:31], s23 offen offset:1024
  v_mfma_f32_32x32x16_bf16 v[192:207], a[244:247], v[180:183], v[192:207]
  ds_read_b64_tr_b16 a[236:237], v18 offset:51200
  ds_read_b64_tr_b16 a[238:239], v18 offset:51712
  ds_read_b64_tr_b16 a[240:241], v20 offset:49152
  s_waitcnt lgkmcnt(9)
  v_mfma_f32_32x32x16_bf16 v[192:207], a[248:251], v[184:187], v[192:207]
  ds_read_b64_tr_b16 a[242:243], v20 offset:49664
  ds_read_b64_tr_b16 a[244:245], v20 offset:51200
  ds_read_b64_tr_b16 a[246:247], v20 offset:51712
  v_mfma_f32_32x32x16_bf16 v[192:207], a[252:255], v[188:191], v[192:207]
  ds_read_b64_tr_b16 a[248:249], v22 offset:49152
  ds_read_b64_tr_b16 a[250:251], v22 offset:49664
  s_waitcnt lgkmcnt(12)
  v_mfma_f32_32x32x16_bf16 v[192:207], a[224:227], v[48:51], v[192:207]
  ds_read_b64_tr_b16 a[252:253], v22 offset:51200
  ds_read_b64_tr_b16 a[254:255], v22 offset:51712
  v_mfma_f32_32x32x16_bf16 v[128:143], a[224:227], a[208:211], v[128:143]
  s_waitcnt lgkmcnt(12)
  v_mfma_f32_32x32x16_bf16 v[192:207], a[228:231], v[52:55], v[192:207]
  s_waitcnt vmcnt(2)
  v_cmp_gt_i32 vcc, s35, v41
  s_nop 1
  s_cbranch_vccnz L_sp4
L_go4:
  ds_read_b64_tr_b16 a[224:225], v17 offset:32768
  ds_read_b64_tr_b16 a[226:227], v17 offset:33280
  v_mfma_f32_32x32x16_bf16 v[128:143], a[228:231], a[212:215], v[128:143]
  buffer_load_dwordx4 a[0:3], v32, s[16:19], s40 offen offset:0 sc1
  s_waitcnt lgkmcnt(12)
  v_mfma_f32_32x32x16_bf16 v[192:207], a[232:235], v[56:59], v[192:207]
  ds_read_b64_tr_b16 a[228:229], v17 offset:34816
  ds_read_b64_tr_b16 a[230:231], v17 offset:35328
  v_mfma_f32_32x32x16_bf16 v[128:143], a[232:235], a[216:219], v[128:143]
  buffer_load_dwordx4 a[4:7], v32, s[16:19], s40 offen offset:1024 sc1
  s_waitcnt lgkmcnt(12)
  v_mfma_f32_32x32x16_bf16 v[192:207], a[236:239], v[60:63], v[192:207]
  ds_read_b64_tr_b16 a[232:233], v19 offset:32768
  ds_read_b64_tr_b16 a[234:235], v19 offset:33280
  v_mfma_f32_32x32x16_bf16 v[128:143], a[236:239], a[220:223], v[128:143]
  buffer_load_dwordx4 a[16:19], v34, s[16:19], s40 offen offset:0 sc1
  s_waitcnt lgkmcnt(10)
  v_mfma_f32_32x32x16_bf16 v[192:207], a[240:243], v[80:83], v[192:207]
  s_waitcnt vmcnt(3)
  buffer_store_dword v40, v1, s[60:63], s3 offen
  ds_read_b64_tr_b16 a[236:237], v19 offset:34816
  ds_read_b64_tr_b16 a[238:239], v19 offset:35328
  ds_read_b64_tr_b16 a[240:241], v21 offset:32768
  v_mfma_f32_32x32x16_bf16 v[192:207], a[244:247], v[84:87], v[192:207]
  ds_read_b64_tr_b16 a[242:243], v21 offset:33280
  v_mov_b32 v40, 5
  s_waitcnt lgkmcnt(10)
  v_mfma_f32_32x32x16_bf16 v[192:207], a[248:251], v[88:91], v[192:207]
  ds_read_b64_tr_b16 a[244:245], v21 offset:34816
  ds_read_b64_tr_b16 a[246:247], v21 offset:35328
  ds_read_b64_tr_b16 a[248:249], v23 offset:32768
  v_mfma_f32_32x32x16_bf16 v[192:207], a[252:255], v[92:95], v[192:207]
  buffer_load_dwordx4 a[20:23], v34, s[16:19], s40 offen offset:1024 sc1
  ds_read_b64_tr_b16 a[250:251], v23 offset:33280
  s_waitcnt lgkmcnt(10)
  v_mfma_f32_32x32x16_bf16 v[112:127], a[224:227], v[240:243], 0
  buffer_load_dwordx4 a[8:11], v33, s[16:19], s40 offen offset:0 sc1
  ds_read_b64_tr_b16 a[252:253], v23 offset:34816
  ds_read_b64_tr_b16 a[254:255], v23 offset:35328
  v_mfma_f32_32x32x16_bf16 v[112:127], a[228:231], v[244:247], v[112:127]
  buffer_load_dwordx4 a[12:15], v33, s[16:19], s40 offen offset:1024 sc1
  s_waitcnt lgkmcnt(8)
  v_mfma_f32_32x32x16_bf16 v[112:127], a[232:235], v[248:251], v[112:127]
  s_add_u32 m0, s42, 98304
  s_add_u32 s55, s53, 0
  buffer_load_dwordx4 v8, s[24:27], s55 offen offset:0  lds
  v_mfma_f32_32x32x16_bf16 v[112:127], a[236:239], v[252:255], v[112:127]
  ds_read_b64_tr_b16 a[224:225], v17 offset:49152
  ds_read_b64_tr_b16 a[226:227], v17 offset:49664
  buffer_load_dwordx4 v9, s[24:27], s55 offen offset:1024  lds
  s_waitcnt lgkmcnt(6)
  v_mfma_f32_32x32x16_bf16 v[112:127], a[240:243], v[176:179], v[112:127]
  ds_read_b64_tr_b16 a[228:229], v17 offset:51200
  ds_read_b64_tr_b16 a[230:231], v17 offset:51712
  buffer_load_dwordx4 v10, s[24:27], s55 offen offset:2048  lds
  v_mfma_f32_32x32x16_bf16 v[112:127], a[244:247], v[180:183], v[112:127]
  ds_read_b64_tr_b16 a[232:233], v19 offset:49152
  ds_read_b64_tr_b16 a[234:235], v19 offset:49664
  ds_read_b64_tr_b16 a[236:237], v19 offset:51200
  s_waitcnt lgkmcnt(7)
  v_mfma_f32_32x32x16_bf16 v[112:127], a[248:251], v[184:187], v[112:127]
  buffer_load_dwordx4 v11, s[24:27], s55 offen offset:3072  lds
  ds_read_b64_tr_b16 a[238:239], v19 offset:51712
  ds_read_b64_tr_b16 a[240:241], v21 offset:49152
  v_mfma_f32_32x32x16_bf16 v[112:127], a[252:255], v[188:191], v[112:127]
  ds_read_b64_tr_b16 a[242:243], v21 offset:49664
  ds_read_b64_tr_b16 a[244:245], v21 offset:51200
  ds_read_b64_tr_b16 a[246:247], v21 offset:51712
  s_waitcnt vmcnt(10)
  v_mfma_f32_32x32x16_bf16 v[192:207], v[24:27], a[0:3], v[192:207]
  ds_read_b64_tr_b16 a[248:249], v23 offset:49152
  ds_read_b64_tr_b16 a[250:251], v23 offset:49664
  s_cmp_ge_u32 5, s46
  s_cselect_b32 s18, 688128, 0
  s_sub_u32 s35, 6, s46
  s_waitcnt vmcnt(9)
  v_mfma_f32_32x32x16_bf16 v[192:207], v[28:31], a[4:7], v[192:207]
  s_add_u32 m0, s42, 102400
  s_add_u32 s55, s53, 28672
  buffer_load_dwordx4 v8, s[24:27], s55 offen offset:0  lds
  s_waitcnt lgkmcnt(10)
  v_mfma_f32_32x32x16_bf16 v[112:127], a[224:227], v[48:51], v[112:127]
  buffer_load_dwordx4 v9, s[24:27], s55 offen offset:1024  lds
  ds_read_b64_tr_b16 a[252:253], v23 offset:51200
  ds_read_b64_tr_b16 a[254:255], v23 offset:51712
  v_mfma_f32_32x32x16_bf16 v[112:127], a[228:231], v[52:55], v[112:127]
  s_waitcnt vmcnt(10)
  v_mfma_f32_32x32x16_bf16 v[128:143], v[24:27], a[16:19], v[128:143]
  buffer_load_dwordx4 v10, s[24:27], s55 offen offset:2048  lds
  v_cvt_pk_bf16_f32 v192, v192, v193
  s_waitcnt vmcnt(9)
  v_mfma_f32_32x32x16_bf16 v[128:143], v[28:31], a[20:23], v[128:143]
  s_barrier
L_RS21:
  ds_read_b64_tr_b16 a[224:225], v16 offset:0
  ds_read_b64_tr_b16 a[226:227], v16 offset:512
  v_cvt_pk_bf16_f32 v193, v194, v195
  s_waitcnt lgkmcnt(10)
  v_mfma_f32_32x32x16_bf16 v[112:127], a[232:235], v[56:59], v[112:127]
  buffer_load_dwordx4 v11, s[24:27], s55 offen offset:3072  lds
  ds_read_b64_tr_b16 a[228:229], v16 offset:2048
  ds_read_b64_tr_b16 a[230:231], v16 offset:2560
  v_mfma_f32_32x32x16_bf16 v[112:127], a[236:239], v[60:63], v[112:127]
  v_cvt_pk_bf16_f32 v194, v196, v197
  v_cvt_pk_bf16_f32 v195, v198, v199
  v_cvt_pk_bf16_f32 v196, v200, v201
  v_cvt_pk_bf16_f32 v197, v202, v203
  v_cvt_pk_bf16_f32 v198, v204, v205
  s_waitcnt vmcnt(9)
  v_mfma_f32_32x32x16_bf16 v[112:127], v[24:27], a[8:11], v[112:127]
  v_cvt_pk_bf16_f32 v199, v206, v207
  ds_read_b64_tr_b16 a[232:233], v18 offset:0
  ds_read_b64_tr_b16 a[234:235], v18 offset:512
  v_cvt_pk_bf16_f32 v128, v128, v129
  v_cvt_pk_bf16_f32 v129, v130, v131
  s_waitcnt vmcnt(8)
  v_mfma_f32_32x32x16_bf16 v[112:127], v[28:31], a[12:15], v[112:127]
  v_cvt_pk_bf16_f32 v130, v132, v133
  v_cvt_pk_bf16_f32 v131, v134, v135
  v_cvt_pk_bf16_f32 v132, v136, v137
  v_cvt_pk_bf16_f32 v133, v138, v139
  v_cvt_pk_bf16_f32 v134, v140, v141
  s_waitcnt lgkmcnt(10)
  v_mfma_f32_32x32x16_bf16 v[112:127], a[240:243], v[80:83], v[112:127]
  buffer_store_dwordx4 v[192:195], v32, s[28:31], s40 offen offset:0
  v_mfma_f32_32x32x16_bf16 v[112:127], a[244:247], v[84:87], v[112:127]
  buffer_store_dwordx4 v[196:199], v32, s[28:31], s40 offen offset:1024
  s_waitcnt lgkmcnt(6)
  v_mfma_f32_32x32x16_bf16 v[112:127], a[248:251], v[88:91], v[112:127]
  ds_read_b64_tr_b16 a[236:237], v18 offset:2048
  ds_read_b64_tr_b16 a[238:239], v18 offset:2560
  v_cvt_pk_bf16_f32 v135, v142, v143
  ds_read_b64_tr_b16 a[240:241], v20 offset:0
  v_mfma_f32_32x32x16_bf16 v[112:127], a[252:255], v[92:95], v[112:127]
  ds_read_b64_tr_b16 a[242:243], v20 offset:512
  ds_read_b64_tr_b16 a[244:245], v20 offset:2048
  ds_read_b64_tr_b16 a[246:247], v20 offset:2560
  s_waitcnt lgkmcnt(10)
  v_mfma_f32_32x32x16_bf16 v[208:223], a[224:227], v[240:243], 0
  buffer_store_dwordx4 v[128:131], v34, s[28:31], s40 offen offset:0
  v_mfma_f32_32x32x16_bf16 v[224:239], a[224:227], a[192:195], 0
  buffer_store_dwordx4 v[132:135], v34, s[28:31], s40 offen offset:1024
  s_waitcnt lgkmcnt(8)
  v_mfma_f32_32x32x16_bf16 v[208:223], a[228:231], v[244:247], v[208:223]
  buffer_load_dword v41, off, s[60:63], s54 sc1
  ds_read_b64_tr_b16 a[248:249], v22 offset:0
  ds_read_b64_tr_b16 a[250:251], v22 offset:512
  ds_read_b64_tr_b16 a[252:253], v22 offset:2048
  v_cvt_pk_bf16_f32 v112, v112, v113
  v_mfma_f32_32x32x16_bf16 v[224:239], a[228:231], a[196:199], v[224:239]
  ds_read_b64_tr_b16 a[254:255], v22 offset:2560
  ds_read_b64_tr_b16 a[224:225], v16 offset:16384
  ds_read_b64_tr_b16 a[226:227], v16 offset:16896
  v_cvt_pk_bf16_f32 v113, v114, v115
  v_cvt_pk_bf16_f32 v114, v116, v117
  s_waitcnt lgkmcnt(12)
  v_mfma_f32_32x32x16_bf16 v[208:223], a[232:235], v[248:251], v[208:223]
  ds_read_b64_tr_b16 a[228:229], v16 offset:18432
  ds_read_b64_tr_b16 a[230:231], v16 offset:18944
  v_cvt_pk_bf16_f32 v115, v118, v119
  v_cvt_pk_bf16_f32 v116, v120, v121
  v_cvt_pk_bf16_f32 v117, v122, v123
  v_cvt_pk_bf16_f32 v118, v124, v125
  v_mfma_f32_32x32x16_bf16 v[224:239], a[232:235], a[200:203], v[224:239]
  v_cvt_pk_bf16_f32 v119, v126, v127
  v_and_b32 v12, 3, v0
  v_lshrrev_b32 v44, 2, v0
  v_lshlrev_b32 v12, 2, v12
  v_and_b32 v42, 15, v0
  s_waitcnt lgkmcnt(12)
  v_mfma_f32_32x32x16_bf16 v[208:223], a[236:239], v[252:255], v[208:223]
  buffer_store_dwordx4 v[112:115], v33, s[28:31], s40 offen offset:0
  v_mfma_f32_32x32x16_bf16 v[224:239], a[236:239], a[204:207], v[224:239]
  ds_read_b64_tr_b16 a[232:233], v18 offset:16384
  ds_read_b64_tr_b16 a[234:235], v18 offset:16896
  v_lshrrev_b32 v43, 4, v0
  v_lshl_add_u32 v12, v44, 7, v12
  v_mul_u32_u24 v15, 896, v42
  s_waitcnt lgkmcnt(10)
  v_mfma_f32_32x32x16_bf16 v[208:223], a[240:243], v[176:179], v[208:223]
  buffer_store_dwordx4 v[116:119], v33, s[28:31], s40 offen offset:1024
  v_mfma_f32_32x32x16_bf16 v[208:223], a[244:247], v[180:183], v[208:223]
  ds_read_b64_tr_b16 a[236:237], v18 offset:18432
  ds_read_b64_tr_b16 a[238:239], v18 offset:18944
  ds_read_b64_tr_b16 a[240:241], v20 offset:16384
  v_and_b32 v44, 1, v43
  v_lshl_add_u32 v38, v44, 3, v15
  s_waitcnt lgkmcnt(9)
  v_mfma_f32_32x32x16_bf16 v[208:223], a[248:251], v[184:187], v[208:223]
  ds_read_b64_tr_b16 a[242:243], v20 offset:16896
  ds_read_b64_tr_b16 a[244:245], v20 offset:18432
  ds_read_b64_tr_b16 a[246:247], v20 offset:18944
  s_cmp_eq_u32 s32, 3
  s_cselect_b32 s37, 0x40000000, 0
  s_cselect_b32 s38, 0x2000000, 16
  v_mfma_f32_32x32x16_bf16 v[208:223], a[252:255], v[188:191], v[208:223]
  ds_read_b64_tr_b16 a[248:249], v22 offset:16384
  ds_read_b64_tr_b16 a[250:251], v22 offset:16896
  v_and_b32 v44, 32, v0
  v_lshl_add_u32 v39, v44, 25, v38
  v_mul_lo_u32 v44, v44, s38
  s_waitcnt lgkmcnt(12)
  v_mfma_f32_32x32x16_bf16 v[208:223], a[224:227], v[48:51], v[208:223]
  ds_read_b64_tr_b16 a[252:253], v22 offset:18432
  ds_read_b64_tr_b16 a[254:255], v22 offset:18944
  v_add_u32 v38, v44, v38
  v_and_b32 v44, 1, v0
  v_lshlrev_b32 v13, 4, v42
  v_lshlrev_b32 v44, 4, v44
  v_mfma_f32_32x32x16_bf16 v[224:239], a[224:227], a[208:211], v[224:239]
  v_mov_b32 v45, 0x3f80
  v_lshl_add_u32 v13, v43, 11, v13
  v_lshl_add_u32 v15, v43, 3, v15
  v_lshrrev_b32 v42, 1, v42
  v_lshlrev_b32 v45, v44, v45
  s_waitcnt lgkmcnt(12)
  v_mfma_f32_32x32x16_bf16 v[208:223], a[228:231], v[52:55], v[208:223]
  s_waitcnt vmcnt(2)
  v_cmp_gt_i32 vcc, s35, v41
  s_nop 1
  s_cbranch_vccnz L_sp5
L_go5:
  ds_read_b64_tr_b16 a[224:225], v17 offset:0
  ds_read_b64_tr_b16 a[226:227], v17 offset:512
  v_mfma_f32_32x32x16_bf16 v[224:239], a[228:231], a[212:215], v[224:239]
  buffer_load_dwordx4 a[24:27], v32, s[16:19], s41 offen offset:0 sc1
  s_waitcnt lgkmcnt(12)
  v_mfma_f32_32x32x16_bf16 v[208:223], a[232:235], v[56:59], v[208:223]
  ds_read_b64_tr_b16 a[228:229], v17 offset:2048
  ds_read_b64_tr_b16 a[230:231], v17 offset:2560
  v_cmp_eq_u32 s[98:99], 0, v42
  s_nop 1
  v_cndmask_b32 v43, 0, v45, s[98:99]
  v_accvgpr_write_b32 a48, v43
  v_mfma_f32_32x32x16_bf16 v[224:239], a[232:235], a[216:219], v[224:239]
  buffer_load_dwordx4 a[28:31], v32, s[16:19], s41 offen offset:1024 sc1
  s_waitcnt lgkmcnt(12)
  v_mfma_f32_32x32x16_bf16 v[208:223], a[236:239], v[60:63], v[208:223]
  ds_read_b64_tr_b16 a[232:233], v19 offset:0
  ds_read_b64_tr_b16 a[234:235], v19 offset:512
  s_mul_i32 s36, s33, 688128
  s_add_u32 s8, s4, s36
  s_addc_u32 s9, s5, 0
  v_add_u32 v14, s37, v13
  v_mfma_f32_32x32x16_bf16 v[224:239], a[236:239], a[220:223], v[224:239]
  buffer_load_dwordx4 a[40:43], v34, s[16:19], s41 offen offset:0 sc1
  s_waitcnt lgkmcnt(10)
  v_mfma_f32_32x32x16_bf16 v[208:223], a[240:243], v[80:83], v[208:223]
  s_waitcnt vmcnt(3)
  buffer_store_dword v40, v1, s[60:63], s3 offen
  ds_read_b64_tr_b16 a[236:237], v19 offset:2048
  ds_read_b64_tr_b16 a[238:239], v19 offset:2560
  ds_read_b64_tr_b16 a[240:241], v21 offset:0
  v_mfma_f32_32x32x16_bf16 v[208:223], a[244:247], v[84:87], v[208:223]
  ds_read_b64_tr_b16 a[242:243], v21 offset:512
  v_mov_b32 v40, 6
  s_mul_i32 s36, s33, 143360
  s_add_u32 s12, s6, s36
  s_addc_u32 s13, s7, 0
  s_waitcnt lgkmcnt(10)
  v_mfma_f32_32x32x16_bf16 v[208:223], a[248:251], v[88:91], v[208:223]
  ds_read_b64_tr_b16 a[244:245], v21 offset:2048
  ds_read_b64_tr_b16 a[246:247], v21 offset:2560
  ds_read_b64_tr_b16 a[248:249], v23 offset:0
  s_mov_b32 s39, s34
  s_lshr_b32 s36, s39, 2
  s_bfe_u32 s37, s39, 65537
  v_mfma_f32_32x32x16_bf16 v[208:223], a[252:255], v[92:95], v[208:223]
  ds_read_b64_tr_b16 a[250:251], v23 offset:512
  buffer_load_dwordx4 a[44:47], v34, s[16:19], s41 offen offset:1024 sc1
  s_waitcnt lgkmcnt(10)
  v_mfma_f32_32x32x16_bf16 v[160:175], a[224:227], v[240:243], 0
  ds_read_b64_tr_b16 a[252:253], v23 offset:2048
  ds_read_b64_tr_b16 a[254:255], v23 offset:2560
  ds_read_b64_tr_b16 a[224:225], v17 offset:16384
  s_lshl_b32 s36, s36, 13
  s_lshl_b32 s37, s37, 10
  s_add_u32 s36, s36, s37
  v_mfma_f32_32x32x16_bf16 v[160:175], a[228:231], v[244:247], v[160:175]
  buffer_load_dwordx4 a[32:35], v33, s[16:19], s41 offen offset:0 sc1
  s_waitcnt lgkmcnt(9)
  v_mfma_f32_32x32x16_bf16 v[160:175], a[232:235], v[248:251], v[160:175]
  ds_read_b64_tr_b16 a[226:227], v17 offset:16896
  buffer_load_dwordx4 a[36:39], v33, s[16:19], s41 offen offset:1024 sc1
  v_mfma_f32_32x32x16_bf16 v[160:175], a[236:239], v[252:255], v[160:175]
  ds_read_b64_tr_b16 a[228:229], v17 offset:18432
  ds_read_b64_tr_b16 a[230:231], v17 offset:18944
  ds_read_b64_tr_b16 a[232:233], v19 offset:16384
  s_and_b32 s37, s39, 1
  s_lshl_b32 s37, s37, 8
  s_waitcnt lgkmcnt(9)
  v_mfma_f32_32x32x16_bf16 v[160:175], a[240:243], v[176:179], v[160:175]
  ds_read_b64_tr_b16 a[234:235], v19 offset:16896
  ds_read_b64_tr_b16 a[236:237], v19 offset:18432
  ds_read_b64_tr_b16 a[238:239], v19 offset:18944
  s_cmp_ge_u32 6, s46
  s_cselect_b32 s18, 688128, 0
  s_sub_u32 s35, 7, s46
  v_mfma_f32_32x32x16_bf16 v[160:175], a[244:247], v[180:183], v[160:175]
  ds_read_b64_tr_b16 a[240:241], v21 offset:16384
  ds_read_b64_tr_b16 a[242:243], v21 offset:16896
  s_mul_i32 s25, s32, 114688
  s_add_u32 s36, s36, s37
  s_add_u32 s24, s25, s36
  s_waitcnt lgkmcnt(10)
  v_mfma_f32_32x32x16_bf16 v[160:175], a[248:251], v[184:187], v[160:175]
  ds_read_b64_tr_b16 a[244:245], v21 offset:18432
  ds_read_b64_tr_b16 a[246:247], v21 offset:18944
  ds_read_b64_tr_b16 a[248:249], v23 offset:16384
  s_lshr_b32 s36, s39, 3
  s_bfe_u32 s37, s39, 65538
  s_lshl_b32 s36, s36, 13
  v_mfma_f32_32x32x16_bf16 v[160:175], a[252:255], v[188:191], v[160:175]
  ds_read_b64_tr_b16 a[250:251], v23 offset:16896
  v_cmp_eq_u32 s[98:99], 1, v42
  s_nop 1
  v_cndmask_b32 v43, 0, v45, s[98:99]
  v_accvgpr_write_b32 a49, v43
  s_waitcnt vmcnt(6)
  v_mfma_f32_32x32x16_bf16 v[208:223], v[24:27], a[24:27], v[208:223]
  v_cmp_eq_u32 s[98:99], 2, v42
  s_nop 1
  v_cndmask_b32 v43, 0, v45, s[98:99]
  v_accvgpr_write_b32 a50, v43
  s_lshl_b32 s37, s37, 10
  s_waitcnt vmcnt(5)
  v_mfma_f32_32x32x16_bf16 v[208:223], v[28:31], a[28:31], v[208:223]
  v_cmp_eq_u32 s[98:99], 3, v42
  s_nop 1
  v_cndmask_b32 v43, 0, v45, s[98:99]
  v_accvgpr_write_b32 a51, v43
  s_add_u32 s36, s36, s37
  s_waitcnt lgkmcnt(10)
  v_mfma_f32_32x32x16_bf16 v[160:175], a[224:227], v[48:51], v[160:175]
  ds_read_b64_tr_b16 a[252:253], v23 offset:18432
  ds_read_b64_tr_b16 a[254:255], v23 offset:18944
  v_cmp_eq_u32 s[98:99], 4, v42
  s_nop 1
  v_cndmask_b32 v43, 0, v45, s[98:99]
  v_accvgpr_write_b32 a52, v43
  v_mfma_f32_32x32x16_bf16 v[160:175], a[228:231], v[52:55], v[160:175]
  v_cvt_pk_bf16_f32 v208, v208, v209
  v_cvt_pk_bf16_f32 v209, v210, v211
  v_cvt_pk_bf16_f32 v210, v212, v213
  v_cvt_pk_bf16_f32 v211, v214, v215
  v_cvt_pk_bf16_f32 v212, v216, v217
  s_waitcnt vmcnt(4)
  v_mfma_f32_32x32x16_bf16 v[224:239], v[24:27], a[40:43], v[224:239]
  v_cvt_pk_bf16_f32 v213, v218, v219
  v_cvt_pk_bf16_f32 v214, v220, v221
  v_cvt_pk_bf16_f32 v215, v222, v223
  s_and_b32 s37, s39, 3
  s_lshl_b32 s37, s37, 8
  s_waitcnt vmcnt(2)
  v_mfma_f32_32x32x16_bf16 v[224:239], v[28:31], a[44:47], v[224:239]
  s_barrier
L_RS22:
  ds_read_b64_tr_b16 a[224:225], v2 offset:32768
  ds_read_b64_tr_b16 a[226:227], v2 offset:33280
  s_add_u32 s36, s36, s37
  s_waitcnt lgkmcnt(10)
  v_mfma_f32_32x32x16_bf16 v[160:175], a[232:235], v[56:59], v[160:175]
  ds_read_b64_tr_b16 a[228:229], v2 offset:34816
  ds_read_b64_tr_b16 a[230:231], v2 offset:35328
  ds_read_b64_tr_b16 a[232:233], v4 offset:32768
  s_lshl_b32 s26, s32, 14
  s_add_u32 s25, s25, s36
  s_add_u32 s26, s26, s36
  v_mfma_f32_32x32x16_bf16 v[160:175], a[236:239], v[60:63], v[160:175]
  ds_read_b64_tr_b16 a[234:235], v4 offset:33280
  v_cvt_pk_bf16_f32 v224, v224, v225
  v_cvt_pk_bf16_f32 v225, v226, v227
  v_cvt_pk_bf16_f32 v226, v228, v229
  v_cvt_pk_bf16_f32 v227, v230, v231
  s_waitcnt vmcnt(1)
  v_mfma_f32_32x32x16_bf16 v[160:175], v[24:27], a[32:35], v[160:175]
  v_cvt_pk_bf16_f32 v228, v232, v233
  v_cvt_pk_bf16_f32 v229, v234, v235
  v_cvt_pk_bf16_f32 v230, v236, v237
  v_cvt_pk_bf16_f32 v231, v238, v239
  s_and_b32 s37, s39, 1
  s_waitcnt vmcnt(0)
  v_mfma_f32_32x32x16_bf16 v[160:175], v[28:31], a[36:39], v[160:175]
  v_cmp_eq_u32 s[98:99], 5, v42
  s_nop 1
  v_cndmask_b32 v43, 0, v45, s[98:99]
  v_accvgpr_write_b32 a53, v43
  s_mul_i32 s56, s37, 14336
  s_waitcnt lgkmcnt(10)
  v_mfma_f32_32x32x16_bf16 v[160:175], a[240:243], v[80:83], v[160:175]
  buffer_store_dwordx4 v[208:211], v32, s[28:31], s41 offen offset:0
  v_mfma_f32_32x32x16_bf16 v[160:175], a[244:247], v[84:87], v[160:175]
  buffer_store_dwordx4 v[212:215], v32, s[28:31], s41 offen offset:1024
  s_waitcnt lgkmcnt(6)
  v_mfma_f32_32x32x16_bf16 v[160:175], a[248:251], v[88:91], v[160:175]
  ds_read_b64_tr_b16 a[236:237], v4 offset:34816
  ds_read_b64_tr_b16 a[238:239], v4 offset:35328
  ds_read_b64_tr_b16 a[240:241], v7 offset:32768
  s_mul_i32 s44, s32, 28672
  s_lshr_b32 s36, s39, 1
  s_add_u32 s44, s44, s56
  v_mfma_f32_32x32x16_bf16 v[160:175], a[252:255], v[92:95], v[160:175]
  ds_read_b64_tr_b16 a[242:243], v7 offset:33280
  ds_read_b64_tr_b16 a[244:245], v7 offset:34816
  ds_read_b64_tr_b16 a[246:247], v7 offset:35328
  s_lshl_b32 s37, s36, 5
  s_add_u32 s27, s44, s37
  s_waitcnt lgkmcnt(10)
  v_mfma_f32_32x32x16_bf16 v[64:79], a[224:227], v[240:243], 0
  buffer_store_dwordx4 v[224:227], v34, s[28:31], s41 offen offset:0
  v_mfma_f32_32x32x16_bf16 v[96:111], a[224:227], a[192:195], 0
  buffer_store_dwordx4 v[228:231], v34, s[28:31], s41 offen offset:1024
  s_waitcnt lgkmcnt(8)
  v_mfma_f32_32x32x16_bf16 v[64:79], a[228:231], v[244:247], v[64:79]
  buffer_load_dword v41, off, s[60:63], s54 sc1
  ds_read_b64_tr_b16 a[248:249], v46 offset:32768
  ds_read_b64_tr_b16 a[250:251], v46 offset:33280
  ds_read_b64_tr_b16 a[252:253], v46 offset:34816
  v_cvt_pk_bf16_f32 v160, v160, v161
  v_mfma_f32_32x32x16_bf16 v[96:111], a[228:231], a[196:199], v[96:111]
  ds_read_b64_tr_b16 a[254:255], v46 offset:35328
  ds_read_b64_tr_b16 a[224:225], v2 offset:49152
  ds_read_b64_tr_b16 a[226:227], v2 offset:49664
  v_cvt_pk_bf16_f32 v161, v162, v163
  v_cvt_pk_bf16_f32 v162, v164, v165
  s_waitcnt lgkmcnt(12)
  v_mfma_f32_32x32x16_bf16 v[64:79], a[232:235], v[248:251], v[64:79]
  ds_read_b64_tr_b16 a[228:229], v2 offset:51200
  ds_read_b64_tr_b16 a[230:231], v2 offset:51712
  v_cvt_pk_bf16_f32 v163, v166, v167
  v_cvt_pk_bf16_f32 v164, v168, v169
  v_cvt_pk_bf16_f32 v165, v170, v171
  v_cvt_pk_bf16_f32 v166, v172, v173
  v_mfma_f32_32x32x16_bf16 v[96:111], a[232:235], a[200:203], v[96:111]
  v_cvt_pk_bf16_f32 v167, v174, v175
  v_cmp_eq_u32 s[98:99], 6, v42
  s_nop 1
  v_cndmask_b32 v43, 0, v45, s[98:99]
  v_accvgpr_write_b32 a54, v43
  s_waitcnt lgkmcnt(12)
  v_mfma_f32_32x32x16_bf16 v[64:79], a[236:239], v[252:255], v[64:79]
  buffer_store_dwordx4 v[160:163], v33, s[28:31], s41 offen offset:0
  v_mfma_f32_32x32x16_bf16 v[96:111], a[236:239], a[204:207], v[96:111]
  ds_read_b64_tr_b16 a[232:233], v4 offset:49152
  ds_read_b64_tr_b16 a[234:235], v4 offset:49664
  s_lshl_b32 s36, s36, 4
  s_add_u32 s56, s56, s36
  s_lshl_b32 s37, s32, 7
  s_waitcnt lgkmcnt(10)
  v_mfma_f32_32x32x16_bf16 v[64:79], a[240:243], v[176:179], v[64:79]
  buffer_store_dwordx4 v[164:167], v33, s[28:31], s41 offen offset:1024
  v_mfma_f32_32x32x16_bf16 v[64:79], a[244:247], v[180:183], v[64:79]
  ds_read_b64_tr_b16 a[236:237], v4 offset:51200
  ds_read_b64_tr_b16 a[238:239], v4 offset:51712
  ds_read_b64_tr_b16 a[240:241], v7 offset:49152
  s_add_u32 s56, s56, s37
  s_mov_b32 s10, 33718272
  s_waitcnt lgkmcnt(9)
  v_mfma_f32_32x32x16_bf16 v[64:79], a[248:251], v[184:187], v[64:79]
  ds_read_b64_tr_b16 a[242:243], v7 offset:49664
  ds_read_b64_tr_b16 a[244:245], v7 offset:51200
  ds_read_b64_tr_b16 a[246:247], v7 offset:51712
  s_mov_b32 s14, 143360
  s_add_u32 s25, s25, 98304
  s_add_u32 s26, s26, 458752
  v_mfma_f32_32x32x16_bf16 v[64:79], a[252:255], v[188:191], v[64:79]
  ds_read_b64_tr_b16 a[248:249], v46 offset:49152
  ds_read_b64_tr_b16 a[250:251], v46 offset:49664
  s_add_u32 s44, s44, s36
  s_add_u32 s56, s56, 114688
  s_waitcnt lgkmcnt(12)
  v_mfma_f32_32x32x16_bf16 v[64:79], a[224:227], v[48:51], v[64:79]
  ds_read_b64_tr_b16 a[252:253], v46 offset:51200
  ds_read_b64_tr_b16 a[254:255], v46 offset:51712
  v_cmp_eq_u32 s[98:99], 7, v42
  s_nop 1
  v_cndmask_b32 v43, 0, v45, s[98:99]
  v_accvgpr_write_b32 a55, v43
  v_mfma_f32_32x32x16_bf16 v[96:111], a[224:227], a[208:211], v[96:111]
  s_waitcnt lgkmcnt(12)
  v_mfma_f32_32x32x16_bf16 v[64:79], a[228:231], v[52:55], v[64:79]
  s_waitcnt vmcnt(2)
  v_cmp_gt_i32 vcc, s35, v41
  s_nop 1
  s_cbranch_vccnz L_sp6
L_go6:
  ds_read_b64_tr_b16 a[224:225], v3 offset:32768
  ds_read_b64_tr_b16 a[226:227], v3 offset:33280
  v_mfma_f32_32x32x16_bf16 v[96:111], a[228:231], a[212:215], v[96:111]
  buffer_load_dwordx4 a[0:3], v32, s[16:19], s45 offen offset:0 sc1
  s_waitcnt lgkmcnt(12)
  v_mfma_f32_32x32x16_bf16 v[64:79], a[232:235], v[56:59], v[64:79]
  ds_read_b64_tr_b16 a[228:229], v3 offset:34816
  ds_read_b64_tr_b16 a[230:231], v3 offset:35328
  v_mfma_f32_32x32x16_bf16 v[96:111], a[232:235], a[216:219], v[96:111]
  buffer_load_dwordx4 a[4:7], v32, s[16:19], s45 offen offset:1024 sc1
  s_waitcnt lgkmcnt(12)
  v_mfma_f32_32x32x16_bf16 v[64:79], a[236:239], v[60:63], v[64:79]
  ds_read_b64_tr_b16 a[232:233], v5 offset:32768
  ds_read_b64_tr_b16 a[234:235], v5 offset:33280
  v_mfma_f32_32x32x16_bf16 v[96:111], a[236:239], a[220:223], v[96:111]
  buffer_load_dwordx4 a[16:19], v34, s[16:19], s45 offen offset:0 sc1
  s_waitcnt lgkmcnt(10)
  v_mfma_f32_32x32x16_bf16 v[64:79], a[240:243], v[80:83], v[64:79]
  s_waitcnt vmcnt(3)
  buffer_store_dword v40, v1, s[60:63], s3 offen
  ds_read_b64_tr_b16 a[236:237], v5 offset:34816
  ds_read_b64_tr_b16 a[238:239], v5 offset:35328
  ds_read_b64_tr_b16 a[240:241], v35 offset:32768
  v_mfma_f32_32x32x16_bf16 v[64:79], a[244:247], v[84:87], v[64:79]
  ds_read_b64_tr_b16 a[242:243], v35 offset:33280
  s_waitcnt lgkmcnt(10)
  v_mfma_f32_32x32x16_bf16 v[64:79], a[248:251], v[88:91], v[64:79]
  ds_read_b64_tr_b16 a[244:245], v35 offset:34816
  ds_read_b64_tr_b16 a[246:247], v35 offset:35328
  ds_read_b64_tr_b16 a[248:249], v47 offset:32768
  v_mfma_f32_32x32x16_bf16 v[64:79], a[252:255], v[92:95], v[64:79]
  ds_read_b64_tr_b16 a[250:251], v47 offset:33280
  buffer_load_dwordx4 a[20:23], v34, s[16:19], s45 offen offset:1024 sc1
  s_waitcnt lgkmcnt(10)
  v_mfma_f32_32x32x16_bf16 v[144:159], a[224:227], v[240:243], 0
  ds_read_b64_tr_b16 a[252:253], v47 offset:34816
  ds_read_b64_tr_b16 a[254:255], v47 offset:35328
  ds_read_b64_tr_b16 a[224:225], v3 offset:49152
  v_mfma_f32_32x32x16_bf16 v[144:159], a[228:231], v[244:247], v[144:159]
  buffer_load_dwordx4 a[8:11], v33, s[16:19], s45 offen offset:0 sc1
  s_waitcnt lgkmcnt(9)
  v_mfma_f32_32x32x16_bf16 v[144:159], a[232:235], v[248:251], v[144:159]
  ds_read_b64_tr_b16 a[226:227], v3 offset:49664
  buffer_load_dwordx4 a[12:15], v33, s[16:19], s45 offen offset:1024 sc1
  v_mfma_f32_32x32x16_bf16 v[144:159], a[236:239], v[252:255], v[144:159]
  ds_read_b64_tr_b16 a[228:229], v3 offset:51200
  ds_read_b64_tr_b16 a[230:231], v3 offset:51712
  ds_read_b64_tr_b16 a[232:233], v5 offset:49152
  s_waitcnt lgkmcnt(9)
  v_mfma_f32_32x32x16_bf16 v[144:159], a[240:243], v[176:179], v[144:159]
  ds_read_b64_tr_b16 a[234:235], v5 offset:49664
  ds_read_b64_tr_b16 a[236:237], v5 offset:51200
  ds_read_b64_tr_b16 a[238:239], v5 offset:51712
  v_mfma_f32_32x32x16_bf16 v[144:159], a[244:247], v[180:183], v[144:159]
  ds_read_b64_tr_b16 a[240:241], v35 offset:49152
  ds_read_b64_tr_b16 a[242:243], v35 offset:49664
  s_waitcnt lgkmcnt(10)
  v_mfma_f32_32x32x16_bf16 v[144:159], a[248:251], v[184:187], v[144:159]
  ds_read_b64_tr_b16 a[244:245], v35 offset:51200
  ds_read_b64_tr_b16 a[246:247], v35 offset:51712
  ds_read_b64_tr_b16 a[248:249], v47 offset:49152
  v_mfma_f32_32x32x16_bf16 v[144:159], a[252:255], v[188:191], v[144:159]
  ds_read_b64_tr_b16 a[250:251], v47 offset:49664
  s_waitcnt vmcnt(6)
  v_mfma_f32_32x32x16_bf16 v[64:79], v[24:27], a[0:3], v[64:79]
  s_waitcnt vmcnt(5)
  v_mfma_f32_32x32x16_bf16 v[64:79], v[28:31], a[4:7], v[64:79]
  s_waitcnt lgkmcnt(10)
  v_mfma_f32_32x32x16_bf16 v[144:159], a[224:227], v[48:51], v[144:159]
  ds_read_b64_tr_b16 a[252:253], v47 offset:51200
  ds_read_b64_tr_b16 a[254:255], v47 offset:51712
  v_mfma_f32_32x32x16_bf16 v[144:159], a[228:231], v[52:55], v[144:159]
  s_waitcnt vmcnt(4)
  v_mfma_f32_32x32x16_bf16 v[96:111], v[24:27], a[16:19], v[96:111]
  s_waitcnt vmcnt(2)
  v_mfma_f32_32x32x16_bf16 v[96:111], v[28:31], a[20:23], v[96:111]
  s_waitcnt lgkmcnt(8)
  v_mfma_f32_32x32x16_bf16 v[144:159], a[232:235], v[56:59], v[144:159]
  v_mfma_f32_32x32x16_bf16 v[144:159], a[236:239], v[60:63], v[144:159]
  v_cvt_pk_bf16_f32 v64, v64, v65
  v_cvt_pk_bf16_f32 v65, v66, v67
  v_cvt_pk_bf16_f32 v66, v68, v69
  v_cvt_pk_bf16_f32 v67, v70, v71
  v_cvt_pk_bf16_f32 v68, v72, v73
  s_waitcnt vmcnt(1)
  v_mfma_f32_32x32x16_bf16 v[144:159], v[24:27], a[8:11], v[144:159]
  v_cvt_pk_bf16_f32 v69, v74, v75
  v_cvt_pk_bf16_f32 v70, v76, v77
  v_cvt_pk_bf16_f32 v71, v78, v79
  v_cvt_pk_bf16_f32 v96, v96, v97
  v_cvt_pk_bf16_f32 v97, v98, v99
  s_waitcnt vmcnt(0)
  v_mfma_f32_32x32x16_bf16 v[144:159], v[28:31], a[12:15], v[144:159]
  v_cvt_pk_bf16_f32 v98, v100, v101
  v_cvt_pk_bf16_f32 v99, v102, v103
  v_cvt_pk_bf16_f32 v100, v104, v105
  v_cvt_pk_bf16_f32 v101, v106, v107
  v_cvt_pk_bf16_f32 v102, v108, v109
  s_waitcnt lgkmcnt(4)
  v_mfma_f32_32x32x16_bf16 v[144:159], a[240:243], v[80:83], v[144:159]
  buffer_store_dwordx4 v[64:67], v32, s[28:31], s45 offen offset:0
  v_mfma_f32_32x32x16_bf16 v[144:159], a[244:247], v[84:87], v[144:159]
  buffer_store_dwordx4 v[68:71], v32, s[28:31], s45 offen offset:1024
  s_waitcnt lgkmcnt(0)
  v_mfma_f32_32x32x16_bf16 v[144:159], a[248:251], v[88:91], v[144:159]
  v_cvt_pk_bf16_f32 v103, v110, v111
  v_mfma_f32_32x32x16_bf16 v[144:159], a[252:255], v[92:95], v[144:159]
  buffer_store_dwordx4 v[96:99], v34, s[28:31], s45 offen offset:0
  buffer_store_dwordx4 v[100:103], v34, s[28:31], s45 offen offset:1024
  s_nop 7
  s_nop 1
  v_cvt_pk_bf16_f32 v144, v144, v145
  v_cvt_pk_bf16_f32 v145, v146, v147
  v_cvt_pk_bf16_f32 v146, v148, v149
  v_cvt_pk_bf16_f32 v147, v150, v151
  v_cvt_pk_bf16_f32 v148, v152, v153
  v_cvt_pk_bf16_f32 v149, v154, v155
  v_cvt_pk_bf16_f32 v150, v156, v157
  v_cvt_pk_bf16_f32 v151, v158, v159
  buffer_store_dwordx4 v[144:147], v33, s[28:31], s45 offen offset:0
  buffer_store_dwordx4 v[148:151], v33, s[28:31], s45 offen offset:1024
  v_mov_b32 v40, 7
  s_cmp_gt_u32 s46, 7
  s_waitcnt vmcnt(0)
  s_cbranch_scc1 L_fall
  buffer_store_dword v40, v1, s[60:63], s3 offen
L_fp:
  buffer_load_dword v41, v12, s[60:63], 0 offen sc1
  s_add_u32 s101, s101, 1
  s_cmp_ge_u32 s101, 1048576
  s_waitcnt vmcnt(0)
  v_cmp_gt_u32 vcc, 7, v41
  s_cbranch_scc1 L_fgo
  s_nop 0
  s_cbranch_vccnz L_fp
L_fgo:
  buffer_load_dwordx4 a[64:67], v13, s[8:11], s26 offen offset:0 sc1
  s_add_u32 s26, s26, 65536
  buffer_load_dwordx4 a[68:71], v14, s[8:11], s26 offen offset:0 sc1
  s_add_u32 s26, s26, 49152
  buffer_load_dwordx4 a[72:75], v13, s[8:11], s26 offen offset:0 sc1
  s_add_u32 s26, s26, 65536
  buffer_load_dwordx4 a[76:79], v14, s[8:11], s26 offen offset:0 sc1
  buffer_load_dwordx4 a[80:83], v13, s[8:11], s24 offen offset:0 sc1
  buffer_load_dwordx4 a[84:87], v13, s[8:11], s24 offen offset:512 sc1
  s_add_u32 s24, s24, 32768
  buffer_load_dwordx4 a[88:91], v13, s[8:11], s24 offen offset:0 sc1
  buffer_load_dwordx4 a[92:95], v13, s[8:11], s24 offen offset:512 sc1
  s_add_u32 s24, s24, 32768
  buffer_load_dwordx4 a[96:99], v13, s[8:11], s24 offen offset:0 sc1
  buffer_load_dwordx4 a[100:103], v13, s[8:11], s24 offen offset:512 sc1
  buffer_load_dwordx4 a[104:107], v13, s[8:11], s25 offen offset:0 sc1
  s_waitcnt vmcnt(10)
  v_mfma_f32_16x16x32_bf16 v[48:51], a[48:51], a[64:67], 0
  s_waitcnt vmcnt(9)
  v_mfma_f32_16x16x32_bf16 v[48:51], a[52:55], a[68:71], v[48:51]
  s_waitcnt vmcnt(8)
  v_mfma_f32_16x16x32_bf16 v[48:51], a[48:51], a[72:75], v[48:51]
  s_waitcnt vmcnt(7)
  v_mfma_f32_16x16x32_bf16 v[48:51], a[52:55], a[76:79], v[48:51]
  s_waitcnt vmcnt(6)
  v_mfma_f32_16x16x32_bf16 v[24:27], a[48:51], a[80:83], 0
  s_waitcnt vmcnt(5)
  v_mfma_f32_16x16x32_bf16 v[24:27], a[52:55], a[84:87], v[24:27]
  s_waitcnt vmcnt(4)
  v_mfma_f32_16x16x32_bf16 v[28:31], a[48:51], a[88:91], 0
  s_waitcnt vmcnt(3)
  v_mfma_f32_16x16x32_bf16 v[28:31], a[52:55], a[92:95], v[28:31]
  s_nop 3
  v_cvt_pk_bf16_f32 v48, v48, v49
  v_cvt_pk_bf16_f32 v49, v50, v51
  buffer_store_dwordx2 v[48:49], v38, s[12:15], s56 offen offset:0
  s_waitcnt vmcnt(3)
  v_mfma_f32_16x16x32_bf16 v[40:43], a[48:51], a[96:99], 0
  s_waitcnt vmcnt(2)
  v_mfma_f32_16x16x32_bf16 v[40:43], a[52:55], a[100:103], v[40:43]
  v_cvt_pk_bf16_f32 v24, v24, v25
  v_cvt_pk_bf16_f32 v25, v26, v27
  buffer_store_dwordx2 v[24:25], v15, s[12:15], s27 offen offset:0
  s_waitcnt vmcnt(2)
  v_mfma_f32_16x16x32_bf16 v[44:47], a[48:51], a[104:107], 0
  v_cvt_pk_bf16_f32 v28, v28, v29
  v_cvt_pk_bf16_f32 v29, v30, v31
  buffer_store_dwordx2 v[28:29], v15, s[12:15], s27 offen offset:256
  s_nop 3
  v_cvt_pk_bf16_f32 v40, v40, v41
  v_cvt_pk_bf16_f32 v41, v42, v43
  buffer_store_dwordx2 v[40:41], v15, s[12:15], s27 offen offset:512
  s_nop 1
  v_cvt_pk_bf16_f32 v44, v44, v45
  v_cvt_pk_bf16_f32 v45, v46, v47
  buffer_store_dwordx2 v[44:45], v39, s[12:15], s44 offen offset:768
L_exit:
  s_endpgm
L_sp1:
  s_cmp_lt_u32 1, s46
  s_cbranch_scc1 L_go1
  v_mov_b32 v41, 1
  s_waitcnt vmcnt(0)
  buffer_store_dword v41, v1, s[60:63], s3 offen
L_sq1:
  buffer_load_dword v41, off, s[60:63], s54 sc1
  s_add_u32 s101, s101, 1
  s_cmp_ge_u32 s101, 1048576
  s_waitcnt vmcnt(0)
  v_cmp_gt_i32 vcc, s35, v41
  s_cbranch_scc1 L_go1
  s_nop 0
  s_cbranch_vccnz L_sq1
  s_branch L_go1
L_sp2:
  s_cmp_lt_u32 2, s46
  s_cbranch_scc1 L_go2
  v_mov_b32 v41, 2
  s_waitcnt vmcnt(0)
  buffer_store_dword v41, v1, s[60:63], s3 offen
L_sq2:
  buffer_load_dword v41, off, s[60:63], s54 sc1
  s_add_u32 s101, s101, 1
  s_cmp_ge_u32 s101, 1048576
  s_waitcnt vmcnt(0)
  v_cmp_gt_i32 vcc, s35, v41
  s_cbranch_scc1 L_go2
  s_nop 0
  s_cbranch_vccnz L_sq2
  s_branch L_go2
L_sp3:
  s_cmp_lt_u32 3, s46
  s_cbranch_scc1 L_go3
  v_mov_b32 v41, 3
  s_waitcnt vmcnt(0)
  buffer_store_dword v41, v1, s[60:63], s3 offen
L_sq3:
  buffer_load_dword v41, off, s[60:63], s54 sc1
  s_add_u32 s101, s101, 1
  s_cmp_ge_u32 s101, 1048576
  s_waitcnt vmcnt(0)
  v_cmp_gt_i32 vcc, s35, v41
  s_cbranch_scc1 L_go3
  s_nop 0
  s_cbranch_vccnz L_sq3
  s_branch L_go3
L_sp4:
  s_cmp_lt_u32 4, s46
  s_cbranch_scc1 L_go4
  v_mov_b32 v41, 4
  s_waitcnt vmcnt(0)
  buffer_store_dword v41, v1, s[60:63], s3 offen
L_sq4:
  buffer_load_dword v41, off, s[60:63], s54 sc1
  s_add_u32 s101, s101, 1
  s_cmp_ge_u32 s101, 1048576
  s_waitcnt vmcnt(0)
  v_cmp_gt_i32 vcc, s35, v41
  s_cbranch_scc1 L_go4
  s_nop 0
  s_cbranch_vccnz L_sq4
  s_branch L_go4
L_sp5:
  s_cmp_lt_u32 5, s46
  s_cbranch_scc1 L_go5
  v_mov_b32 v41, 5
  s_waitcnt vmcnt(0)
  buffer_store_dword v41, v1, s[60:63], s3 offen
L_sq5:
  buffer_load_dword v41, off, s[60:63], s54 sc1
  s_add_u32 s101, s101, 1
  s_cmp_ge_u32 s101, 1048576
  s_waitcnt vmcnt(0)
  v_cmp_gt_i32 vcc, s35, v41
  s_cbranch_scc1 L_go5
  s_nop 0
  s_cbranch_vccnz L_sq5
  s_branch L_go5
L_sp6:
  s_cmp_lt_u32 6, s46
  s_cbranch_scc1 L_go6
  v_mov_b32 v41, 6
  s_waitcnt vmcnt(0)
  buffer_store_dword v41, v1, s[60:63], s3 offen
L_sq6:
  buffer_load_dword v41, off, s[60:63], s54 sc1
  s_add_u32 s101, s101, 1
  s_cmp_ge_u32 s101, 1048576
  s_waitcnt vmcnt(0)
  v_cmp_gt_i32 vcc, s35, v41
  s_cbranch_scc1 L_go6
  s_nop 0
  s_cbranch_vccnz L_sq6
  s_branch L_go6
L_codeend:
L_decide:
  s_cmp_lt_i32 s100, 0
  s_cbranch_scc1 L_apart
  s_cmp_eq_u32 s100, s94
  s_cbranch_scc1 L_decided
  s_or_b32 s36, s100, 0x80000000
  v_mov_b32 v42, s36
  v_mov_b32 v43, s100
  v_lshlrev_b32 v44, 23, v0
  buffer_atomic_cmpswap v[42:43], v44, s[64:67], 0 offen sc0 sc1
  s_waitcnt vmcnt(0)
  v_readfirstlane_b32 s36, v42
  s_nop 0
  s_cmp_eq_u32 s36, s100
  s_mov_b32 s100, s36
  s_cbranch_scc0 L_decide
L_apart:
  s_and_b32 s36, s34, 3
  s_mul_i32 s36, s36, 11010048
  s_add_u32 s28, s28, s36
  s_addc_u32 s29, s29, 0
  s_mov_b32 s46, 99
  s_branch L_decided
L_fall:
  s_barrier
  buffer_wbl2 sc1
  s_lshl_b32 s36, s32, 29
  v_add_u32 v44, s36, v1
  v_mov_b32 v42, 1
  s_lshl_b32 s36, s32, 8
  v_lshlrev_b32 v43, 2, v0
  s_waitcnt vmcnt(0)
  buffer_atomic_add v42, v44, s[64:67], 0 offen offset:4 sc0 sc1
  v_add_u32 v43, s36, v43
  v_mov_b32 v44, 0
  s_waitcnt vmcnt(0)
  ds_write_b32 v43, v42
  s_waitcnt lgkmcnt(0)
  s_barrier
  ds_read_b32 v42, v44
  s_mov_b32 s39, 0
  s_waitcnt lgkmcnt(0)
  v_readfirstlane_b32 s36, v42
  s_nop 0
  s_cmp_lg_u32 s36, 15
  s_cbranch_scc1 L_exit
  buffer_inv sc1
  v_add_u32 v52, 0, v13
  v_add_u32 v56, 0, v14
  v_add_u32 v53, 11010048, v13
  v_add_u32 v57, 11010048, v14
  v_add_u32 v54, 22020096, v13
  v_add_u32 v58, 22020096, v14
  v_add_u32 v55, 33030144, v13
  v_add_u32 v59, 33030144, v14
  s_waitcnt vmcnt(0)
  s_barrier
L_all:
  s_mul_i32 s25, s32, 114688
  s_lshr_b32 s36, s39, 2
  s_lshl_b32 s36, s36, 13
  s_bfe_u32 s37, s39, 65537
  s_lshl_b32 s37, s37, 10
  s_add_u32 s36, s36, s37
  s_and_b32 s37, s39, 1
  s_lshl_b32 s37, s37, 8
  s_add_u32 s36, s36, s37
  s_add_u32 s24, s25, s36
  s_lshr_b32 s36, s39, 3
  s_lshl_b32 s36, s36, 13
  s_bfe_u32 s37, s39, 65538
  s_lshl_b32 s37, s37, 10
  s_add_u32 s36, s36, s37
  s_and_b32 s37, s39, 3
  s_lshl_b32 s37, s37, 8
  s_add_u32 s36, s36, s37
  s_add_u32 s25, s25, s36
  s_add_u32 s25, s25, 98304
  s_lshl_b32 s26, s32, 14
  s_add_u32 s26, s26, s36
  s_add_u32 s26, s26, 458752
  s_and_b32 s37, s39, 1
  s_mul_i32 s56, s37, 14336
  s_mul_i32 s44, s32, 28672
  s_add_u32 s44, s44, s56
  s_lshr_b32 s36, s39, 1
  s_lshl_b32 s37, s36, 5
  s_add_u32 s27, s44, s37
  s_lshl_b32 s36, s36, 4
  s_add_u32 s44, s44, s36
  s_add_u32 s56, s56, s36
  s_lshl_b32 s37, s32, 7
  s_add_u32 s56, s56, s37
  s_add_u32 s56, s56, 114688
  buffer_load_dwordx4 a[64:67], v52, s[8:11], s26 offen offset:0 sc1
  buffer_load_dwordx4 a[68:71], v53, s[8:11], s26 offen offset:0 sc1
  buffer_load_dwordx4 a[72:75], v54, s[8:11], s26 offen offset:0 sc1
  buffer_load_dwordx4 a[76:79], v55, s[8:11], s26 offen offset:0 sc1
  s_add_u32 s26, s26, 65536
  buffer_load_dwordx4 a[80:83], v56, s[8:11], s26 offen offset:0 sc1
  buffer_load_dwordx4 a[84:87], v57, s[8:11], s26 offen offset:0 sc1
  buffer_load_dwordx4 a[88:91], v58, s[8:11], s26 offen offset:0 sc1
  buffer_load_dwordx4 a[92:95], v59, s[8:11], s26 offen offset:0 sc1
  s_add_u32 s26, s26, 49152
  buffer_load_dwordx4 a[96:99], v52, s[8:11], s26 offen offset:0 sc1
  buffer_load_dwordx4 a[100:103], v53, s[8:11], s26 offen offset:0 sc1
  buffer_load_dwordx4 a[104:107], v54, s[8:11], s26 offen offset:0 sc1
  buffer_load_dwordx4 a[108:111], v55, s[8:11], s26 offen offset:0 sc1
  s_add_u32 s26, s26, 65536
  buffer_load_dwordx4 a[112:115], v56, s[8:11], s26 offen offset:0 sc1
  buffer_load_dwordx4 a[116:119], v57, s[8:11], s26 offen offset:0 sc1
  buffer_load_dwordx4 a[120:123], v58, s[8:11], s26 offen offset:0 sc1
  buffer_load_dwordx4 a[124:127], v59, s[8:11], s26 offen offset:0 sc1
  buffer_load_dwordx4 a[128:131], v52, s[8:11], s24 offen offset:0 sc1
  buffer_load_dwordx4 a[132:135], v53, s[8:11], s24 offen offset:0 sc1
  buffer_load_dwordx4 a[136:139], v54, s[8:11], s24 offen offset:0 sc1
  buffer_load_dwordx4 a[140:143], v55, s[8:11], s24 offen offset:0 sc1
  buffer_load_dwordx4 a[144:147], v52, s[8:11], s24 offen offset:512 sc1
  buffer_load_dwordx4 a[148:151], v53, s[8:11], s24 offen offset:512 sc1
  buffer_load_dwordx4 a[152:155], v54, s[8:11], s24 offen offset:512 sc1
  buffer_load_dwordx4 a[156:159], v55, s[8:11], s24 offen offset:512 sc1
  s_add_u32 s24, s24, 32768
  buffer_load_dwordx4 a[160:163], v52, s[8:11], s24 offen offset:0 sc1
  buffer_load_dwordx4 a[164:167], v53, s[8:11], s24 offen offset:0 sc1
  buffer_load_dwordx4 a[168:171], v54, s[8:11], s24 offen offset:0 sc1
  buffer_load_dwordx4 a[172:175], v55, s[8:11], s24 offen offset:0 sc1
  buffer_load_dwordx4 a[176:179], v52, s[8:11], s24 offen offset:512 sc1
  buffer_load_dwordx4 a[180:183], v53, s[8:11], s24 offen offset:512 sc1
  buffer_load_dwordx4 a[184:187], v54, s[8:11], s24 offen offset:512 sc1
  buffer_load_dwordx4 a[188:191], v55, s[8:11], s24 offen offset:512 sc1
  s_add_u32 s24, s24, 32768
  buffer_load_dwordx4 a[192:195], v52, s[8:11], s24 offen offset:0 sc1
  buffer_load_dwordx4 a[196:199], v53, s[8:11], s24 offen offset:0 sc1
  buffer_load_dwordx4 a[200:203], v54, s[8:11], s24 offen offset:0 sc1
  buffer_load_dwordx4 a[204:207], v55, s[8:11], s24 offen offset:0 sc1
  buffer_load_dwordx4 a[208:211], v52, s[8:11], s24 offen offset:512 sc1
  buffer_load_dwordx4 a[212:215], v53, s[8:11], s24 offen offset:512 sc1
  buffer_load_dwordx4 a[216:219], v54, s[8:11], s24 offen offset:512 sc1
  buffer_load_dwordx4 a[220:223], v55, s[8:11], s24 offen offset:512 sc1
  buffer_load_dwordx4 a[224:227], v52, s[8:11], s25 offen offset:0 sc1
  buffer_load_dwordx4 a[228:231], v53, s[8:11], s25 offen offset:0 sc1
  buffer_load_dwordx4 a[232:235], v54, s[8:11], s25 offen offset:0 sc1
  buffer_load_dwordx4 a[236:239], v55, s[8:11], s25 offen offset:0 sc1
  s_waitcnt vmcnt(43)
  v_mfma_f32_16x16x32_bf16 v[48:51], a[48:51], a[64:67], 0
  s_waitcnt vmcnt(42)
  v_mfma_f32_16x16x32_bf16 v[48:51], a[48:51], a[68:71], v[48:51]
  s_waitcnt vmcnt(41)
  v_mfma_f32_16x16x32_bf16 v[48:51], a[48:51], a[72:75], v[48:51]
  s_waitcnt vmcnt(40)
  v_mfma_f32_16x16x32_bf16 v[48:51], a[48:51], a[76:79], v[48:51]
  s_waitcnt vmcnt(39)
  v_mfma_f32_16x16x32_bf16 v[48:51], a[52:55], a[80:83], v[48:51]
  s_waitcnt vmcnt(38)
  v_mfma_f32_16x16x32_bf16 v[48:51], a[52:55], a[84:87], v[48:51]
  s_waitcnt vmcnt(37)
  v_mfma_f32_16x16x32_bf16 v[48:51], a[52:55], a[88:91], v[48:51]
  s_waitcnt vmcnt(36)
  v_mfma_f32_16x16x32_bf16 v[48:51], a[52:55], a[92:95], v[48:51]
  s_waitcnt vmcnt(35)
  v_mfma_f32_16x16x32_bf16 v[48:51], a[48:51], a[96:99], v[48:51]
  s_waitcnt vmcnt(34)
  v_mfma_f32_16x16x32_bf16 v[48:51], a[48:51], a[100:103], v[48:51]
  s_waitcnt vmcnt(33)
  v_mfma_f32_16x16x32_bf16 v[48:51], a[48:51], a[104:107], v[48:51]
  s_waitcnt vmcnt(32)
  v_mfma_f32_16x16x32_bf16 v[48:51], a[48:51], a[108:111], v[48:51]
  s_waitcnt vmcnt(31)
  v_mfma_f32_16x16x32_bf16 v[48:51], a[52:55], a[112:115], v[48:51]
  s_waitcnt vmcnt(30)
  v_mfma_f32_16x16x32_bf16 v[48:51], a[52:55], a[116:119], v[48:51]
  s_waitcnt vmcnt(29)
  v_mfma_f32_16x16x32_bf16 v[48:51], a[52:55], a[120:123], v[48:51]
  s_waitcnt vmcnt(28)
  v_mfma_f32_16x16x32_bf16 v[48:51], a[52:55], a[124:127], v[48:51]
  s_waitcnt vmcnt(27)
  v_mfma_f32_16x16x32_bf16 v[24:27], a[48:51], a[128:131], 0
  s_waitcnt vmcnt(26)
  v_mfma_f32_16x16x32_bf16 v[24:27], a[48:51], a[132:135], v[24:27]
  s_waitcnt vmcnt(25)
  v_mfma_f32_16x16x32_bf16 v[24:27], a[48:51], a[136:139], v[24:27]
  s_waitcnt vmcnt(24)
  v_mfma_f32_16x16x32_bf16 v[24:27], a[48:51], a[140:143], v[24:27]
  s_waitcnt vmcnt(23)
  v_mfma_f32_16x16x32_bf16 v[24:27], a[52:55], a[144:147], v[24:27]
  s_waitcnt vmcnt(22)
  v_mfma_f32_16x16x32_bf16 v[24:27], a[52:55], a[148:151], v[24:27]
  s_waitcnt vmcnt(21)
  v_mfma_f32_16x16x32_bf16 v[24:27], a[52:55], a[152:155], v[24:27]
  s_waitcnt vmcnt(20)
  v_mfma_f32_16x16x32_bf16 v[24:27], a[52:55], a[156:159], v[24:27]
  s_waitcnt vmcnt(19)
  v_mfma_f32_16x16x32_bf16 v[28:31], a[48:51], a[160:163], 0
  s_waitcnt vmcnt(18)
  v_mfma_f32_16x16x32_bf16 v[28:31], a[48:51], a[164:167], v[28:31]
  s_waitcnt vmcnt(17)
  v_mfma_f32_16x16x32_bf16 v[28:31], a[48:51], a[168:171], v[28:31]
  s_waitcnt vmcnt(16)
  v_mfma_f32_16x16x32_bf16 v[28:31], a[48:51], a[172:175], v[28:31]
  s_waitcnt vmcnt(15)
  v_mfma_f32_16x16x32_bf16 v[28:31], a[52:55], a[176:179], v[28:31]
  s_waitcnt vmcnt(14)
  v_mfma_f32_16x16x32_bf16 v[28:31], a[52:55], a[180:183], v[28:31]
  s_waitcnt vmcnt(13)
  v_mfma_f32_16x16x32_bf16 v[28:31], a[52:55], a[184:187], v[28:31]
  s_waitcnt vmcnt(12)
  v_mfma_f32_16x16x32_bf16 v[28:31], a[52:55], a[188:191], v[28:31]
  v_cvt_pk_bf16_f32 v48, v48, v49
  v_cvt_pk_bf16_f32 v49, v50, v51
  buffer_store_dwordx2 v[48:49], v38, s[12:15], s56 offen offset:0
  s_waitcnt vmcnt(12)
  v_mfma_f32_16x16x32_bf16 v[40:43], a[48:51], a[192:195], 0
  s_waitcnt vmcnt(11)
  v_mfma_f32_16x16x32_bf16 v[40:43], a[48:51], a[196:199], v[40:43]
  s_waitcnt vmcnt(10)
  v_mfma_f32_16x16x32_bf16 v[40:43], a[48:51], a[200:203], v[40:43]
  s_waitcnt vmcnt(9)
  v_mfma_f32_16x16x32_bf16 v[40:43], a[48:51], a[204:207], v[40:43]
  s_waitcnt vmcnt(8)
  v_mfma_f32_16x16x32_bf16 v[40:43], a[52:55], a[208:211], v[40:43]
  s_waitcnt vmcnt(7)
  v_mfma_f32_16x16x32_bf16 v[40:43], a[52:55], a[212:215], v[40:43]
  s_waitcnt vmcnt(6)
  v_mfma_f32_16x16x32_bf16 v[40:43], a[52:55], a[216:219], v[40:43]
  s_waitcnt vmcnt(5)
  v_mfma_f32_16x16x32_bf16 v[40:43], a[52:55], a[220:223], v[40:43]
  v_cvt_pk_bf16_f32 v24, v24, v25
  v_cvt_pk_bf16_f32 v25, v26, v27
  buffer_store_dwordx2 v[24:25], v15, s[12:15], s27 offen offset:0
  s_waitcnt vmcnt(5)
  v_mfma_f32_16x16x32_bf16 v[44:47], a[48:51], a[224:227], 0
  s_waitcnt vmcnt(4)
  v_mfma_f32_16x16x32_bf16 v[44:47], a[48:51], a[228:231], v[44:47]
  s_waitcnt vmcnt(3)
  v_mfma_f32_16x16x32_bf16 v[44:47], a[48:51], a[232:235], v[44:47]
  s_waitcnt vmcnt(2)
  v_mfma_f32_16x16x32_bf16 v[44:47], a[48:51], a[236:239], v[44:47]
  v_cvt_pk_bf16_f32 v28, v28, v29
  v_cvt_pk_bf16_f32 v29, v30, v31
  buffer_store_dwordx2 v[28:29], v15, s[12:15], s27 offen offset:256
  v_cvt_pk_bf16_f32 v40, v40, v41
  v_cvt_pk_bf16_f32 v41, v42, v43
  buffer_store_dwordx2 v[40:41], v15, s[12:15], s27 offen offset:512
  s_nop 5
  v_cvt_pk_bf16_f32 v44, v44, v45
  v_cvt_pk_bf16_f32 v45, v46, v47
  buffer_store_dwordx2 v[44:45], v39, s[12:15], s44 offen offset:768
  s_add_u32 s39, s39, 1
  s_cmp_lt_u32 s39, 16
  s_cbranch_scc1 L_all
  s_endpgm
L_fix0:
  s_nop 7
  s_nop 7
  s_cmp_eq_u32 s57, 2
  s_cbranch_scc1 L_sub0
  v_max3_f32 v41, v48, v49, v41
  v_max3_f32 v41, v50, v51, v41
  v_max3_f32 v41, v52, v53, v41
  v_max3_f32 v41, v54, v55, v41
  v_max3_f32 v41, v56, v57, v41
  v_max3_f32 v41, v58, v59, v41
  v_max3_f32 v41, v60, v61, v41
  v_max3_f32 v41, v62, v63, v41
  s_branch L_ret0
L_sub0:
  v_sub_f32 v48, v48, v41
  v_sub_f32 v49, v49, v41
  v_sub_f32 v50, v50, v41
  v_sub_f32 v51, v51, v41
  v_sub_f32 v52, v52, v41
  v_sub_f32 v53, v53, v41
  v_sub_f32 v54, v54, v41
  v_sub_f32 v55, v55, v41
  v_sub_f32 v56, v56, v41
  v_sub_f32 v57, v57, v41
  v_sub_f32 v58, v58, v41
  v_sub_f32 v59, v59, v41
  v_sub_f32 v60, v60, v41
  v_sub_f32 v61, v61, v41
  v_sub_f32 v62, v62, v41
  v_sub_f32 v63, v63, v41
  s_branch L_ret0
L_fix1:
  s_nop 7
  s_nop 7
  s_cmp_eq_u32 s57, 2
  s_cbranch_scc1 L_sub1
  v_max3_f32 v40, v240, v241, v40
  v_max3_f32 v40, v242, v243, v40
  v_max3_f32 v40, v244, v245, v40
  v_max3_f32 v40, v246, v247, v40
  v_max3_f32 v40, v248, v249, v40
  v_max3_f32 v40, v250, v251, v40
  v_max3_f32 v40, v252, v253, v40
  v_max3_f32 v40, v254, v255, v40
  s_branch L_ret1
L_sub1:
  v_sub_f32 v240, v240, v40
  v_sub_f32 v241, v241, v40
  v_sub_f32 v242, v242, v40
  v_sub_f32 v243, v243, v40
  v_sub_f32 v244, v244, v40
  v_sub_f32 v245, v245, v40
  v_sub_f32 v246, v246, v40
  v_sub_f32 v247, v247, v40
  v_sub_f32 v248, v248, v40
  v_sub_f32 v249, v249, v40
  v_sub_f32 v250, v250, v40
  v_sub_f32 v251, v251, v40
  v_sub_f32 v252, v252, v40
  v_sub_f32 v253, v253, v40
  v_sub_f32 v254, v254, v40
  v_sub_f32 v255, v255, v40
  s_branch L_ret1
L_fix2:
  s_nop 7
  s_nop 7
  s_cmp_eq_u32 s57, 2
  s_cbranch_scc1 L_sub2
  v_max3_f32 v40, v224, v225, v40
  v_max3_f32 v40, v226, v227, v40
  v_max3_f32 v40, v228, v229, v40
  v_max3_f32 v40, v230, v231, v40
  v_max3_f32 v40, v232, v233, v40
  v_max3_f32 v40, v234, v235, v40
  v_max3_f32 v40, v236, v237, v40
  v_max3_f32 v40, v238, v239, v40
  s_branch L_ret2
L_sub2:
  v_sub_f32 v224, v224, v40
  v_sub_f32 v225, v225, v40
  v_sub_f32 v226, v226, v40
  v_sub_f32 v227, v227, v40
  v_sub_f32 v228, v228, v40
  v_sub_f32 v229, v229, v40
  v_sub_f32 v230, v230, v40
  v_sub_f32 v231, v231, v40
  v_sub_f32 v232, v232, v40
  v_sub_f32 v233, v233, v40
  v_sub_f32 v234, v234, v40
  v_sub_f32 v235, v235, v40
  v_sub_f32 v236, v236, v40
  v_sub_f32 v237, v237, v40
  v_sub_f32 v238, v238, v40
  v_sub_f32 v239, v239, v40
  s_branch L_ret2
L_fix3:
  s_nop 7
  s_nop 7
  s_cmp_eq_u32 s57, 2
  s_cbranch_scc1 L_sub3
  v_max3_f32 v40, v176, v177, v40
  v_max3_f32 v40, v178, v179, v40
  v_max3_f32 v40, v180, v181, v40
  v_max3_f32 v40, v182, v183, v40
  v_max3_f32 v40, v184, v185, v40
  v_max3_f32 v40, v186, v187, v40
  v_max3_f32 v40, v188, v189, v40
  v_max3_f32 v40, v190, v191, v40
  s_branch L_ret3
L_sub3:
  v_sub_f32 v176, v176, v40
  v_sub_f32 v177, v177, v40
  v_sub_f32 v178, v178, v40
  v_sub_f32 v179, v179, v40
  v_sub_f32 v180, v180, v40
  v_sub_f32 v181, v181, v40
  v_sub_f32 v182, v182, v40
  v_sub_f32 v183, v183, v40
  v_sub_f32 v184, v184, v40
  v_sub_f32 v185, v185, v40
  v_sub_f32 v186, v186, v40
  v_sub_f32 v187, v187, v40
  v_sub_f32 v188, v188, v40
  v_sub_f32 v189, v189, v40
  v_sub_f32 v190, v190, v40
  v_sub_f32 v191, v191, v40
  s_branch L_ret3
L_fix4:
  s_nop 7
  s_nop 7
  s_cmp_eq_u32 s57, 2
  s_cbranch_scc1 L_sub4
  v_max3_f32 v40, v208, v209, v40
  v_max3_f32 v40, v210, v211, v40
  v_max3_f32 v40, v212, v213, v40
  v_max3_f32 v40, v214, v215, v40
  v_max3_f32 v40, v216, v217, v40
  v_max3_f32 v40, v218, v219, v40
  v_max3_f32 v40, v220, v221, v40
  v_max3_f32 v40, v222, v223, v40
  s_branch L_ret4
L_sub4:
  v_sub_f32 v208, v208, v40
  v_sub_f32 v209, v209, v40
  v_sub_f32 v210, v210, v40
  v_sub_f32 v211, v211, v40
  v_sub_f32 v212, v212, v40
  v_sub_f32 v213, v213, v40
  v_sub_f32 v214, v214, v40
  v_sub_f32 v215, v215, v40
  v_sub_f32 v216, v216, v40
  v_sub_f32 v217, v217, v40
  v_sub_f32 v218, v218, v40
  v_sub_f32 v219, v219, v40
  v_sub_f32 v220, v220, v40
  v_sub_f32 v221, v221, v40
  v_sub_f32 v222, v222, v40
  v_sub_f32 v223, v223, v40
  s_branch L_ret4
L_fix5:
  s_nop 7
  s_nop 7
  s_cmp_eq_u32 s57, 2
  s_cbranch_scc1 L_sub5
  v_max3_f32 v41, v128, v129, v41
  v_max3_f32 v41, v130, v131, v41
  v_max3_f32 v41, v132, v133, v41
  v_max3_f32 v41, v134, v135, v41
  v_max3_f32 v41, v136, v137, v41
  v_max3_f32 v41, v138, v139, v41
  v_max3_f32 v41, v140, v141, v41
  v_max3_f32 v41, v142, v143, v41
  s_branch L_ret5
L_sub5:
  v_sub_f32 v128, v128, v41
  v_sub_f32 v129, v129, v41
  v_sub_f32 v130, v130, v41
  v_sub_f32 v131, v131, v41
  v_sub_f32 v132, v132, v41
  v_sub_f32 v133, v133, v41
  v_sub_f32 v134, v134, v41
  v_sub_f32 v135, v135, v41
  v_sub_f32 v136, v136, v41
  v_sub_f32 v137, v137, v41
  v_sub_f32 v138, v138, v41
  v_sub_f32 v139, v139, v41
  v_sub_f32 v140, v140, v41
  v_sub_f32 v141, v141, v41
  v_sub_f32 v142, v142, v41
  v_sub_f32 v143, v143, v41
  s_branch L_ret5
L_fix6:
  s_nop 7
  s_nop 7
  s_cmp_eq_u32 s57, 2
  s_cbranch_scc1 L_sub6
  v_max3_f32 v40, v64, v65, v40
  v_max3_f32 v40, v66, v67, v40
  v_max3_f32 v40, v68, v69, v40
  v_max3_f32 v40, v70, v71, v40
  v_max3_f32 v40, v72, v73, v40
  v_max3_f32 v40, v74, v75, v40
  v_max3_f32 v40, v76, v77, v40
  v_max3_f32 v40, v78, v79, v40
  s_branch L_ret6
L_sub6:
  v_sub_f32 v64, v64, v40
  v_sub_f32 v65, v65, v40
  v_sub_f32 v66, v66, v40
  v_sub_f32 v67, v67, v40
  v_sub_f32 v68, v68, v40
  v_sub_f32 v69, v69, v40
  v_sub_f32 v70, v70, v40
  v_sub_f32 v71, v71, v40
  v_sub_f32 v72, v72, v40
  v_sub_f32 v73, v73, v40
  v_sub_f32 v74, v74, v40
  v_sub_f32 v75, v75, v40
  v_sub_f32 v76, v76, v40
  v_sub_f32 v77, v77, v40
  v_sub_f32 v78, v78, v40
  v_sub_f32 v79, v79, v40
  s_branch L_ret6
L_fix7:
  s_nop 7
  s_nop 7
  s_cmp_eq_u32 s57, 2
  s_cbranch_scc1 L_sub7
  v_max3_f32 v40, v80, v81, v40
  v_max3_f32 v40, v82, v83, v40
  v_max3_f32 v40, v84, v85, v40
  v_max3_f32 v40, v86, v87, v40
  v_max3_f32 v40, v88, v89, v40
  v_max3_f32 v40, v90, v91, v40
  v_max3_f32 v40, v92, v93, v40
  v_max3_f32 v40, v94, v95, v40
  s_branch L_ret7
L_sub7:
  v_sub_f32 v80, v80, v40
  v_sub_f32 v81, v81, v40
  v_sub_f32 v82, v82, v40
  v_sub_f32 v83, v83, v40
  v_sub_f32 v84, v84, v40
  v_sub_f32 v85, v85, v40
  v_sub_f32 v86, v86, v40
  v_sub_f32 v87, v87, v40
  v_sub_f32 v88, v88, v40
  v_sub_f32 v89, v89, v40
  v_sub_f32 v90, v90, v40
  v_sub_f32 v91, v91, v40
  v_sub_f32 v92, v92, v40
  v_sub_f32 v93, v93, v40
  v_sub_f32 v94, v94, v40
  v_sub_f32 v95, v95, v40
  s_branch L_ret7
L_fix8:
  s_nop 7
  s_nop 7
  s_cmp_eq_u32 s57, 2
  s_cbranch_scc1 L_sub8
  v_max3_f32 v40, v96, v97, v40
  v_max3_f32 v40, v98, v99, v40
  v_max3_f32 v40, v100, v101, v40
  v_max3_f32 v40, v102, v103, v40
  v_max3_f32 v40, v104, v105, v40
  v_max3_f32 v40, v106, v107, v40
  v_max3_f32 v40, v108, v109, v40
  v_max3_f32 v40, v110, v111, v40
  s_branch L_ret8
L_sub8:
  v_sub_f32 v96, v96, v40
  v_sub_f32 v97, v97, v40
  v_sub_f32 v98, v98, v40
  v_sub_f32 v99, v99, v40
  v_sub_f32 v100, v100, v40
  v_sub_f32 v101, v101, v40
  v_sub_f32 v102, v102, v40
  v_sub_f32 v103, v103, v40
  v_sub_f32 v104, v104, v40
  v_sub_f32 v105, v105, v40
  v_sub_f32 v106, v106, v40
  v_sub_f32 v107, v107, v40
  v_sub_f32 v108, v108, v40
  v_sub_f32 v109, v109, v40
  v_sub_f32 v110, v110, v40
  v_sub_f32 v111, v111, v40
  s_branch L_ret8
L_fix9:
  s_nop 7
  s_nop 7
  s_cmp_eq_u32 s57, 2
  s_cbranch_scc1 L_sub9
  v_max3_f32 v40, v112, v113, v40
  v_max3_f32 v40, v114, v115, v40
  v_max3_f32 v40, v116, v117, v40
  v_max3_f32 v40, v118, v119, v40
  v_max3_f32 v40, v120, v121, v40
  v_max3_f32 v40, v122, v123, v40
  v_max3_f32 v40, v124, v125, v40
  v_max3_f32 v40, v126, v127, v40
  s_branch L_ret9
L_sub9:
  v_sub_f32 v112, v112, v40
  v_sub_f32 v113, v113, v40
  v_sub_f32 v114, v114, v40
  v_sub_f32 v115, v115, v40
  v_sub_f32 v116, v116, v40
  v_sub_f32 v117, v117, v40
  v_sub_f32 v118, v118, v40
  v_sub_f32 v119, v119, v40
  v_sub_f32 v120, v120, v40
  v_sub_f32 v121, v121, v40
  v_sub_f32 v122, v122, v40
  v_sub_f32 v123, v123, v40
  v_sub_f32 v124, v124, v40
  v_sub_f32 v125, v125, v40
  v_sub_f32 v126, v126, v40
  v_sub_f32 v127, v127, v40
  s_branch L_ret9
L_fix10:
  s_nop 7
  s_nop 7
  s_cmp_eq_u32 s57, 2
  s_cbranch_scc1 L_sub10
  v_max3_f32 v41, v48, v49, v41
  v_max3_f32 v41, v50, v51, v41
  v_max3_f32 v41, v52, v53, v41
  v_max3_f32 v41, v54, v55, v41
  v_max3_f32 v41, v56, v57, v41
  v_max3_f32 v41, v58, v59, v41
  v_max3_f32 v41, v60, v61, v41
  v_max3_f32 v41, v62, v63, v41
  s_branch L_ret10
L_sub10:
  v_sub_f32 v48, v48, v41
  v_sub_f32 v49, v49, v41
  v_sub_f32 v50, v50, v41
  v_sub_f32 v51, v51, v41
  v_sub_f32 v52, v52, v41
  v_sub_f32 v53, v53, v41
  v_sub_f32 v54, v54, v41
  v_sub_f32 v55, v55, v41
  v_sub_f32 v56, v56, v41
  v_sub_f32 v57, v57, v41
  v_sub_f32 v58, v58, v41
  v_sub_f32 v59, v59, v41
  v_sub_f32 v60, v60, v41
  v_sub_f32 v61, v61, v41
  v_sub_f32 v62, v62, v41
  v_sub_f32 v63, v63, v41
  s_branch L_ret10
L_fix11:
  s_nop 7
  s_nop 7
  s_cmp_eq_u32 s57, 2
  s_cbranch_scc1 L_sub11
  v_max3_f32 v40, v144, v145, v40
  v_max3_f32 v40, v146, v147, v40
  v_max3_f32 v40, v148, v149, v40
  v_max3_f32 v40, v150, v151, v40
  v_max3_f32 v40, v152, v153, v40
  v_max3_f32 v40, v154, v155, v40
  v_max3_f32 v40, v156, v157, v40
  v_max3_f32 v40, v158, v159, v40
  s_branch L_ret11
L_sub11:
  v_sub_f32 v144, v144, v40
  v_sub_f32 v145, v145, v40
  v_sub_f32 v146, v146, v40
  v_sub_f32 v147, v147, v40
  v_sub_f32 v148, v148, v40
  v_sub_f32 v149, v149, v40
  v_sub_f32 v150, v150, v40
  v_sub_f32 v151, v151, v40
  v_sub_f32 v152, v152, v40
  v_sub_f32 v153, v153, v40
  v_sub_f32 v154, v154, v40
  v_sub_f32 v155, v155, v40
  v_sub_f32 v156, v156, v40
  v_sub_f32 v157, v157, v40
  v_sub_f32 v158, v158, v40
  v_sub_f32 v159, v159, v40
  s_branch L_ret11
L_fix12:
  s_nop 7
  s_nop 7
  s_cmp_eq_u32 s57, 2
  s_cbranch_scc1 L_sub12
  v_max3_f32 v40, v160, v161, v40
  v_max3_f32 v40, v162, v163, v40
  v_max3_f32 v40, v164, v165, v40
  v_max3_f32 v40, v166, v167, v40
  v_max3_f32 v40, v168, v169, v40
  v_max3_f32 v40, v170, v171, v40
  v_max3_f32 v40, v172, v173, v40
  v_max3_f32 v40, v174, v175, v40
  s_branch L_ret12
L_sub12:
  v_sub_f32 v160, v160, v40
  v_sub_f32 v161, v161, v40
  v_sub_f32 v162, v162, v40
  v_sub_f32 v163, v163, v40
  v_sub_f32 v164, v164, v40
  v_sub_f32 v165, v165, v40
  v_sub_f32 v166, v166, v40
  v_sub_f32 v167, v167, v40
  v_sub_f32 v168, v168, v40
  v_sub_f32 v169, v169, v40
  v_sub_f32 v170, v170, v40
  v_sub_f32 v171, v171, v40
  v_sub_f32 v172, v172, v40
  v_sub_f32 v173, v173, v40
  v_sub_f32 v174, v174, v40
  v_sub_f32 v175, v175, v40
  s_branch L_ret12
L_fix13:
  s_nop 7
  s_nop 7
  s_cmp_eq_u32 s57, 2
  s_cbranch_scc1 L_sub13
  v_max3_f32 v40, v192, v193, v40
  v_max3_f32 v40, v194, v195, v40
  v_max3_f32 v40, v196, v197, v40
  v_max3_f32 v40, v198, v199, v40
  v_max3_f32 v40, v200, v201, v40
  v_max3_f32 v40, v202, v203, v40
  v_max3_f32 v40, v204, v205, v40
  v_max3_f32 v40, v206, v207, v40
  s_branch L_ret13
L_sub13:
  v_sub_f32 v192, v192, v40
  v_sub_f32 v193, v193, v40
  v_sub_f32 v194, v194, v40
  v_sub_f32 v195, v195, v40
  v_sub_f32 v196, v196, v40
  v_sub_f32 v197, v197, v40
  v_sub_f32 v198, v198, v40
  v_sub_f32 v199, v199, v40
  v_sub_f32 v200, v200, v40
  v_sub_f32 v201, v201, v40
  v_sub_f32 v202, v202, v40
  v_sub_f32 v203, v203, v40
  v_sub_f32 v204, v204, v40
  v_sub_f32 v205, v205, v40
  v_sub_f32 v206, v206, v40
  v_sub_f32 v207, v207, v40
  s_branch L_ret13
L_fix14:
  s_nop 7
  s_nop 7
  s_cmp_eq_u32 s57, 2
  s_cbranch_scc1 L_sub14
  v_max3_f32 v40, v224, v225, v40
  v_max3_f32 v40, v226, v227, v40
  v_max3_f32 v40, v228, v229, v40
  v_max3_f32 v40, v230, v231, v40
  v_max3_f32 v40, v232, v233, v40
  v_max3_f32 v40, v234, v235, v40
  v_max3_f32 v40, v236, v237, v40
  v_max3_f32 v40, v238, v239, v40
  s_branch L_ret14
L_sub14:
  v_sub_f32 v224, v224, v40
  v_sub_f32 v225, v225, v40
  v_sub_f32 v226, v226, v40
  v_sub_f32 v227, v227, v40
  v_sub_f32 v228, v228, v40
  v_sub_f32 v229, v229, v40
  v_sub_f32 v230, v230, v40
  v_sub_f32 v231, v231, v40
  v_sub_f32 v232, v232, v40
  v_sub_f32 v233, v233, v40
  v_sub_f32 v234, v234, v40
  v_sub_f32 v235, v235, v40
  v_sub_f32 v236, v236, v40
  v_sub_f32 v237, v237, v40
  v_sub_f32 v238, v238, v40
  v_sub_f32 v239, v239, v40
  s_branch L_ret14
L_fix15:
  s_nop 7
  s_nop 7
  s_cmp_eq_u32 s57, 2
  s_cbranch_scc1 L_sub15
  v_max3_f32 v41, v208, v209, v41
  v_max3_f32 v41, v210, v211, v41
  v_max3_f32 v41, v212, v213, v41
  v_max3_f32 v41, v214, v215, v41
  v_max3_f32 v41, v216, v217, v41
  v_max3_f32 v41, v218, v219, v41
  v_max3_f32 v41, v220, v221, v41
  v_max3_f32 v41, v222, v223, v41
  s_branch L_ret15
L_sub15:
  v_sub_f32 v208, v208, v41
  v_sub_f32 v209, v209, v41
  v_sub_f32 v210, v210, v41
  v_sub_f32 v211, v211, v41
  v_sub_f32 v212, v212, v41
  v_sub_f32 v213, v213, v41
  v_sub_f32 v214, v214, v41
  v_sub_f32 v215, v215, v41
  v_sub_f32 v216, v216, v41
  v_sub_f32 v217, v217, v41
  v_sub_f32 v218, v218, v41
  v_sub_f32 v219, v219, v41
  v_sub_f32 v220, v220, v41
  v_sub_f32 v221, v221, v41
  v_sub_f32 v222, v222, v41
  v_sub_f32 v223, v223, v41
  s_branch L_ret15
L_fix16:
  s_nop 7
  s_nop 7
  s_cmp_eq_u32 s57, 2
  s_cbranch_scc1 L_sub16
  v_max3_f32 v40, v128, v129, v40
  v_max3_f32 v40, v130, v131, v40
  v_max3_f32 v40, v132, v133, v40
  v_max3_f32 v40, v134, v135, v40
  v_max3_f32 v40, v136, v137, v40
  v_max3_f32 v40, v138, v139, v40
  v_max3_f32 v40, v140, v141, v40
  v_max3_f32 v40, v142, v143, v40
  s_branch L_ret16
L_sub16:
  v_sub_f32 v128, v128, v40
  v_sub_f32 v129, v129, v40
  v_sub_f32 v130, v130, v40
  v_sub_f32 v131, v131, v40
  v_sub_f32 v132, v132, v40
  v_sub_f32 v133, v133, v40
  v_sub_f32 v134, v134, v40
  v_sub_f32 v135, v135, v40
  v_sub_f32 v136, v136, v40
  v_sub_f32 v137, v137, v40
  v_sub_f32 v138, v138, v40
  v_sub_f32 v139, v139, v40
  v_sub_f32 v140, v140, v40
  v_sub_f32 v141, v141, v40
  v_sub_f32 v142, v142, v40
  v_sub_f32 v143, v143, v40
  s_branch L_ret16
L_fix17:
  s_nop 7
  s_nop 7
  s_cmp_eq_u32 s57, 2
  s_cbranch_scc1 L_sub17
  v_max3_f32 v40, v80, v81, v40
  v_max3_f32 v40, v82, v83, v40
  v_max3_f32 v40, v84, v85, v40
  v_max3_f32 v40, v86, v87, v40
  v_max3_f32 v40, v88, v89, v40
  v_max3_f32 v40, v90, v91, v40
  v_max3_f32 v40, v92, v93, v40
  v_max3_f32 v40, v94, v95, v40
  s_branch L_ret17
L_sub17:
  v_sub_f32 v80, v80, v40
  v_sub_f32 v81, v81, v40
  v_sub_f32 v82, v82, v40
  v_sub_f32 v83, v83, v40
  v_sub_f32 v84, v84, v40
  v_sub_f32 v85, v85, v40
  v_sub_f32 v86, v86, v40
  v_sub_f32 v87, v87, v40
  v_sub_f32 v88, v88, v40
  v_sub_f32 v89, v89, v40
  v_sub_f32 v90, v90, v40
  v_sub_f32 v91, v91, v40
  v_sub_f32 v92, v92, v40
  v_sub_f32 v93, v93, v40
  v_sub_f32 v94, v94, v40
  v_sub_f32 v95, v95, v40
  s_branch L_ret17
L_fix18:
  s_nop 7
  s_nop 7
  s_cmp_eq_u32 s57, 2
  s_cbranch_scc1 L_sub18
  v_max3_f32 v40, v112, v113, v40
  v_max3_f32 v40, v114, v115, v40
  v_max3_f32 v40, v116, v117, v40
  v_max3_f32 v40, v118, v119, v40
  v_max3_f32 v40, v120, v121, v40
  v_max3_f32 v40, v122, v123, v40
  v_max3_f32 v40, v124, v125, v40
  v_max3_f32 v40, v126, v127, v40
  s_branch L_ret18
L_sub18:
  v_sub_f32 v112, v112, v40
  v_sub_f32 v113, v113, v40
  v_sub_f32 v114, v114, v40
  v_sub_f32 v115, v115, v40
  v_sub_f32 v116, v116, v40
  v_sub_f32 v117, v117, v40
  v_sub_f32 v118, v118, v40
  v_sub_f32 v119, v119, v40
  v_sub_f32 v120, v120, v40
  v_sub_f32 v121, v121, v40
  v_sub_f32 v122, v122, v40
  v_sub_f32 v123, v123, v40
  v_sub_f32 v124, v124, v40
  v_sub_f32 v125, v125, v40
  v_sub_f32 v126, v126, v40
  v_sub_f32 v127, v127, v40
  s_branch L_ret18
L_fix19:
  s_nop 7
  s_nop 7
  s_cmp_eq_u32 s57, 2
  s_cbranch_scc1 L_sub19
  v_max3_f32 v40, v160, v161, v40
  v_max3_f32 v40, v162, v163, v40
  v_max3_f32 v40, v164, v165, v40
  v_max3_f32 v40, v166, v167, v40
  v_max3_f32 v40, v168, v169, v40
  v_max3_f32 v40, v170, v171, v40
  v_max3_f32 v40, v172, v173, v40
  v_max3_f32 v40, v174, v175, v40
  s_branch L_ret19
L_sub19:
  v_sub_f32 v160, v160, v40
  v_sub_f32 v161, v161, v40
  v_sub_f32 v162, v162, v40
  v_sub_f32 v163, v163, v40
  v_sub_f32 v164, v164, v40
  v_sub_f32 v165, v165, v40
  v_sub_f32 v166, v166, v40
  v_sub_f32 v167, v167, v40
  v_sub_f32 v168, v168, v40
  v_sub_f32 v169, v169, v40
  v_sub_f32 v170, v170, v40
  v_sub_f32 v171, v171, v40
  v_sub_f32 v172, v172, v40
  v_sub_f32 v173, v173, v40
  v_sub_f32 v174, v174, v40
  v_sub_f32 v175, v175, v40
  s_branch L_ret19
L_slow:
  s_cmp_eq_u32 s57, 2
  s_cbranch_scc1 L_checked
  s_nop 7
  s_nop 7
  s_waitcnt vmcnt(0) lgkmcnt(0)
  s_barrier
  s_mov_b64 vcc, -1
  s_cmp_eq_u32 s57, 1
  s_cbranch_scc1 L_slow2
  s_mov_b32 s57, 1
  s_mov_b32 s59, 0
  v_mov_b32 v40, 0xff800000
  v_mov_b32 v41, 0xff800000
  s_branch L_start
L_slow2:
  s_mov_b32 s57, 2
  s_mov_b32 s58, 0
  s_mov_b32 s59, -1
  v_mov_b32 v42, v40
  v_mov_b32 v43, v41
  s_nop 1
  v_permlane32_swap_b32 v42, v40
  v_permlane32_swap_b32 v43, v41
  v_lshlrev_b32 v44, 2, v0
  s_lshl_b32 s36, s32, 8
  v_max_f32 v40, v42, v40
  v_max_f32 v41, v43, v41
  v_add_u32 v45, s36, v44
  ds_write_b32 v45, v41
  s_waitcnt lgkmcnt(0)
  s_barrier
  ds_read_b32 v42, v44
  ds_read_b32 v43, v44 offset:256
  ds_read_b32 v45, v44 offset:512
  ds_read_b32 v46, v44 offset:768
  s_waitcnt lgkmcnt(0)
  v_max3_f32 v41, v42, v43, v45
  v_max_f32 v41, v41, v46
  s_barrier
  s_branch L_start
s_endpgm
.section .rodata,"a"
.p2align 6
.amdhsa_kernel standalone__mha_block_cached__near_ridge_kernel
  .amdhsa_next_free_vgpr 512
  .amdhsa_next_free_sgpr 102
  .amdhsa_accum_offset 256
  .amdhsa_group_segment_fixed_size 0
  .amdhsa_kernarg_size 64
  .amdhsa_user_sgpr_count 2
  .amdhsa_user_sgpr_kernarg_segment_ptr 1
  .amdhsa_system_sgpr_workgroup_id_x 1
.end_amdhsa_kernel
.p2align 6
```
